```python
import torch

def _softmax(x, axis=-1):
    return torch.softmax(x, dim=axis)
def _gelu(x):
    return torch.nn.functional.gelu(x, approximate="tanh")
def _silu(x):
    return torch.nn.functional.silu(x)
def _sigmoid(x):
    return torch.sigmoid(x)
def _layernorm(x, axis=-1, eps=1e-5):
    m = x.mean(dim=axis, keepdim=True)
    v = x.var(dim=axis, keepdim=True, unbiased=False)
    return (x - m) / torch.sqrt(v + eps)
def _scatter_add(tgt, idx, src, axis=0):
    return tgt.clone().index_add_(axis, idx, src)
def _segment_sum(src, seg, n):
    out = torch.zeros((n,) + src.shape[1:], dtype=src.dtype)
    return out.index_add_(0, seg, src)
def _pad(x, pw):
    flat = tuple(v for pair in reversed(pw) for v in pair)
    return torch.nn.functional.pad(x, flat)

kernel_name = 'sequential_preLN__ssm_conv_h3__glu_gated_glu__prompt'

def setup_inputs():

    _w = (lambda a: (lambda t: t.to(torch.bfloat16) if t.is_floating_point() else t)(torch.as_tensor(a)))
    def _A_setup():
        B, S, D = 1, 2048, 640
        ks = 4
        return {
            "q": _w((lambda *s: torch.randn(*s, dtype=torch.bfloat16) * 0.05)(B, S, D)),
            "k": _w((lambda *s: torch.randn(*s, dtype=torch.bfloat16) * 0.4)(B, S, D)),
            "v": _w((lambda *s: torch.randn(*s, dtype=torch.bfloat16) * 0.4)(B, S, D)),
            "shift_k": _w((lambda *s: torch.randn(*s, dtype=torch.bfloat16) * 0.4)(D, ks) * 0.5),
            "ssm_k": _w((lambda *s: torch.randn(*s, dtype=torch.bfloat16) * 0.4)(D, S) * (1.0 / S ** 0.5)),
            "ssm_D": _w((lambda *s: torch.randn(*s, dtype=torch.bfloat16) * 0.4)(D)),
        }
    _A_in = _A_setup()

    def _B_setup():
        B, S, D, F = 1, 2048, 640, 1728
        return {
            "x": _w((lambda *s: torch.randn(*s, dtype=torch.bfloat16) * 0.05)(B, S, D)),
            "w_gate": _w((lambda *s: torch.randn(*s, dtype=torch.bfloat16) * 0.05)(D, F)),
            "w_up": _w((lambda *s: torch.randn(*s, dtype=torch.bfloat16) * 0.05)(D, F)),
            "w_down": _w((lambda *s: torch.randn(*s, dtype=torch.bfloat16) * 0.05)(F, D)),
        }
    _B_in = _B_setup()

    return {
        "A_q": _A_in["q"],
        "A_k": _A_in["k"],
        "A_v": _A_in["v"],
        "A_shift_k": _A_in["shift_k"],
        "A_ssm_k": _A_in["ssm_k"],
        "A_ssm_D": _A_in["ssm_D"],
        "B_x": _B_in["x"],
        "B_w_gate": _B_in["w_gate"],
        "B_w_up": _B_in["w_up"],
        "B_w_down": _B_in["w_down"],
    }

def reference(A_q, A_k, A_v, A_shift_k, A_ssm_k, A_ssm_D, B_x, B_w_gate, B_w_up, B_w_down):
    def _A_ref(q, k, v, shift_k, ssm_k, ssm_D):
        B, S, D = q.shape
        ks = shift_k.shape[-1]
        k_pad = _pad(k, ((0, 0), (ks - 1, 0), (0, 0)))
        k_shift = torch.zeros_like(k)
        for t in range(ks):
            k_shift = k_shift + k_pad[:, t:t + S, :] * shift_k[:, ks - 1 - t][None, None, :]
        kv = k_shift * v
        L = 2 * S
        kv_pad = _pad(kv, ((0, 0), (0, S), (0, 0)))
        kf_pad = _pad(ssm_k, ((0, 0), (0, S)))
        kv_f = (lambda x, axes=(-2,-1): torch.fft.rfft2(x.float(), dim=axes))(kv_pad[:, None, :, :], axes=(1, 2))
        kf_f = (lambda x, axes=(-2,-1): torch.fft.rfft2(x.float(), dim=axes))(kf_pad[:, None, :], axes=(1, 2))
        kf_f = (lambda x, *d: x.permute(*d))(kf_f, 1, 2, 0)
        y_f = kv_f * kf_f[None, :, :, :]
        y = (lambda x, s, axes=(-2,-1): torch.fft.irfft2(x, s=s, dim=axes).to(torch.bfloat16))(y_f, (1, L), axes=(1, 2))[:, 0, :S, :]
        y = y + kv * ssm_D[None, None, :]
        return q * y

    def _B_ref(x, w_gate, w_up, w_down):
        g = torch.einsum("bsd,df->bsf", x, w_gate)
        u = torch.einsum("bsd,df->bsf", x, w_up)
        h = _sigmoid(g) * u
        return torch.einsum("bsf,fd->bsd", h, w_down)

    x = A_q
    h = x + _A_ref(_layernorm(x, axis=-1), A_k, A_v, A_shift_k, A_ssm_k, A_ssm_D)
    h2 = h + _B_ref(_layernorm(h, axis=-1), B_w_gate, B_w_up, B_w_down)
    return h2
```

```asm
; @launch grid=(256,1,1) block=(256,1,1) lds=163840
.amdgcn_target "amdgcn-amd-amdhsa--gfx950"
.text
.globl sequential_preLN__ssm_conv_h3__glu_gated_glu__prompt_kernel
.p2align 8
.type sequential_preLN__ssm_conv_h3__glu_gated_glu__prompt_kernel,@function
sequential_preLN__ssm_conv_h3__glu_gated_glu__prompt_kernel:
    s_cmp_ge_u32 s2, 256
    s_cbranch_scc1 L_end
    s_load_dwordx16 s[4:19], s[0:1], 0
    s_load_dwordx8 s[20:27], s[0:1], 64
    s_load_dwordx2 s[28:29], s[0:1], 96
    s_and_b32 s97, s2, 7
    s_lshr_b32 s96, s2, 3
    s_getpc_b64 s[52:53]
L_pc:
    v_lshrrev_b32 v1, 6, v0
    v_bfrev_b32 v8, 1
    v_readfirstlane_b32 s3, v1
    v_and_b32 v1, 63, v0
    v_lshlrev_b32 v10, 4, v1
    s_cmp_ge_u32 s96, 20
    s_cbranch_scc1 L_nc
    s_mul_i32 s50, s2, 6554
    s_lshr_b32 s50, s50, 16
    s_mul_i32 s51, s50, 10
    s_sub_u32 s51, s2, s51
    s_mul_i32 s57, s50, 81920
    s_lshl_b32 s61, s51, 7
    s_add_u32 s57, s57, s61
    s_mul_i32 s60, s3, 10240
    s_add_u32 s60, s60, s57
    s_sub_u32 s61, s60, 3840
    s_add_u32 s57, s57, 78080
    v_lshrrev_b32 v12, 3, v1
    v_and_b32 v3, 7, v1
    v_lshrrev_b32 v13, 5, v1
    v_lshlrev_b32 v13, 1, v13
    v_xor_b32 v13, v13, v3
    v_mul_u32_u24 v6, 1280, v12
    v_lshl_add_u32 v6, v13, 4, v6
    s_and_b32 s30, s3, 2
    s_lshl_b32 s30, s30, 5
    v_xor_b32 v5, s30, v6
    v_cmp_gt_u32 vcc, 24, v1
    v_add_u32 v14, s61, v5
    v_min_u32 v14, v14, v8
    v_cndmask_b32 v6, v8, v6, vcc
    v_cmp_gt_u32 vcc, 32, v1
    s_mul_i32 s62, s3, 1152
    s_add_u32 s62, s62, 122880
    s_lshl_b32 s63, s51, 9
    v_cndmask_b32 v9, v8, v10, vcc
    s_waitcnt lgkmcnt(0)
    s_mov_b32 s32, s6
    s_and_b32 s33, s7, 0xffff
    s_mov_b32 s34, 2621440
    s_mov_b32 s35, 0x20000
    s_add_u32 m0, s62, 0
    s_nop 0
    buffer_load_dwordx4 v14, s[32:35], 0 offen nt lds
    s_mov_b32 s36, s8
    s_and_b32 s37, s9, 0xffff
    s_mov_b32 s38, 2621440
    s_mov_b32 s39, 0x20000
    s_add_u32 m0, s62, 10368
    s_add_u32 s30, s60, 0
    buffer_load_dwordx4 v5, s[36:39], s30 offen nt lds
    s_add_u32 m0, s62, 4608
    s_add_u32 s30, s61, 40960
    buffer_load_dwordx4 v5, s[32:35], s30 offen nt lds
    s_add_u32 m0, s62, 14976
    s_add_u32 s30, s60, 40960
    buffer_load_dwordx4 v5, s[36:39], s30 offen nt lds
    s_mov_b32 m0, 132096
    s_add_u32 s30, s57, 0
    buffer_load_dwordx4 v6, s[32:35], s30 offen nt lds
    s_add_u32 s30, s28, 41943040
    s_addc_u32 s31, s29, 0
    s_load_dword s100, s[30:31], 0
    s_mov_b32 s40, s10
    s_and_b32 s41, s11, 0xffff
    s_mov_b32 s42, 5120
    s_mov_b32 s43, 0x20000
    s_mov_b32 m0, 162048
    s_nop 0
    buffer_load_dwordx4 v9, s[40:43], s63 offen lds
    s_mov_b32 s52, s12
    s_and_b32 s53, s13, 0xffff
    s_mov_b32 s54, 2621440
    s_mov_b32 s55, 0x20000
    s_mul_i32 s79, s97, 20
    s_add_u32 s79, s79, s96
    s_lshl_b32 s56, s79, 2
    s_add_u32 s56, s56, s3
    s_mul_i32 s64, s3, 8320
    s_add_u32 s64, s64, 40960
    s_add_u32 m0, s64, 4192
    s_lshl_b32 s30, s56, 12
    buffer_load_dwordx4 v10, s[52:55], s30 offen offset:0 nt lds
    buffer_load_dwordx4 v10, s[52:55], s30 offen offset:1024 nt lds
    buffer_load_dwordx4 v10, s[52:55], s30 offen offset:2048 nt lds
    buffer_load_dwordx4 v10, s[52:55], s30 offen offset:3072 nt lds
    s_and_b32 s31, s3, 1
    s_lshl_b32 s30, s31, 8
    s_add_u32 s30, s30, 162048
    v_lshlrev_b32 v254, 5, v12
    v_add_u32 v254, s30, v254
    v_mul_u32_u24 v2, 4096, v12
    v_lshl_add_u32 v2, v3, 4, v2
    s_lshr_b32 s63, s3, 1
    s_mul_i32 s30, s63, 4608
    s_add_u32 s30, s30, 122880
    s_lshl_b32 s31, s31, 6
    v_lshlrev_b32 v7, 3, v12
    v_or_b32 v7, s31, v7
    v_add_u32 v13, 0, v3
    v_lshrrev_b32 v14, 1, v13
    v_mul_u32_u24 v14, 1152, v14
    v_and_b32 v15, 1, v13
    v_lshl_add_u32 v14, v15, 9, v14
    v_and_b32 v13, 4, v13
    v_lshlrev_b32 v13, 4, v13
    v_lshl_or_b32 v13, v15, 5, v13
    v_xor_b32 v13, v13, v7
    v_add3_u32 v4, v14, v13, s30
    v_add_u32 v13, 1, v3
    v_lshrrev_b32 v14, 1, v13
    v_mul_u32_u24 v14, 1152, v14
    v_and_b32 v15, 1, v13
    v_lshl_add_u32 v14, v15, 9, v14
    v_and_b32 v13, 4, v13
    v_lshlrev_b32 v13, 4, v13
    v_lshl_or_b32 v13, v15, 5, v13
    v_xor_b32 v13, v13, v7
    v_add3_u32 v9, v14, v13, s30
    s_lshl_b32 s50, s50, 1
    s_add_u32 s50, s50, s63
    s_lshr_b32 s48, s50, 3
    s_mul_i32 s48, s48, 655360
    s_mul_i32 s49, s51, 65536
    s_add_u32 s48, s48, s49
    s_mul_i32 s49, s31, 512
    s_add_u32 s48, s48, s49
    s_and_b32 s49, s50, 7
    s_lshl_b32 s49, s49, 7
    s_add_u32 s48, s48, s49
    s_add_u32 s48, s48, 25165824
    s_add_u32 s49, s48, 2621440
    v_mul_u32_u24 v17, 20480, v12
    v_lshl_add_u32 v17, v3, 4, v17
    s_lshl_b32 s30, s79, 3
    s_load_dwordx2 s[58:59], s[14:15], s30
    v_and_b32 v30, 15, v1
    v_lshrrev_b32 v31, 4, v1
    s_mul_i32 s63, s3, 4576
    s_add_u32 s31, s63, 480
    v_lshlrev_b32 v13, 5, v30
    v_sub_u32 v13, s31, v13
    v_lshl_add_u32 v13, v31, 4, v13
    s_add_u32 s31, s63, 504
    v_lshlrev_b32 v12, 3, v1
    v_sub_u32 v12, s31, v12
    v_and_b32 v14, 1, v1
    v_mul_u32_u24 v14, 4160, v14
    v_lshrrev_b32 v15, 1, v30
    v_lshl_add_u32 v14, v15, 2, v14
    v_lshl_add_u32 v14, v31, 4, v14
    v_add3_u32 v14, v14, s64, 4
    s_mul_i32 s65, s3, 576
    s_add_u32 s65, s65, 18304
    v_lshlrev_b32 v15, 5, v30
    v_lshl_add_u32 v15, v31, 3, v15
    v_add_u32 v15, s65, v15
    v_bfe_u32 v16, v1, 2, 2
    v_mul_u32_u24 v16, 576, v16
    v_lshl_add_u32 v16, v31, 5, v16
    v_and_b32 v7, 3, v1
    v_lshl_add_u32 v16, v7, 3, v16
    s_lshl_b32 s66, s3, 7
    s_add_u32 s66, s66, 18304
    v_add_u32 v16, s66, v16
    s_mul_i32 s69, s3, 163840
    s_lshl_b32 s66, s79, 7
    s_add_u32 s69, s69, s66
    s_add_u32 s69, s69, 33554432
    s_mul_i32 s68, s79, 4096
    s_lshl_b32 s66, s3, 10
    s_add_u32 s68, s68, s66
    s_add_u32 s68, s68, 25165824
    s_mov_b32 s27, 0x07060302
    v_mov_b32 v18, 0xffff
    v_mov_b32 v20, 0
    v_mov_b32 v21, 0
    v_mov_b32 v22, 0
    v_mov_b32 v23, 0
    v_add_u32 v7, s63, v10
    v_add_u32 v19, s64, v10
    s_mov_b64 exec, 0x3fffffff
    ds_write_b128 v7, v[20:23] offset:4096
    s_mov_b64 exec, 3
    ds_write_b128 v19, v[20:23]
    ds_write_b128 v19, v[20:23] offset:4160
    s_mov_b64 exec, -1
    v_lshl_add_u32 v30, v31, 3, v30
    v_sub_u32 v30, 15, v30
    v_and_b32 v31, 1, v30
    v_lshlrev_b32 v29, 4, v31
    v_ashrrev_i32 v28, 1, v30
    s_mov_b32 s44, s28
    s_and_b32 s45, s29, 0xffff
    s_mov_b32 s46, 268435456
    s_mov_b32 s47, 0x20000
    s_mov_b32 s26, 0xffff0000
    s_lshr_b32 s31, s97, 1
    s_add_u32 s31, s31, 2
    s_and_b32 s31, s31, 3
    s_add_u32 s30, s96, 3
    s_sub_u32 s30, s30, s31
    s_mul_i32 s30, s30, 21846
    s_lshr_b32 s30, s30, 16
    s_add_u32 s30, s30, s96
    s_lshl2_add_u32 s31, s96, s31
    s_sub_u32 s31, s31, 80
    s_min_u32 s31, s31, 26
    s_cmp_lt_u32 s96, 20
    s_cselect_b32 s31, s30, s31
    s_lshr_b32 s30, s97, 1
    s_mul_i32 s30, s30, 27
    s_add_u32 s30, s30, s31
    s_lshr_b32 s78, s30, 2
    s_and_b32 s77, s30, 3
    s_and_b32 s30, s97, 1
    s_lshl_b32 s30, s30, 2
    s_add_u32 s77, s77, s30
    v_lshrrev_b32 v30, 3, v1
    v_mul_u32_u24 v248, 3456, v30
    v_and_b32 v30, 2, v30
    v_and_b32 v31, 7, v1
    v_xor_b32 v30, v30, v31
    v_xor_b32 v31, 4, v30
    v_lshl_add_u32 v249, v31, 4, v248
    v_lshl_add_u32 v248, v30, 4, v248
    s_and_b32 s30, s3, 1
    s_mul_i32 s70, s30, 276480
    s_lshl_b32 s30, s78, 7
    s_add_u32 s70, s70, s30
    s_mul_i32 s71, s3, 10240
    s_cmp_ge_u32 s3, 2
    s_cselect_b32 s40, s20, s18
    s_cselect_b32 s41, s21, s19
    s_and_b32 s41, s41, 0xffff
    s_mov_b32 s42, 2211840
    s_mov_b32 s43, 0x20000
    v_lshrrev_b32 v30, 4, v1
    v_bfe_u32 v31, v1, 2, 2
    v_lshl_add_u32 v250, v30, 3, v31
    v_lshlrev_b32 v250, 7, v250
    v_bfe_u32 v30, v1, 3, 2
    v_xor_b32 v30, s3, v30
    v_lshl_add_u32 v250, v30, 5, v250
    v_and_b32 v30, 3, v1
    v_lshl_add_u32 v250, v30, 3, v250
    s_lshr_b32 s76, s97, 1
    s_lshl_b32 s76, s76, 3
    s_lshr_b32 s30, s96, 2
    s_add_u32 s76, s76, s30
    s_and_b32 s75, s97, 1
    s_lshl_b32 s75, s75, 2
    s_and_b32 s30, s96, 3
    s_add_u32 s75, s75, s30
    s_mul_i32 s74, s3, 14
    s_cmp_eq_u32 s3, 3
    s_cselect_b32 s74, 41, s74
    s_mul_i32 s72, s75, 276480
    s_mul_i32 s30, s74, 5120
    s_add_u32 s72, s72, s30
    s_add_u32 s72, s72, 20971520
    s_mul_i32 s73, s76, 55296
    s_lshl_b32 s30, s74, 10
    s_add_u32 s73, s73, s30
    s_add_u32 s73, s73, 12582912
    s_waitcnt lgkmcnt(0)
    s_mul_i32 s100, s100, 0x41c64e6d
    s_add_u32 s100, s100, 12345
    s_and_b32 s99, s100, 0x1fff
    s_or_b32 s99, s99, 0x4000
    s_lshl_b32 s98, s99, 16
    v_mov_b32 v11, s100
    s_mov_b32 s4, s100
    s_mov_b32 s5, s100
    s_waitcnt vmcnt(4)
    s_barrier
    ds_read_b128 v[124:127], v254 offset:0
    ds_read_b128 v[128:131], v254 offset:16
    ds_read_b64 v[100:101], v4 offset:0
    ds_read_b64 v[102:103], v4 offset:128
    ds_read_b64 v[104:105], v4 offset:256
    ds_read_b64 v[106:107], v4 offset:384
    ds_read_b64 v[108:109], v9 offset:0
    ds_read_b64 v[110:111], v9 offset:128
    ds_read_b64 v[112:113], v9 offset:256
    ds_read_b64 v[114:115], v4 offset:10368
    ds_read_b64 v[116:117], v4 offset:10496
    ds_read_b64 v[118:119], v4 offset:10624
    ds_read_b64 v[120:121], v4 offset:10752
    s_waitcnt lgkmcnt(11)
    v_lshlrev_b32 v228, 16, v124
    v_and_b32 v232, s26, v124
    v_lshlrev_b32 v236, 16, v125
    v_and_b32 v240, s26, v125
    v_lshlrev_b32 v229, 16, v126
    v_and_b32 v233, s26, v126
    v_lshlrev_b32 v237, 16, v127
    v_and_b32 v241, s26, v127
    v_lshlrev_b32 v230, 16, v128
    v_and_b32 v234, s26, v128
    v_lshlrev_b32 v238, 16, v129
    v_and_b32 v242, s26, v129
    v_lshlrev_b32 v231, 16, v130
    v_and_b32 v235, s26, v130
    v_lshlrev_b32 v239, 16, v131
    v_and_b32 v243, s26, v131
    s_waitcnt lgkmcnt(4)
    v_lshlrev_b32 v148, 16, v100
    v_and_b32 v149, s26, v100
    v_lshlrev_b32 v150, 16, v102
    v_and_b32 v151, s26, v102
    v_lshlrev_b32 v152, 16, v104
    v_and_b32 v153, s26, v104
    v_lshlrev_b32 v154, 16, v106
    v_and_b32 v155, s26, v106
    v_lshlrev_b32 v156, 16, v108
    v_and_b32 v157, s26, v108
    v_lshlrev_b32 v158, 16, v110
    v_and_b32 v159, s26, v110
    v_lshlrev_b32 v160, 16, v112
    v_and_b32 v161, s26, v112
.p2align 3
    v_pk_mul_f32 v[162:163], v[148:149], v[240:241]
    v_pk_mul_f32 v[164:165], v[150:151], v[240:241]
    v_pk_mul_f32 v[166:167], v[152:153], v[240:241]
    v_pk_mul_f32 v[168:169], v[154:155], v[240:241]
    v_pk_fma_f32 v[162:163], v[150:151], v[236:237], v[162:163]
    v_pk_fma_f32 v[164:165], v[152:153], v[236:237], v[164:165]
    v_pk_fma_f32 v[166:167], v[154:155], v[236:237], v[166:167]
    v_pk_fma_f32 v[168:169], v[156:157], v[236:237], v[168:169]
    v_pk_fma_f32 v[162:163], v[152:153], v[232:233], v[162:163]
    v_pk_fma_f32 v[164:165], v[154:155], v[232:233], v[164:165]
    v_pk_fma_f32 v[166:167], v[156:157], v[232:233], v[166:167]
    v_pk_fma_f32 v[168:169], v[158:159], v[232:233], v[168:169]
    v_pk_fma_f32 v[162:163], v[154:155], v[228:229], v[162:163]
    v_pk_fma_f32 v[164:165], v[156:157], v[228:229], v[164:165]
    v_pk_fma_f32 v[166:167], v[158:159], v[228:229], v[166:167]
    v_pk_fma_f32 v[168:169], v[160:161], v[228:229], v[168:169]
    s_waitcnt lgkmcnt(0)
    v_lshlrev_b32 v148, 16, v114
    v_and_b32 v149, s26, v114
    v_lshlrev_b32 v150, 16, v116
    v_and_b32 v151, s26, v116
    v_lshlrev_b32 v152, 16, v118
    v_and_b32 v153, s26, v118
    v_lshlrev_b32 v154, 16, v120
    v_and_b32 v155, s26, v120
.p2align 3
    v_pk_mul_f32 v[162:163], v[162:163], v[148:149]
    v_pk_mul_f32 v[164:165], v[164:165], v[150:151]
    v_pk_mul_f32 v[166:167], v[166:167], v[152:153]
    v_pk_mul_f32 v[168:169], v[168:169], v[154:155]
    v_cvt_pk_bf16_f32 v172, s98, v162
    v_cvt_pk_bf16_f32 v173, s98, v164
    v_cvt_pk_bf16_f32 v174, s98, v166
    v_cvt_pk_bf16_f32 v175, s98, v168
    buffer_store_dwordx4 v[172:175], v2, s[44:47], s48 offen offset:0 sc1
    v_cvt_pk_bf16_f32 v176, s98, v163
    v_cvt_pk_bf16_f32 v177, s98, v165
    v_cvt_pk_bf16_f32 v178, s98, v167
    v_cvt_pk_bf16_f32 v179, s98, v169
    buffer_store_dwordx4 v[176:179], v2, s[44:47], s48 offen offset:1024 sc1
    v_lshlrev_b32 v148, 16, v101
    v_and_b32 v149, s26, v101
    v_lshlrev_b32 v150, 16, v103
    v_and_b32 v151, s26, v103
    v_lshlrev_b32 v152, 16, v105
    v_and_b32 v153, s26, v105
    v_lshlrev_b32 v154, 16, v107
    v_and_b32 v155, s26, v107
    v_lshlrev_b32 v156, 16, v109
    v_and_b32 v157, s26, v109
    v_lshlrev_b32 v158, 16, v111
    v_and_b32 v159, s26, v111
    v_lshlrev_b32 v160, 16, v113
    v_and_b32 v161, s26, v113
.p2align 3
    v_pk_mul_f32 v[162:163], v[148:149], v[242:243]
    v_pk_mul_f32 v[164:165], v[150:151], v[242:243]
    v_pk_mul_f32 v[166:167], v[152:153], v[242:243]
    v_pk_mul_f32 v[168:169], v[154:155], v[242:243]
    v_pk_fma_f32 v[162:163], v[150:151], v[238:239], v[162:163]
    v_pk_fma_f32 v[164:165], v[152:153], v[238:239], v[164:165]
    v_pk_fma_f32 v[166:167], v[154:155], v[238:239], v[166:167]
    v_pk_fma_f32 v[168:169], v[156:157], v[238:239], v[168:169]
    v_pk_fma_f32 v[162:163], v[152:153], v[234:235], v[162:163]
    v_pk_fma_f32 v[164:165], v[154:155], v[234:235], v[164:165]
    v_pk_fma_f32 v[166:167], v[156:157], v[234:235], v[166:167]
    v_pk_fma_f32 v[168:169], v[158:159], v[234:235], v[168:169]
    v_pk_fma_f32 v[162:163], v[154:155], v[230:231], v[162:163]
    v_pk_fma_f32 v[164:165], v[156:157], v[230:231], v[164:165]
    v_pk_fma_f32 v[166:167], v[158:159], v[230:231], v[166:167]
    v_pk_fma_f32 v[168:169], v[160:161], v[230:231], v[168:169]
    v_lshlrev_b32 v148, 16, v115
    v_and_b32 v149, s26, v115
    v_lshlrev_b32 v150, 16, v117
    v_and_b32 v151, s26, v117
    v_lshlrev_b32 v152, 16, v119
    v_and_b32 v153, s26, v119
    v_lshlrev_b32 v154, 16, v121
    v_and_b32 v155, s26, v121
.p2align 3
    v_pk_mul_f32 v[162:163], v[162:163], v[148:149]
    v_pk_mul_f32 v[164:165], v[164:165], v[150:151]
    v_pk_mul_f32 v[166:167], v[166:167], v[152:153]
    v_pk_mul_f32 v[168:169], v[168:169], v[154:155]
    v_cvt_pk_bf16_f32 v180, s98, v162
    v_cvt_pk_bf16_f32 v181, s98, v164
    v_cvt_pk_bf16_f32 v182, s98, v166
    v_cvt_pk_bf16_f32 v183, s98, v168
    buffer_store_dwordx4 v[180:183], v2, s[44:47], s48 offen offset:2048 sc1
    v_cvt_pk_bf16_f32 v184, s98, v163
    v_cvt_pk_bf16_f32 v185, s98, v165
    v_cvt_pk_bf16_f32 v186, s98, v167
    v_cvt_pk_bf16_f32 v187, s98, v169
    buffer_store_dwordx4 v[184:187], v2, s[44:47], s48 offen offset:3072 sc1
    s_add_u32 m0, s62, 19584
    s_add_u32 s30, s61, 1310720
    buffer_load_dwordx4 v5, s[32:35], s30 offen nt lds
    s_add_u32 m0, s62, 29952
    s_add_u32 s30, s60, 1310720
    buffer_load_dwordx4 v5, s[36:39], s30 offen nt lds
    s_add_u32 m0, s62, 24192
    s_add_u32 s30, s61, 1351680
    buffer_load_dwordx4 v5, s[32:35], s30 offen nt lds
    s_add_u32 m0, s62, 34560
    s_add_u32 s30, s60, 1351680
    buffer_load_dwordx4 v5, s[36:39], s30 offen nt lds
    s_mov_b32 m0, 151680
    s_add_u32 s30, s57, 1310720
    buffer_load_dwordx4 v6, s[32:35], s30 offen nt lds
    s_waitcnt vmcnt(9)
    ds_read_b128 v[60:63], v19 offset:4192
    ds_read_b32 v76, v19 offset:4188
    ds_read_b128 v[64:67], v19 offset:5216
    ds_read_b32 v77, v19 offset:5212
    ds_read_b128 v[68:71], v19 offset:6240
    ds_read_b32 v78, v19 offset:6236
    ds_read_b128 v[72:75], v19 offset:7264
    ds_read_b32 v79, v19 offset:7260
    s_waitcnt lgkmcnt(6)
    v_alignbit_b32 v80, v60, v76, 16
    v_alignbit_b32 v81, v61, v60, 16
    v_alignbit_b32 v82, v62, v61, 16
    v_alignbit_b32 v83, v63, v62, 16
    ds_write_b128 v19, v[80:83] offset:32
    s_waitcnt lgkmcnt(5)
    v_alignbit_b32 v84, v64, v77, 16
    v_alignbit_b32 v85, v65, v64, 16
    v_alignbit_b32 v86, v66, v65, 16
    v_alignbit_b32 v87, v67, v66, 16
    ds_write_b128 v19, v[84:87] offset:1056
    s_waitcnt lgkmcnt(4)
    v_alignbit_b32 v88, v68, v78, 16
    v_alignbit_b32 v89, v69, v68, 16
    v_alignbit_b32 v90, v70, v69, 16
    v_alignbit_b32 v91, v71, v70, 16
    ds_write_b128 v19, v[88:91] offset:2080
    s_waitcnt lgkmcnt(3)
    v_alignbit_b32 v92, v72, v79, 16
    v_alignbit_b32 v93, v73, v72, 16
    v_alignbit_b32 v94, v74, v73, 16
    v_alignbit_b32 v95, v75, v74, 16
    ds_write_b128 v19, v[92:95] offset:3104
    ds_read2_b32 a[224:225], v14 offset0:0 offset1:1
    ds_read2_b32 a[226:227], v14 offset0:2 offset1:3
    ds_read2_b32 a[228:229], v14 offset0:16 offset1:17
    ds_read2_b32 a[230:231], v14 offset0:18 offset1:19
    ds_read2_b32 a[232:233], v14 offset0:32 offset1:33
    ds_read2_b32 a[234:235], v14 offset0:34 offset1:35
    ds_read2_b32 a[236:237], v14 offset0:48 offset1:49
    ds_read2_b32 a[238:239], v14 offset0:50 offset1:51
    ds_read2_b32 a[240:241], v14 offset0:64 offset1:65
    ds_read2_b32 a[242:243], v14 offset0:66 offset1:67
    ds_read2_b32 a[244:245], v14 offset0:80 offset1:81
    ds_read2_b32 a[246:247], v14 offset0:82 offset1:83
    ds_read2_b32 a[248:249], v14 offset0:96 offset1:97
    ds_read2_b32 a[250:251], v14 offset0:98 offset1:99
    s_lshl_b32 s30, s3, 4
    s_lshr_b64 s[58:59], s[58:59], s30
    s_and_b32 s58, s58, 0xffff
    v_lshlrev_b32 v29, v29, s58
    v_cmp_eq_u32 vcc, 0, v28
    s_nop 1
    v_cndmask_b32 v24, 0, v29, vcc
    v_cmp_eq_u32 vcc, 1, v28
    s_nop 1
    v_cndmask_b32 v25, 0, v29, vcc
    v_cmp_eq_u32 vcc, 2, v28
    s_nop 1
    v_cndmask_b32 v26, 0, v29, vcc
    v_cmp_eq_u32 vcc, 3, v28
    s_nop 1
    v_cndmask_b32 v27, 0, v29, vcc
    ds_read2_b32 a[252:253], v14 offset0:112 offset1:113
    ds_read2_b32 a[254:255], v14 offset0:114 offset1:115
    ds_read2_b32 a[96:97], v14 offset0:128 offset1:129
    ds_read2_b32 a[98:99], v14 offset0:130 offset1:131
    ds_read2_b32 a[100:101], v14 offset0:144 offset1:145
    ds_read2_b32 a[102:103], v14 offset0:146 offset1:147
    ds_read2_b32 a[104:105], v14 offset0:160 offset1:161
    ds_read2_b32 a[106:107], v14 offset0:162 offset1:163
    ds_read2_b32 a[108:109], v14 offset0:176 offset1:177
    ds_read2_b32 a[110:111], v14 offset0:178 offset1:179
    ds_read2_b32 a[112:113], v14 offset0:192 offset1:193
    ds_read2_b32 a[114:115], v14 offset0:194 offset1:195
    ds_read2_b32 a[116:117], v14 offset0:208 offset1:209
    ds_read2_b32 a[118:119], v14 offset0:210 offset1:211
    ds_read2_b32 a[120:121], v14 offset0:224 offset1:225
    ds_read2_b32 a[122:123], v14 offset0:226 offset1:227
    ds_read2_b32 a[124:125], v14 offset0:240 offset1:241
    ds_read2_b32 a[126:127], v14 offset0:242 offset1:243
    v_add_u32 v14, 1024, v14
    ds_read2_b32 a[64:65], v14 offset0:0 offset1:1
    ds_read2_b32 a[66:67], v14 offset0:2 offset1:3
    ds_read2_b32 a[68:69], v14 offset0:16 offset1:17
    ds_read2_b32 a[70:71], v14 offset0:18 offset1:19
    ds_read2_b32 a[72:73], v14 offset0:32 offset1:33
    ds_read2_b32 a[74:75], v14 offset0:34 offset1:35
    ds_read2_b32 a[76:77], v14 offset0:48 offset1:49
    ds_read2_b32 a[78:79], v14 offset0:50 offset1:51
    ds_read2_b32 a[80:81], v14 offset0:64 offset1:65
    ds_read2_b32 a[82:83], v14 offset0:66 offset1:67
    ds_read2_b32 a[84:85], v14 offset0:80 offset1:81
    ds_read2_b32 a[86:87], v14 offset0:82 offset1:83
    ds_read2_b32 a[88:89], v14 offset0:96 offset1:97
    ds_read2_b32 a[90:91], v14 offset0:98 offset1:99
    ds_read2_b32 a[92:93], v14 offset0:112 offset1:113
    ds_read2_b32 a[94:95], v14 offset0:114 offset1:115
    ds_read2_b32 a[32:33], v14 offset0:128 offset1:129
    ds_read2_b32 a[34:35], v14 offset0:130 offset1:131
    ds_read2_b32 a[36:37], v14 offset0:144 offset1:145
    ds_read2_b32 a[38:39], v14 offset0:146 offset1:147
    ds_read2_b32 a[40:41], v14 offset0:160 offset1:161
    ds_read2_b32 a[42:43], v14 offset0:162 offset1:163
    ds_read2_b32 a[44:45], v14 offset0:176 offset1:177
    ds_read2_b32 a[46:47], v14 offset0:178 offset1:179
    ds_read2_b32 a[48:49], v14 offset0:192 offset1:193
    ds_read2_b32 a[50:51], v14 offset0:194 offset1:195
    ds_read2_b32 a[52:53], v14 offset0:208 offset1:209
    ds_read2_b32 a[54:55], v14 offset0:210 offset1:211
    ds_read2_b32 a[56:57], v14 offset0:224 offset1:225
    ds_read2_b32 a[58:59], v14 offset0:226 offset1:227
    ds_read2_b32 a[60:61], v14 offset0:240 offset1:241
    ds_read2_b32 a[62:63], v14 offset0:242 offset1:243
    v_add_u32 v14, 1024, v14
    ds_read2_b32 a[0:1], v14 offset0:0 offset1:1
    ds_read2_b32 a[2:3], v14 offset0:2 offset1:3
    ds_read2_b32 a[4:5], v14 offset0:16 offset1:17
    ds_read2_b32 a[6:7], v14 offset0:18 offset1:19
    ds_read2_b32 a[8:9], v14 offset0:32 offset1:33
    ds_read2_b32 a[10:11], v14 offset0:34 offset1:35
    ds_read2_b32 a[12:13], v14 offset0:48 offset1:49
    ds_read2_b32 a[14:15], v14 offset0:50 offset1:51
    ds_read2_b32 a[16:17], v14 offset0:64 offset1:65
    ds_read2_b32 a[18:19], v14 offset0:66 offset1:67
    ds_read2_b32 a[20:21], v14 offset0:80 offset1:81
    ds_read2_b32 a[22:23], v14 offset0:82 offset1:83
    ds_read2_b32 a[24:25], v14 offset0:96 offset1:97
    ds_read2_b32 a[26:27], v14 offset0:98 offset1:99
    ds_read2_b32 a[28:29], v14 offset0:112 offset1:113
    ds_read2_b32 a[30:31], v14 offset0:114 offset1:115
    ds_read2_b32 a[192:193], v14 offset0:128 offset1:129
    ds_read2_b32 a[194:195], v14 offset0:130 offset1:131
    ds_read2_b32 a[196:197], v14 offset0:144 offset1:145
    ds_read2_b32 a[198:199], v14 offset0:146 offset1:147
    ds_read2_b32 a[200:201], v14 offset0:160 offset1:161
    ds_read2_b32 a[202:203], v14 offset0:162 offset1:163
    ds_read2_b32 a[204:205], v14 offset0:176 offset1:177
    ds_read2_b32 a[206:207], v14 offset0:178 offset1:179
    ds_read2_b32 a[208:209], v14 offset0:192 offset1:193
    ds_read2_b32 a[210:211], v14 offset0:194 offset1:195
    ds_read2_b32 a[212:213], v14 offset0:208 offset1:209
    ds_read2_b32 a[214:215], v14 offset0:210 offset1:211
    ds_read2_b32 a[216:217], v14 offset0:224 offset1:225
    ds_read2_b32 a[218:219], v14 offset0:226 offset1:227
    ds_read2_b32 a[220:221], v14 offset0:240 offset1:241
    ds_read2_b32 a[222:223], v14 offset0:242 offset1:243
    v_add_u32 v14, 1024, v14
    ds_read2_b32 a[160:161], v14 offset0:0 offset1:1
    ds_read2_b32 a[162:163], v14 offset0:2 offset1:3
    ds_read2_b32 a[164:165], v14 offset0:16 offset1:17
    ds_read2_b32 a[166:167], v14 offset0:18 offset1:19
    ds_read2_b32 a[168:169], v14 offset0:32 offset1:33
    ds_read2_b32 a[170:171], v14 offset0:34 offset1:35
    ds_read2_b32 a[172:173], v14 offset0:48 offset1:49
    ds_read2_b32 a[174:175], v14 offset0:50 offset1:51
    ds_read2_b32 a[176:177], v14 offset0:64 offset1:65
    ds_read2_b32 a[178:179], v14 offset0:66 offset1:67
    ds_read2_b32 a[180:181], v14 offset0:80 offset1:81
    ds_read2_b32 a[182:183], v14 offset0:82 offset1:83
    ds_read2_b32 a[184:185], v14 offset0:96 offset1:97
    ds_read2_b32 a[186:187], v14 offset0:98 offset1:99
    ds_read2_b32 a[188:189], v14 offset0:112 offset1:113
    ds_read2_b32 a[190:191], v14 offset0:114 offset1:115
    s_waitcnt vmcnt(0)
    s_barrier
    ds_read_b64 v[100:101], v4 offset:19584
    ds_read_b64 v[102:103], v4 offset:19712
    ds_read_b64 v[104:105], v4 offset:19840
    ds_read_b64 v[106:107], v4 offset:19968
    ds_read_b64 v[108:109], v9 offset:19584
    ds_read_b64 v[110:111], v9 offset:19712
    ds_read_b64 v[112:113], v9 offset:19840
    ds_read_b64 v[114:115], v4 offset:29952
    ds_read_b64 v[116:117], v4 offset:30080
    ds_read_b64 v[118:119], v4 offset:30208
    ds_read_b64 v[120:121], v4 offset:30336
    s_add_u32 s30, s68, 0
    buffer_load_dwordx4 v[188:191], v10, s[44:47], s30 offen sc1
    s_add_u32 s30, s68, 655360
    buffer_load_dwordx4 v[192:195], v10, s[44:47], s30 offen sc1
    s_add_u32 s30, s68, 1310720
    buffer_load_dwordx4 v[196:199], v10, s[44:47], s30 offen sc1
    s_add_u32 s30, s68, 1966080
    buffer_load_dwordx4 v[200:203], v10, s[44:47], s30 offen sc1
    s_waitcnt lgkmcnt(4)
    v_lshlrev_b32 v148, 16, v100
    v_and_b32 v149, s26, v100
    v_lshlrev_b32 v150, 16, v102
    v_and_b32 v151, s26, v102
    v_lshlrev_b32 v152, 16, v104
    v_and_b32 v153, s26, v104
    v_lshlrev_b32 v154, 16, v106
    v_and_b32 v155, s26, v106
    v_lshlrev_b32 v156, 16, v108
    v_and_b32 v157, s26, v108
    v_lshlrev_b32 v158, 16, v110
    v_and_b32 v159, s26, v110
    v_lshlrev_b32 v160, 16, v112
    v_and_b32 v161, s26, v112
    ds_read2_b32 a[128:129], v14 offset0:128 offset1:129
    ds_read2_b32 a[130:131], v14 offset0:130 offset1:131
    ds_read2_b32 a[132:133], v14 offset0:144 offset1:145
    ds_read2_b32 a[134:135], v14 offset0:146 offset1:147
.p2align 3
    v_pk_mul_f32 v[162:163], v[148:149], v[240:241]
    v_pk_mul_f32 v[164:165], v[150:151], v[240:241]
    v_pk_mul_f32 v[166:167], v[152:153], v[240:241]
    v_pk_mul_f32 v[168:169], v[154:155], v[240:241]
    v_pk_fma_f32 v[162:163], v[150:151], v[236:237], v[162:163]
    v_pk_fma_f32 v[164:165], v[152:153], v[236:237], v[164:165]
    v_pk_fma_f32 v[166:167], v[154:155], v[236:237], v[166:167]
    v_pk_fma_f32 v[168:169], v[156:157], v[236:237], v[168:169]
    v_pk_fma_f32 v[162:163], v[152:153], v[232:233], v[162:163]
    v_pk_fma_f32 v[164:165], v[154:155], v[232:233], v[164:165]
    v_pk_fma_f32 v[166:167], v[156:157], v[232:233], v[166:167]
    v_pk_fma_f32 v[168:169], v[158:159], v[232:233], v[168:169]
    v_pk_fma_f32 v[162:163], v[154:155], v[228:229], v[162:163]
    v_pk_fma_f32 v[164:165], v[156:157], v[228:229], v[164:165]
    v_pk_fma_f32 v[166:167], v[158:159], v[228:229], v[166:167]
    v_pk_fma_f32 v[168:169], v[160:161], v[228:229], v[168:169]
    ds_read2_b32 a[136:137], v14 offset0:160 offset1:161
    ds_read2_b32 a[138:139], v14 offset0:162 offset1:163
    s_waitcnt lgkmcnt(6)
    v_lshlrev_b32 v148, 16, v114
    v_and_b32 v149, s26, v114
    v_lshlrev_b32 v150, 16, v116
    v_and_b32 v151, s26, v116
    v_lshlrev_b32 v152, 16, v118
    v_and_b32 v153, s26, v118
    v_lshlrev_b32 v154, 16, v120
    v_and_b32 v155, s26, v120
.p2align 3
    v_pk_mul_f32 v[162:163], v[162:163], v[148:149]
    v_pk_mul_f32 v[164:165], v[164:165], v[150:151]
    v_pk_mul_f32 v[166:167], v[166:167], v[152:153]
    v_pk_mul_f32 v[168:169], v[168:169], v[154:155]
    ds_read2_b32 a[140:141], v14 offset0:176 offset1:177
    ds_read2_b32 a[142:143], v14 offset0:178 offset1:179
    v_cvt_pk_bf16_f32 v172, s98, v162
    v_cvt_pk_bf16_f32 v173, s98, v164
    v_cvt_pk_bf16_f32 v174, s98, v166
    v_cvt_pk_bf16_f32 v175, s98, v168
    buffer_store_dwordx4 v[172:175], v2, s[44:47], s49 offen offset:0 sc1
    v_cvt_pk_bf16_f32 v176, s98, v163
    v_cvt_pk_bf16_f32 v177, s98, v165
    v_cvt_pk_bf16_f32 v178, s98, v167
    v_cvt_pk_bf16_f32 v179, s98, v169
    buffer_store_dwordx4 v[176:179], v2, s[44:47], s49 offen offset:1024 sc1
    ds_read2_b32 a[144:145], v14 offset0:192 offset1:193
    ds_read2_b32 a[146:147], v14 offset0:194 offset1:195
    v_lshlrev_b32 v148, 16, v101
    v_and_b32 v149, s26, v101
    v_lshlrev_b32 v150, 16, v103
    v_and_b32 v151, s26, v103
    v_lshlrev_b32 v152, 16, v105
    v_and_b32 v153, s26, v105
    v_lshlrev_b32 v154, 16, v107
    v_and_b32 v155, s26, v107
    v_lshlrev_b32 v156, 16, v109
    v_and_b32 v157, s26, v109
    v_lshlrev_b32 v158, 16, v111
    v_and_b32 v159, s26, v111
    v_lshlrev_b32 v160, 16, v113
    v_and_b32 v161, s26, v113
    ds_read2_b32 a[148:149], v14 offset0:208 offset1:209
    ds_read2_b32 a[150:151], v14 offset0:210 offset1:211
.p2align 3
    v_pk_mul_f32 v[162:163], v[148:149], v[242:243]
    v_pk_mul_f32 v[164:165], v[150:151], v[242:243]
    v_pk_mul_f32 v[166:167], v[152:153], v[242:243]
    v_pk_mul_f32 v[168:169], v[154:155], v[242:243]
    v_pk_fma_f32 v[162:163], v[150:151], v[238:239], v[162:163]
    v_pk_fma_f32 v[164:165], v[152:153], v[238:239], v[164:165]
    v_pk_fma_f32 v[166:167], v[154:155], v[238:239], v[166:167]
    v_pk_fma_f32 v[168:169], v[156:157], v[238:239], v[168:169]
    v_pk_fma_f32 v[162:163], v[152:153], v[234:235], v[162:163]
    v_pk_fma_f32 v[164:165], v[154:155], v[234:235], v[164:165]
    v_pk_fma_f32 v[166:167], v[156:157], v[234:235], v[166:167]
    v_pk_fma_f32 v[168:169], v[158:159], v[234:235], v[168:169]
    v_pk_fma_f32 v[162:163], v[154:155], v[230:231], v[162:163]
    v_pk_fma_f32 v[164:165], v[156:157], v[230:231], v[164:165]
    v_pk_fma_f32 v[166:167], v[158:159], v[230:231], v[166:167]
    v_pk_fma_f32 v[168:169], v[160:161], v[230:231], v[168:169]
    ds_read2_b32 a[152:153], v14 offset0:224 offset1:225
    ds_read2_b32 a[154:155], v14 offset0:226 offset1:227
    v_lshlrev_b32 v148, 16, v115
    v_and_b32 v149, s26, v115
    v_lshlrev_b32 v150, 16, v117
    v_and_b32 v151, s26, v117
    v_lshlrev_b32 v152, 16, v119
    v_and_b32 v153, s26, v119
    v_lshlrev_b32 v154, 16, v121
    v_and_b32 v155, s26, v121
.p2align 3
    v_pk_mul_f32 v[162:163], v[162:163], v[148:149]
    v_pk_mul_f32 v[164:165], v[164:165], v[150:151]
    v_pk_mul_f32 v[166:167], v[166:167], v[152:153]
    v_pk_mul_f32 v[168:169], v[168:169], v[154:155]
    ds_read2_b32 a[156:157], v14 offset0:240 offset1:241
    ds_read2_b32 a[158:159], v14 offset0:242 offset1:243
    v_cvt_pk_bf16_f32 v180, s98, v162
    v_cvt_pk_bf16_f32 v181, s98, v164
    v_cvt_pk_bf16_f32 v182, s98, v166
    v_cvt_pk_bf16_f32 v183, s98, v168
    buffer_store_dwordx4 v[180:183], v2, s[44:47], s49 offen offset:2048 sc1
    v_cvt_pk_bf16_f32 v184, s98, v163
    v_cvt_pk_bf16_f32 v185, s98, v165
    v_cvt_pk_bf16_f32 v186, s98, v167
    v_cvt_pk_bf16_f32 v187, s98, v169
    buffer_store_dwordx4 v[184:187], v2, s[44:47], s49 offen offset:3072 sc1
    s_waitcnt vmcnt(7)
    v_xor_b32 v20, s99, v188
    v_bitop3_b32 v20, v189, s99, v20 bitop3:0xbe
    v_bitop3_b32 v20, v190, s99, v20 bitop3:0xbe
    v_bitop3_b32 v20, v191, s99, v20 bitop3:0xbe
    v_cmp_ne_u16 vcc, 0, v20
    s_nop 0
    s_cbranch_vccnz L_cv0r
L_cv0b:
    v_perm_b32 v20, v190, v191, s27
    v_perm_b32 v21, v188, v189, s27
    ds_write_b64 v12, v[20:21] offset:3584
    ds_read_b128 v[60:63], v13 offset:3584
    ds_read_b128 v[64:67], v13 offset:3648
    ds_read_b128 v[68:71], v13 offset:3712
    ds_read_b128 v[72:75], v13 offset:3776
    ds_read_b128 v[76:79], v13 offset:3840
    ds_read_b128 v[80:83], v13 offset:3904
    ds_read_b128 v[84:87], v13 offset:3968
    ds_read_b128 v[88:91], v13 offset:4032
    s_waitcnt lgkmcnt(5)
    s_waitcnt vmcnt(6)
    v_xor_b32 v20, s99, v192
    v_mfma_f32_16x16x32_bf16 v[28:31], a[224:227], v[60:63], 0
    v_bitop3_b32 v20, v193, s99, v20 bitop3:0xbe
    v_bitop3_b32 v20, v194, s99, v20 bitop3:0xbe
    v_mfma_f32_16x16x32_bf16 v[28:31], a[228:231], v[64:67], v[28:31]
    v_bitop3_b32 v20, v195, s99, v20 bitop3:0xbe
    v_cmp_ne_u16 vcc, 0, v20
    v_mfma_f32_16x16x32_bf16 v[28:31], a[232:235], v[68:71], v[28:31]
    s_waitcnt lgkmcnt(2)
    s_cbranch_vccnz L_cv1r
L_cv1b:
    v_perm_b32 v20, v194, v195, s27
    v_mfma_f32_16x16x32_bf16 v[28:31], a[236:239], v[72:75], v[28:31]
    v_perm_b32 v21, v192, v193, s27
    v_mfma_f32_16x16x32_bf16 v[28:31], a[240:243], v[76:79], v[28:31]
    ds_write_b64 v12, v[20:21] offset:3072
    v_mfma_f32_16x16x32_bf16 v[28:31], a[244:247], v[80:83], v[28:31]
    s_waitcnt lgkmcnt(1)
    v_mfma_f32_16x16x32_bf16 v[28:31], a[248:251], v[84:87], v[28:31]
    ds_read_b128 v[92:95], v13 offset:3072
    v_mfma_f32_16x16x32_bf16 v[28:31], a[252:255], v[88:91], v[28:31]
    ds_read_b128 v[96:99], v13 offset:3136
    v_mfma_f32_16x16x32_bf16 v[28:31], v[24:27], v[60:63], v[28:31]
    ds_read_b128 v[100:103], v13 offset:3200
    v_mfma_f32_16x16x32_bf16 v[32:35], a[96:99], v[60:63], 0
    ds_read_b128 v[104:107], v13 offset:3264
    v_mfma_f32_16x16x32_bf16 v[32:35], a[100:103], v[64:67], v[32:35]
    ds_read_b128 v[108:111], v13 offset:3328
    v_mfma_f32_16x16x32_bf16 v[32:35], a[104:107], v[68:71], v[32:35]
    ds_read_b128 v[112:115], v13 offset:3392
    s_nop 0
    v_cvt_pk_bf16_f32 v220, v28, v29
    v_mfma_f32_16x16x32_bf16 v[32:35], a[108:111], v[72:75], v[32:35]
    ds_read_b128 v[116:119], v13 offset:3456
    v_cvt_pk_bf16_f32 v221, v30, v31
    v_mfma_f32_16x16x32_bf16 v[32:35], a[112:115], v[76:79], v[32:35]
    ds_write_b64 v15, v[220:221] offset:0
    v_mfma_f32_16x16x32_bf16 v[32:35], a[116:119], v[80:83], v[32:35]
    ds_read_b128 v[120:123], v13 offset:3520
    s_waitcnt vmcnt(5)
    v_mfma_f32_16x16x32_bf16 v[32:35], a[120:123], v[84:87], v[32:35]
    v_xor_b32 v20, s99, v196
    v_bitop3_b32 v20, v197, s99, v20 bitop3:0xbe
    v_mfma_f32_16x16x32_bf16 v[32:35], a[124:127], v[88:91], v[32:35]
    v_bitop3_b32 v20, v198, s99, v20 bitop3:0xbe
    v_bitop3_b32 v20, v199, s99, v20 bitop3:0xbe
    v_mfma_f32_16x16x32_bf16 v[36:39], a[64:67], v[60:63], 0
    v_cmp_ne_u16 vcc, 0, v20
    s_nop 0
    s_cbranch_vccnz L_cv2r
L_cv2b:
    v_mfma_f32_16x16x32_bf16 v[36:39], a[68:71], v[64:67], v[36:39]
    v_perm_b32 v20, v198, v199, s27
    v_perm_b32 v21, v196, v197, s27
    v_mfma_f32_16x16x32_bf16 v[36:39], a[72:75], v[68:71], v[36:39]
    s_waitcnt lgkmcnt(1)
    s_barrier
    ds_read_b64_tr_b16 v[222:223], v16 offset:0
    v_mfma_f32_16x16x32_bf16 v[36:39], a[76:79], v[72:75], v[36:39]
    ds_write_b64 v12, v[20:21] offset:2560
    v_mfma_f32_16x16x32_bf16 v[36:39], a[80:83], v[76:79], v[36:39]
    v_mfma_f32_16x16x32_bf16 v[36:39], a[84:87], v[80:83], v[36:39]
    ds_read_b128 v[124:127], v13 offset:2560
    v_mfma_f32_16x16x32_bf16 v[36:39], a[88:91], v[84:87], v[36:39]
    ds_read_b128 v[128:131], v13 offset:2624
    v_mfma_f32_16x16x32_bf16 v[36:39], a[92:95], v[88:91], v[36:39]
    s_waitcnt lgkmcnt(4)
    ds_read_b128 v[132:135], v13 offset:2688
    v_mfma_f32_16x16x32_bf16 v[32:35], a[224:227], v[92:95], v[32:35]
    s_waitcnt lgkmcnt(4)
    ds_read_b128 v[136:139], v13 offset:2752
    v_lshl_or_b32 v224, v222, 16, s99
    v_mfma_f32_16x16x32_bf16 v[32:35], a[228:231], v[96:99], v[32:35]
    ds_read_b128 v[140:143], v13 offset:2816
    v_bfi_b32 v225, v18, s99, v222
    v_mfma_f32_16x16x32_bf16 v[32:35], a[232:235], v[100:103], v[32:35]
    ds_read_b128 v[144:147], v13 offset:2880
    v_lshl_or_b32 v226, v223, 16, s99
    v_mfma_f32_16x16x32_bf16 v[32:35], a[236:239], v[104:107], v[32:35]
    ds_read_b128 v[148:151], v13 offset:2944
    v_bfi_b32 v227, v18, s99, v223
    v_mfma_f32_16x16x32_bf16 v[32:35], a[240:243], v[108:111], v[32:35]
    buffer_store_dwordx4 v[224:227], v17, s[44:47], s69 offen sc1
    v_mfma_f32_16x16x32_bf16 v[32:35], a[244:247], v[112:115], v[32:35]
    s_add_u32 s69, s69, 655360
    ds_read_b128 v[152:155], v13 offset:3008
    v_mfma_f32_16x16x32_bf16 v[32:35], a[248:251], v[116:119], v[32:35]
    v_mfma_f32_16x16x32_bf16 v[32:35], a[252:255], v[120:123], v[32:35]
    v_mfma_f32_16x16x32_bf16 v[32:35], v[24:27], v[92:95], v[32:35]
    v_mfma_f32_16x16x32_bf16 v[36:39], a[96:99], v[92:95], v[36:39]
    s_nop 0
    v_mfma_f32_16x16x32_bf16 v[36:39], a[100:103], v[96:99], v[36:39]
    s_nop 2
    v_mfma_f32_16x16x32_bf16 v[36:39], a[104:107], v[100:103], v[36:39]
    s_nop 0
    v_cvt_pk_bf16_f32 v220, v32, v33
    v_cvt_pk_bf16_f32 v221, v34, v35
    v_mfma_f32_16x16x32_bf16 v[36:39], a[108:111], v[104:107], v[36:39]
    ds_write_b64 v15, v[220:221] offset:2304
    v_mfma_f32_16x16x32_bf16 v[36:39], a[112:115], v[108:111], v[36:39]
    v_mfma_f32_16x16x32_bf16 v[36:39], a[116:119], v[112:115], v[36:39]
    s_waitcnt vmcnt(5)
    v_xor_b32 v20, s99, v200
    v_bitop3_b32 v20, v201, s99, v20 bitop3:0xbe
    v_mfma_f32_16x16x32_bf16 v[36:39], a[120:123], v[116:119], v[36:39]
    v_bitop3_b32 v20, v202, s99, v20 bitop3:0xbe
    v_bitop3_b32 v20, v203, s99, v20 bitop3:0xbe
    v_mfma_f32_16x16x32_bf16 v[36:39], a[124:127], v[120:123], v[36:39]
    v_cmp_ne_u16 vcc, 0, v20
    s_nop 0
    s_cbranch_vccnz L_cv3r
L_cv3b:
    v_mfma_f32_16x16x32_bf16 v[40:43], a[32:35], v[60:63], 0
    v_perm_b32 v20, v202, v203, s27
    v_perm_b32 v21, v200, v201, s27
    v_mfma_f32_16x16x32_bf16 v[40:43], a[36:39], v[64:67], v[40:43]
    ds_write_b64 v12, v[20:21] offset:2048
    v_mfma_f32_16x16x32_bf16 v[40:43], a[40:43], v[68:71], v[40:43]
    s_waitcnt lgkmcnt(1)
    s_barrier
    ds_read_b64_tr_b16 v[222:223], v16 offset:2304
    v_mfma_f32_16x16x32_bf16 v[40:43], a[44:47], v[72:75], v[40:43]
    v_mfma_f32_16x16x32_bf16 v[40:43], a[48:51], v[76:79], v[40:43]
    v_mfma_f32_16x16x32_bf16 v[40:43], a[52:55], v[80:83], v[40:43]
    ds_read_b128 v[156:159], v13 offset:2048
    v_mfma_f32_16x16x32_bf16 v[40:43], a[56:59], v[84:87], v[40:43]
    ds_read_b128 v[160:163], v13 offset:2112
    v_mfma_f32_16x16x32_bf16 v[40:43], a[60:63], v[88:91], v[40:43]
    s_waitcnt lgkmcnt(5)
    ds_read_b128 v[164:167], v13 offset:2176
    v_mfma_f32_16x16x32_bf16 v[36:39], a[224:227], v[124:127], v[36:39]
    s_waitcnt lgkmcnt(3)
    ds_read_b128 v[168:171], v13 offset:2240
    v_lshl_or_b32 v224, v222, 16, s99
    v_mfma_f32_16x16x32_bf16 v[36:39], a[228:231], v[128:131], v[36:39]
    ds_read_b128 v[172:175], v13 offset:2304
    v_bfi_b32 v225, v18, s99, v222
    v_mfma_f32_16x16x32_bf16 v[36:39], a[232:235], v[132:135], v[36:39]
    ds_read_b128 v[176:179], v13 offset:2368
    v_lshl_or_b32 v226, v223, 16, s99
    v_mfma_f32_16x16x32_bf16 v[36:39], a[236:239], v[136:139], v[36:39]
    ds_read_b128 v[180:183], v13 offset:2432
    v_bfi_b32 v227, v18, s99, v223
    v_mfma_f32_16x16x32_bf16 v[36:39], a[240:243], v[140:143], v[36:39]
    buffer_store_dwordx4 v[224:227], v17, s[44:47], s69 offen sc1
    v_mfma_f32_16x16x32_bf16 v[36:39], a[244:247], v[144:147], v[36:39]
    s_add_u32 s69, s69, 655360
    ds_read_b128 v[184:187], v13 offset:2496
    v_mfma_f32_16x16x32_bf16 v[36:39], a[248:251], v[148:151], v[36:39]
    v_mfma_f32_16x16x32_bf16 v[36:39], a[252:255], v[152:155], v[36:39]
    v_mfma_f32_16x16x32_bf16 v[36:39], v[24:27], v[124:127], v[36:39]
    v_mfma_f32_16x16x32_bf16 v[40:43], a[64:67], v[92:95], v[40:43]
    s_nop 0
    v_mfma_f32_16x16x32_bf16 v[40:43], a[68:71], v[96:99], v[40:43]
    s_nop 2
    v_mfma_f32_16x16x32_bf16 v[40:43], a[72:75], v[100:103], v[40:43]
    s_nop 0
    v_cvt_pk_bf16_f32 v220, v36, v37
    v_cvt_pk_bf16_f32 v221, v38, v39
    v_mfma_f32_16x16x32_bf16 v[40:43], a[76:79], v[104:107], v[40:43]
    ds_write_b64 v15, v[220:221] offset:0
    v_mfma_f32_16x16x32_bf16 v[40:43], a[80:83], v[108:111], v[40:43]
    v_mfma_f32_16x16x32_bf16 v[40:43], a[84:87], v[112:115], v[40:43]
    v_mfma_f32_16x16x32_bf16 v[40:43], a[88:91], v[116:119], v[40:43]
    v_mfma_f32_16x16x32_bf16 v[40:43], a[92:95], v[120:123], v[40:43]
    v_mfma_f32_16x16x32_bf16 v[40:43], a[96:99], v[124:127], v[40:43]
    v_mfma_f32_16x16x32_bf16 v[40:43], a[100:103], v[128:131], v[40:43]
    v_mfma_f32_16x16x32_bf16 v[40:43], a[104:107], v[132:135], v[40:43]
    s_waitcnt lgkmcnt(0)
    s_barrier
    ds_read_b64_tr_b16 v[222:223], v16 offset:0
    v_mfma_f32_16x16x32_bf16 v[40:43], a[108:111], v[136:139], v[40:43]
    v_mfma_f32_16x16x32_bf16 v[40:43], a[112:115], v[140:143], v[40:43]
    v_mfma_f32_16x16x32_bf16 v[40:43], a[116:119], v[144:147], v[40:43]
    v_mfma_f32_16x16x32_bf16 v[40:43], a[120:123], v[148:151], v[40:43]
    v_mfma_f32_16x16x32_bf16 v[40:43], a[124:127], v[152:155], v[40:43]
    s_waitcnt lgkmcnt(2)
    v_mfma_f32_16x16x32_bf16 v[40:43], a[224:227], v[156:159], v[40:43]
    s_waitcnt lgkmcnt(0)
    v_lshl_or_b32 v224, v222, 16, s99
    v_bfi_b32 v225, v18, s99, v222
    v_mfma_f32_16x16x32_bf16 v[40:43], a[228:231], v[160:163], v[40:43]
    v_lshl_or_b32 v226, v223, 16, s99
    v_bfi_b32 v227, v18, s99, v223
    v_mfma_f32_16x16x32_bf16 v[40:43], a[232:235], v[164:167], v[40:43]
    buffer_store_dwordx4 v[224:227], v17, s[44:47], s69 offen sc1
    v_mfma_f32_16x16x32_bf16 v[40:43], a[236:239], v[168:171], v[40:43]
    s_add_u32 s69, s69, 655360
    v_mfma_f32_16x16x32_bf16 v[40:43], a[240:243], v[172:175], v[40:43]
    v_mfma_f32_16x16x32_bf16 v[40:43], a[244:247], v[176:179], v[40:43]
    v_mfma_f32_16x16x32_bf16 v[40:43], a[248:251], v[180:183], v[40:43]
    v_mfma_f32_16x16x32_bf16 v[40:43], a[252:255], v[184:187], v[40:43]
    v_mfma_f32_16x16x32_bf16 v[40:43], v[24:27], v[156:159], v[40:43]
    v_mfma_f32_16x16x32_bf16 v[44:47], a[0:3], v[60:63], 0
    s_nop 0
    v_mfma_f32_16x16x32_bf16 v[44:47], a[4:7], v[64:67], v[44:47]
    s_nop 2
    v_mfma_f32_16x16x32_bf16 v[44:47], a[8:11], v[68:71], v[44:47]
    s_nop 0
    v_cvt_pk_bf16_f32 v220, v40, v41
    v_cvt_pk_bf16_f32 v221, v42, v43
    v_mfma_f32_16x16x32_bf16 v[44:47], a[12:15], v[72:75], v[44:47]
    ds_write_b64 v15, v[220:221] offset:2304
    v_mfma_f32_16x16x32_bf16 v[44:47], a[16:19], v[76:79], v[44:47]
    v_mfma_f32_16x16x32_bf16 v[44:47], a[20:23], v[80:83], v[44:47]
    v_mfma_f32_16x16x32_bf16 v[44:47], a[24:27], v[84:87], v[44:47]
    v_mfma_f32_16x16x32_bf16 v[44:47], a[28:31], v[88:91], v[44:47]
    v_mfma_f32_16x16x32_bf16 v[48:51], a[192:195], v[60:63], 0
    v_mfma_f32_16x16x32_bf16 v[48:51], a[196:199], v[64:67], v[48:51]
    v_mfma_f32_16x16x32_bf16 v[48:51], a[200:203], v[68:71], v[48:51]
    v_mfma_f32_16x16x32_bf16 v[48:51], a[204:207], v[72:75], v[48:51]
    v_mfma_f32_16x16x32_bf16 v[48:51], a[208:211], v[76:79], v[48:51]
    v_mfma_f32_16x16x32_bf16 v[48:51], a[212:215], v[80:83], v[48:51]
    s_add_u32 m0, s71, 81920
    v_mfma_f32_16x16x32_bf16 v[48:51], a[216:219], v[84:87], v[48:51]
    s_add_u32 s31, s70, 0
    v_mfma_f32_16x16x32_bf16 v[48:51], a[220:223], v[88:91], v[48:51]
    s_waitcnt lgkmcnt(0)
    s_barrier
    ds_read_b64_tr_b16 v[222:223], v16 offset:2304
    v_mfma_f32_16x16x32_bf16 v[52:55], a[160:163], v[60:63], 0
    buffer_load_dwordx4 v248, s[40:43], s31 offen offset:0 lds
    v_mfma_f32_16x16x32_bf16 v[52:55], a[164:167], v[64:67], v[52:55]
    v_mfma_f32_16x16x32_bf16 v[52:55], a[168:171], v[68:71], v[52:55]
    s_add_u32 s31, s70, 26624
    v_mfma_f32_16x16x32_bf16 v[52:55], a[172:175], v[72:75], v[52:55]
    v_mfma_f32_16x16x32_bf16 v[52:55], a[176:179], v[76:79], v[52:55]
    buffer_load_dwordx4 v249, s[40:43], s31 offen offset:1024 lds
    v_mfma_f32_16x16x32_bf16 v[52:55], a[180:183], v[80:83], v[52:55]
    v_mfma_f32_16x16x32_bf16 v[52:55], a[184:187], v[84:87], v[52:55]
    v_mfma_f32_16x16x32_bf16 v[52:55], a[188:191], v[88:91], v[52:55]
    s_add_u32 s31, s70, 53248
    v_mfma_f32_16x16x32_bf16 v[44:47], a[32:35], v[92:95], v[44:47]
    v_mfma_f32_16x16x32_bf16 v[44:47], a[36:39], v[96:99], v[44:47]
    buffer_load_dwordx4 v248, s[40:43], s31 offen offset:2048 lds
    v_mfma_f32_16x16x32_bf16 v[44:47], a[40:43], v[100:103], v[44:47]
    v_mfma_f32_16x16x32_bf16 v[44:47], a[44:47], v[104:107], v[44:47]
    s_waitcnt lgkmcnt(0)
    v_lshl_or_b32 v224, v222, 16, s99
    v_bfi_b32 v225, v18, s99, v222
    v_mfma_f32_16x16x32_bf16 v[44:47], a[48:51], v[108:111], v[44:47]
    s_add_u32 s31, s70, 79872
    v_lshl_or_b32 v226, v223, 16, s99
    v_bfi_b32 v227, v18, s99, v223
    v_mfma_f32_16x16x32_bf16 v[44:47], a[52:55], v[112:115], v[44:47]
    buffer_store_dwordx4 v[224:227], v17, s[44:47], s69 offen sc1
    v_mfma_f32_16x16x32_bf16 v[44:47], a[56:59], v[116:119], v[44:47]
    s_add_u32 s69, s69, 655360
    buffer_load_dwordx4 v249, s[40:43], s31 offen offset:3072 lds
    v_mfma_f32_16x16x32_bf16 v[44:47], a[60:63], v[120:123], v[44:47]
    v_mfma_f32_16x16x32_bf16 v[48:51], a[0:3], v[92:95], v[48:51]
    v_mfma_f32_16x16x32_bf16 v[48:51], a[4:7], v[96:99], v[48:51]
    s_add_u32 m0, s71, 86016
    v_mfma_f32_16x16x32_bf16 v[48:51], a[8:11], v[100:103], v[48:51]
    s_add_u32 s31, s70, 110592
    v_mfma_f32_16x16x32_bf16 v[48:51], a[12:15], v[104:107], v[48:51]
    buffer_load_dwordx4 v248, s[40:43], s31 offen offset:0 lds
    v_mfma_f32_16x16x32_bf16 v[48:51], a[16:19], v[108:111], v[48:51]
    v_mfma_f32_16x16x32_bf16 v[48:51], a[20:23], v[112:115], v[48:51]
    v_mfma_f32_16x16x32_bf16 v[48:51], a[24:27], v[116:119], v[48:51]
    s_add_u32 s31, s70, 137216
    v_mfma_f32_16x16x32_bf16 v[48:51], a[28:31], v[120:123], v[48:51]
    s_add_u32 s66, s68, 2621440
    v_mfma_f32_16x16x32_bf16 v[52:55], a[192:195], v[92:95], v[52:55]
    buffer_load_dwordx4 v249, s[40:43], s31 offen offset:1024 lds
    v_mfma_f32_16x16x32_bf16 v[52:55], a[196:199], v[96:99], v[52:55]
    buffer_load_dwordx4 v[204:207], v10, s[44:47], s66 offen sc1
    v_mfma_f32_16x16x32_bf16 v[52:55], a[200:203], v[100:103], v[52:55]
    v_mfma_f32_16x16x32_bf16 v[52:55], a[204:207], v[104:107], v[52:55]
    s_add_u32 s31, s70, 163840
    v_mfma_f32_16x16x32_bf16 v[52:55], a[208:211], v[108:111], v[52:55]
    v_mfma_f32_16x16x32_bf16 v[52:55], a[212:215], v[112:115], v[52:55]
    buffer_load_dwordx4 v248, s[40:43], s31 offen offset:2048 lds
    v_mfma_f32_16x16x32_bf16 v[52:55], a[216:219], v[116:119], v[52:55]
    v_mfma_f32_16x16x32_bf16 v[52:55], a[220:223], v[120:123], v[52:55]
    v_mfma_f32_16x16x32_bf16 v[44:47], a[64:67], v[124:127], v[44:47]
    s_add_u32 s31, s70, 190464
    v_mfma_f32_16x16x32_bf16 v[44:47], a[68:71], v[128:131], v[44:47]
    v_mfma_f32_16x16x32_bf16 v[44:47], a[72:75], v[132:135], v[44:47]
    buffer_load_dwordx4 v249, s[40:43], s31 offen offset:3072 lds
    v_mfma_f32_16x16x32_bf16 v[44:47], a[76:79], v[136:139], v[44:47]
    s_add_u32 s66, s68, 3276800
    v_mfma_f32_16x16x32_bf16 v[44:47], a[80:83], v[140:143], v[44:47]
    v_mfma_f32_16x16x32_bf16 v[44:47], a[84:87], v[144:147], v[44:47]
    s_add_u32 m0, s71, 90112
    buffer_load_dwordx4 v[208:211], v10, s[44:47], s66 offen sc1
    v_mfma_f32_16x16x32_bf16 v[44:47], a[88:91], v[148:151], v[44:47]
    s_add_u32 s31, s70, 221184
    v_mfma_f32_16x16x32_bf16 v[44:47], a[92:95], v[152:155], v[44:47]
    buffer_load_dwordx4 v248, s[40:43], s31 offen offset:0 lds
    v_mfma_f32_16x16x32_bf16 v[48:51], a[32:35], v[124:127], v[48:51]
    v_mfma_f32_16x16x32_bf16 v[48:51], a[36:39], v[128:131], v[48:51]
    v_mfma_f32_16x16x32_bf16 v[48:51], a[40:43], v[132:135], v[48:51]
    s_add_u32 s31, s70, 247808
    v_mfma_f32_16x16x32_bf16 v[48:51], a[44:47], v[136:139], v[48:51]
    v_mfma_f32_16x16x32_bf16 v[48:51], a[48:51], v[140:143], v[48:51]
    buffer_load_dwordx4 v249, s[40:43], s31 offen offset:1024 lds
    v_mfma_f32_16x16x32_bf16 v[48:51], a[52:55], v[144:147], v[48:51]
    v_mfma_f32_16x16x32_bf16 v[48:51], a[56:59], v[148:151], v[48:51]
    v_mfma_f32_16x16x32_bf16 v[48:51], a[60:63], v[152:155], v[48:51]
    s_add_u32 s66, s68, 3932160
    v_mfma_f32_16x16x32_bf16 v[52:55], a[0:3], v[124:127], v[52:55]
    s_add_u32 m0, s71, 122880
    v_mfma_f32_16x16x32_bf16 v[52:55], a[4:7], v[128:131], v[52:55]
    s_add_u32 s31, s70, 552960
    buffer_load_dwordx4 v[212:215], v10, s[44:47], s66 offen sc1
    buffer_load_dwordx4 v248, s[40:43], s31 offen offset:0 lds
    v_mfma_f32_16x16x32_bf16 v[52:55], a[8:11], v[132:135], v[52:55]
    s_lshl_b32 s53, s77, 12
    s_lshr_b32 s48, s3, 1
    v_mfma_f32_16x16x32_bf16 v[52:55], a[12:15], v[136:139], v[52:55]
    s_lshl_b32 s48, s48, 11
    v_mfma_f32_16x16x32_bf16 v[52:55], a[16:19], v[140:143], v[52:55]
    s_add_u32 s31, s70, 579584
    s_add_u32 s53, s53, s48
    v_mfma_f32_16x16x32_bf16 v[52:55], a[20:23], v[144:147], v[52:55]
    s_waitcnt vmcnt(7)
    v_xor_b32 v20, s99, v204
    v_bitop3_b32 v20, v205, s99, v20 bitop3:0xbe
    v_mfma_f32_16x16x32_bf16 v[52:55], a[24:27], v[148:151], v[52:55]
    s_add_u32 s53, s53, 42991616
    buffer_load_dwordx4 v249, s[40:43], s31 offen offset:1024 lds
    v_bitop3_b32 v20, v206, s99, v20 bitop3:0xbe
    v_mfma_f32_16x16x32_bf16 v[52:55], a[28:31], v[152:155], v[52:55]
    s_lshl_b32 s48, s97, 7
    v_bitop3_b32 v20, v207, s99, v20 bitop3:0xbe
    v_cmp_ne_u16 vcc, 0, v20
    v_mfma_f32_16x16x32_bf16 v[44:47], a[96:99], v[156:159], v[44:47]
    s_cbranch_vccnz L_cv4r
L_cv4b:
    v_perm_b32 v20, v206, v207, s27
    v_perm_b32 v21, v204, v205, s27
    v_mfma_f32_16x16x32_bf16 v[44:47], a[100:103], v[160:163], v[44:47]
    s_add_u32 s31, s70, 606208
    ds_write_b64 v12, v[20:21] offset:1536
    v_mfma_f32_16x16x32_bf16 v[44:47], a[104:107], v[164:167], v[44:47]
    s_add_u32 s53, s53, s48
    v_min_u32 v7, 1, v1
    v_lshlrev_b32 v7, 10, v7
    v_mfma_f32_16x16x32_bf16 v[44:47], a[108:111], v[168:171], v[44:47]
    s_add_u32 s66, s68, 4587520
    buffer_load_dwordx4 v248, s[40:43], s31 offen offset:2048 lds
    s_mul_i32 s51, s77, 110592
    v_mfma_f32_16x16x32_bf16 v[44:47], a[112:115], v[172:175], v[44:47]
    s_lshl_b32 s48, s78, 11
    s_add_u32 s51, s51, s48
    v_mfma_f32_16x16x32_bf16 v[44:47], a[116:119], v[176:179], v[44:47]
    s_lshl_b32 s48, s3, 9
    ds_read_b128 v[60:63], v13 offset:1536
    buffer_load_dwordx4 v[216:219], v10, s[44:47], s66 offen sc1
    v_mfma_f32_16x16x32_bf16 v[44:47], a[120:123], v[180:183], v[44:47]
    s_add_u32 s31, s70, 632832
    ds_read_b128 v[64:67], v13 offset:1600
    s_add_u32 s51, s51, s48
    v_mfma_f32_16x16x32_bf16 v[44:47], a[124:127], v[184:187], v[44:47]
    s_add_u32 s51, s51, 12582912
    ds_read_b128 v[68:71], v13 offset:1664
    v_mfma_f32_16x16x32_bf16 v[48:51], a[64:67], v[156:159], v[48:51]
    s_mul_i32 s50, s77, 40960
    ds_read_b128 v[72:75], v13 offset:1728
    buffer_load_dwordx4 v249, s[40:43], s31 offen offset:3072 lds
    v_mfma_f32_16x16x32_bf16 v[48:51], a[68:71], v[160:163], v[48:51]
    s_add_u32 s50, s50, s71
    ds_read_b128 v[76:79], v13 offset:1792
    v_mfma_f32_16x16x32_bf16 v[48:51], a[72:75], v[164:167], v[48:51]
    s_lshr_b32 s48, s3, 1
    ds_read_b128 v[80:83], v13 offset:1856
    v_mfma_f32_16x16x32_bf16 v[48:51], a[76:79], v[168:171], v[48:51]
    s_add_u32 m0, s71, 126976
    ds_read_b128 v[84:87], v13 offset:1920
    s_mul_i32 s48, s48, 0
    v_mfma_f32_16x16x32_bf16 v[48:51], a[80:83], v[172:175], v[48:51]
    s_add_u32 s31, s70, 663552
    ds_read_b128 v[88:91], v13 offset:1984
    s_add_u32 s50, s50, s48
    v_mfma_f32_16x16x32_bf16 v[48:51], a[84:87], v[176:179], v[48:51]
    s_add_u32 s50, s50, 4194304
    buffer_load_dwordx4 v248, s[40:43], s31 offen offset:0 lds
    v_mfma_f32_16x16x32_bf16 v[48:51], a[88:91], v[180:183], v[48:51]
    s_waitcnt vmcnt(9)
    v_xor_b32 v20, s99, v208
    v_bitop3_b32 v20, v209, s99, v20 bitop3:0xbe
    v_mfma_f32_16x16x32_bf16 v[48:51], a[92:95], v[184:187], v[48:51]
    s_mov_b32 s52, 0xbfb8aa3b
    v_bitop3_b32 v20, v210, s99, v20 bitop3:0xbe
    v_bitop3_b32 v20, v211, s99, v20 bitop3:0xbe
    v_mfma_f32_16x16x32_bf16 v[52:55], a[32:35], v[156:159], v[52:55]
    s_add_u32 s31, s70, 690176
    v_cmp_ne_u16 vcc, 0, v20
    s_nop 0
    s_cbranch_vccnz L_cv5r
L_cv5b:
    v_mfma_f32_16x16x32_bf16 v[52:55], a[36:39], v[160:163], v[52:55]
    s_lshl_b32 s54, s77, 5
    v_perm_b32 v20, v210, v211, s27
    v_perm_b32 v21, v208, v209, s27
    v_mfma_f32_16x16x32_bf16 v[52:55], a[40:43], v[164:167], v[52:55]
    s_add_u32 s54, s54, s78
    ds_write_b64 v12, v[20:21] offset:1024
    v_mfma_f32_16x16x32_bf16 v[52:55], a[44:47], v[168:171], v[52:55]
    s_lshl_b32 s54, s54, 8
    buffer_load_dwordx4 v249, s[40:43], s31 offen offset:1024 lds
    s_add_u32 s54, s54, 42205184
    v_mfma_f32_16x16x32_bf16 v[52:55], a[48:51], v[172:175], v[52:55]
    v_bfe_u32 v6, v1, 4, 1
    v_mul_u32_u24 v5, 55296, v6
    v_mfma_f32_16x16x32_bf16 v[52:55], a[52:55], v[176:179], v[52:55]
    s_add_u32 s31, s70, 716800
    v_lshrrev_b32 v6, 5, v1
    v_mfma_f32_16x16x32_bf16 v[52:55], a[56:59], v[180:183], v[52:55]
    ds_read_b128 v[92:95], v13 offset:1024
    v_lshl_add_u32 v5, v6, 8, v5
    v_mfma_f32_16x16x32_bf16 v[52:55], a[60:63], v[184:187], v[52:55]
    s_waitcnt lgkmcnt(2)
    ds_read_b128 v[96:99], v13 offset:1088
    buffer_load_dwordx4 v248, s[40:43], s31 offen offset:2048 lds
    v_mfma_f32_16x16x32_bf16 v[44:47], a[224:227], v[60:63], v[44:47]
    ds_read_b128 v[100:103], v13 offset:1152
    v_and_b32 v6, 15, v1
    v_mfma_f32_16x16x32_bf16 v[44:47], a[228:231], v[64:67], v[44:47]
    ds_read_b128 v[104:107], v13 offset:1216
    v_lshl_add_u32 v5, v6, 4, v5
    v_mfma_f32_16x16x32_bf16 v[44:47], a[232:235], v[68:71], v[44:47]
    s_add_u32 s31, s70, 743424
    ds_read_b128 v[108:111], v13 offset:1280
    v_lshrrev_b32 v6, 6, v0
    v_mfma_f32_16x16x32_bf16 v[44:47], a[236:239], v[72:75], v[44:47]
    ds_read_b128 v[112:115], v13 offset:1344
    v_min_u32 v6, 1, v6
    v_mfma_f32_16x16x32_bf16 v[44:47], a[240:243], v[76:79], v[44:47]
    ds_read_b128 v[116:119], v13 offset:1408
    buffer_load_dwordx4 v249, s[40:43], s31 offen offset:3072 lds
    v_mfma_f32_16x16x32_bf16 v[44:47], a[244:247], v[80:83], v[44:47]
    ds_read_b128 v[120:123], v13 offset:1472
    v_lshrrev_b32 v9, 2, v10
    v_mfma_f32_16x16x32_bf16 v[44:47], a[248:251], v[84:87], v[44:47]
    v_lshl_or_b32 v9, v6, 31, v9
    v_add_u32 v2, 122880, v10
    v_mfma_f32_16x16x32_bf16 v[44:47], a[252:255], v[88:91], v[44:47]
    s_add_u32 m0, s71, 131072
    v_add_u32 v3, 40960, v10
    v_add_u32 v4, 81920, v10
    v_mfma_f32_16x16x32_bf16 v[44:47], v[24:27], v[60:63], v[44:47]
    s_add_u32 s31, s70, 774144
    s_lshr_b32 s48, s3, 1
    v_mfma_f32_16x16x32_bf16 v[48:51], a[96:99], v[60:63], v[48:51]
    s_waitcnt vmcnt(9)
    buffer_load_dwordx4 v248, s[40:43], s31 offen offset:0 lds
    v_xor_b32 v20, s99, v212
    v_mfma_f32_16x16x32_bf16 v[48:51], a[100:103], v[64:67], v[48:51]
    s_lshl_b32 s48, s48, 31
    v_bitop3_b32 v20, v213, s99, v20 bitop3:0xbe
    v_bitop3_b32 v20, v214, s99, v20 bitop3:0xbe
    v_mfma_f32_16x16x32_bf16 v[48:51], a[104:107], v[68:71], v[48:51]
    v_cvt_pk_bf16_f32 v220, v44, v45
    v_cvt_pk_bf16_f32 v221, v46, v47
    v_mfma_f32_16x16x32_bf16 v[48:51], a[108:111], v[72:75], v[48:51]
    s_add_u32 s31, s70, 800768
    ds_write_b64 v15, v[220:221] offset:0
    v_mfma_f32_16x16x32_bf16 v[48:51], a[112:115], v[76:79], v[48:51]
    v_bitop3_b32 v20, v215, s99, v20 bitop3:0xbe
    v_cmp_ne_u16 vcc, 0, v20
    v_mfma_f32_16x16x32_bf16 v[48:51], a[116:119], v[80:83], v[48:51]
    s_cbranch_vccnz L_cv6r
L_cv6b:
    buffer_load_dwordx4 v249, s[40:43], s31 offen offset:1024 lds
    v_perm_b32 v20, v214, v215, s27
    v_mfma_f32_16x16x32_bf16 v[48:51], a[120:123], v[84:87], v[48:51]
    v_perm_b32 v21, v212, v213, s27
    v_or_b32 v6, s48, v10
    v_mfma_f32_16x16x32_bf16 v[48:51], a[124:127], v[88:91], v[48:51]
    s_waitcnt lgkmcnt(1)
    ds_write_b64 v12, v[20:21] offset:512
    v_mfma_f32_16x16x32_bf16 v[48:51], a[224:227], v[92:95], v[48:51]
    s_add_u32 m0, s71, 40960
    ds_read_b128 v[124:127], v13 offset:512
    v_mfma_f32_16x16x32_bf16 v[48:51], a[228:231], v[96:99], v[48:51]
    s_add_u32 s31, s70, 1105920
    ds_read_b128 v[128:131], v13 offset:576
    v_mfma_f32_16x16x32_bf16 v[48:51], a[232:235], v[100:103], v[48:51]
    s_waitcnt lgkmcnt(3)
    s_barrier
    ds_read_b64_tr_b16 v[222:223], v16 offset:0
    v_mfma_f32_16x16x32_bf16 v[48:51], a[236:239], v[104:107], v[48:51]
    ds_read_b128 v[132:135], v13 offset:640
    ds_read_b128 v[136:139], v13 offset:704
    v_mfma_f32_16x16x32_bf16 v[48:51], a[240:243], v[108:111], v[48:51]
    ds_read_b128 v[140:143], v13 offset:768
    buffer_load_dwordx4 v248, s[40:43], s31 offen offset:0 lds
    v_mfma_f32_16x16x32_bf16 v[48:51], a[244:247], v[112:115], v[48:51]
    s_add_u32 s31, s70, 1132544
    ds_read_b128 v[144:147], v13 offset:832
    v_mfma_f32_16x16x32_bf16 v[48:51], a[248:251], v[116:119], v[48:51]
    ds_read_b128 v[148:151], v13 offset:896
    v_mfma_f32_16x16x32_bf16 v[48:51], a[252:255], v[120:123], v[48:51]
    ds_read_b128 v[152:155], v13 offset:960
    buffer_load_dwordx4 v249, s[40:43], s31 offen offset:1024 lds
    v_mfma_f32_16x16x32_bf16 v[48:51], v[24:27], v[92:95], v[48:51]
    s_waitcnt lgkmcnt(6)
    v_lshl_or_b32 v224, v222, 16, s99
    v_bfi_b32 v225, v18, s99, v222
    v_mfma_f32_16x16x32_bf16 v[52:55], a[64:67], v[60:63], v[52:55]
    v_lshl_or_b32 v226, v223, 16, s99
    v_bfi_b32 v227, v18, s99, v223
    v_mfma_f32_16x16x32_bf16 v[52:55], a[68:71], v[64:67], v[52:55]
    s_add_u32 s31, s70, 1159168
    buffer_store_dwordx4 v[224:227], v17, s[44:47], s69 offen sc1
    v_mfma_f32_16x16x32_bf16 v[52:55], a[72:75], v[68:71], v[52:55]
    s_add_u32 s69, s69, 655360
    v_cvt_pk_bf16_f32 v220, v48, v49
    v_cvt_pk_bf16_f32 v221, v50, v51
    v_mfma_f32_16x16x32_bf16 v[52:55], a[76:79], v[72:75], v[52:55]
    ds_write_b64 v15, v[220:221] offset:2304
    v_mfma_f32_16x16x32_bf16 v[52:55], a[80:83], v[76:79], v[52:55]
    buffer_load_dwordx4 v248, s[40:43], s31 offen offset:2048 lds
    v_mfma_f32_16x16x32_bf16 v[52:55], a[84:87], v[80:83], v[52:55]
    v_mfma_f32_16x16x32_bf16 v[52:55], a[88:91], v[84:87], v[52:55]
    s_add_u32 s31, s70, 1185792
    v_mfma_f32_16x16x32_bf16 v[52:55], a[92:95], v[88:91], v[52:55]
    v_mfma_f32_16x16x32_bf16 v[52:55], a[96:99], v[92:95], v[52:55]
    buffer_load_dwordx4 v249, s[40:43], s31 offen offset:3072 lds
    v_mfma_f32_16x16x32_bf16 v[52:55], a[100:103], v[96:99], v[52:55]
    v_mfma_f32_16x16x32_bf16 v[52:55], a[104:107], v[100:103], v[52:55]
    v_mfma_f32_16x16x32_bf16 v[52:55], a[108:111], v[104:107], v[52:55]
    s_add_u32 m0, s71, 45056
    v_mfma_f32_16x16x32_bf16 v[52:55], a[112:115], v[108:111], v[52:55]
    s_add_u32 s31, s70, 1216512
    v_mfma_f32_16x16x32_bf16 v[52:55], a[116:119], v[112:115], v[52:55]
    buffer_load_dwordx4 v248, s[40:43], s31 offen offset:0 lds
    v_mfma_f32_16x16x32_bf16 v[52:55], a[120:123], v[116:119], v[52:55]
    v_mfma_f32_16x16x32_bf16 v[52:55], a[124:127], v[120:123], v[52:55]
    s_waitcnt lgkmcnt(1)
    s_waitcnt lgkmcnt(0)
    s_barrier
    ds_read_b64_tr_b16 v[222:223], v16 offset:2304
    v_mfma_f32_16x16x32_bf16 v[52:55], a[224:227], v[124:127], v[52:55]
    s_waitcnt vmcnt(13)
    v_xor_b32 v20, s99, v216
    v_bitop3_b32 v20, v217, s99, v20 bitop3:0xbe
    v_mfma_f32_16x16x32_bf16 v[52:55], a[228:231], v[128:131], v[52:55]
    s_add_u32 s31, s70, 1243136
    v_bitop3_b32 v20, v218, s99, v20 bitop3:0xbe
    v_bitop3_b32 v20, v219, s99, v20 bitop3:0xbe
    v_mfma_f32_16x16x32_bf16 v[52:55], a[232:235], v[132:135], v[52:55]
    buffer_load_dwordx4 v249, s[40:43], s31 offen offset:1024 lds
    v_cmp_ne_u16 vcc, 0, v20
    v_mfma_f32_16x16x32_bf16 v[52:55], a[236:239], v[136:139], v[52:55]
    s_cbranch_vccnz L_cv7r
L_cv7b:
    v_perm_b32 v20, v218, v219, s27
    v_perm_b32 v21, v216, v217, s27
    v_mfma_f32_16x16x32_bf16 v[52:55], a[240:243], v[140:143], v[52:55]
    ds_write_b64 v12, v[20:21] offset:0
    v_mfma_f32_16x16x32_bf16 v[52:55], a[244:247], v[144:147], v[52:55]
    s_add_u32 s31, s70, 1269760
    v_mfma_f32_16x16x32_bf16 v[52:55], a[248:251], v[148:151], v[52:55]
    v_mfma_f32_16x16x32_bf16 v[52:55], a[252:255], v[152:155], v[52:55]
    buffer_load_dwordx4 v248, s[40:43], s31 offen offset:2048 lds
    v_mfma_f32_16x16x32_bf16 v[52:55], v[24:27], v[124:127], v[52:55]
    v_mfma_f32_16x16x32_bf16 v[56:59], a[0:3], v[156:159], 0
    v_mfma_f32_16x16x32_bf16 v[56:59], a[4:7], v[160:163], v[56:59]
    s_add_u32 s31, s70, 1296384
    v_mfma_f32_16x16x32_bf16 v[56:59], a[8:11], v[164:167], v[56:59]
    s_waitcnt lgkmcnt(1)
    v_lshl_or_b32 v224, v222, 16, s99
    v_bfi_b32 v225, v18, s99, v222
    v_mfma_f32_16x16x32_bf16 v[56:59], a[12:15], v[168:171], v[56:59]
    buffer_load_dwordx4 v249, s[40:43], s31 offen offset:3072 lds
    v_lshl_or_b32 v226, v223, 16, s99
    v_mfma_f32_16x16x32_bf16 v[56:59], a[16:19], v[172:175], v[56:59]
    v_bfi_b32 v227, v18, s99, v223
    v_mfma_f32_16x16x32_bf16 v[56:59], a[20:23], v[176:179], v[56:59]
    buffer_store_dwordx4 v[224:227], v17, s[44:47], s69 offen sc1
    v_mfma_f32_16x16x32_bf16 v[56:59], a[24:27], v[180:183], v[56:59]
    s_add_u32 s69, s69, 655360
    v_cvt_pk_bf16_f32 v220, v52, v53
    v_cvt_pk_bf16_f32 v221, v54, v55
    v_mfma_f32_16x16x32_bf16 v[56:59], a[28:31], v[184:187], v[56:59]
    s_add_u32 m0, s71, 49152
    ds_write_b64 v15, v[220:221] offset:0
    v_mfma_f32_16x16x32_bf16 v[56:59], a[32:35], v[60:63], v[56:59]
    s_add_u32 s31, s70, 1327104
    ds_read_b128 v[156:159], v13 offset:3584
    ds_read_b128 v[160:163], v13 offset:3648
    v_mfma_f32_16x16x32_bf16 v[56:59], a[36:39], v[64:67], v[56:59]
    ds_read_b128 v[164:167], v13 offset:3712
    buffer_load_dwordx4 v248, s[40:43], s31 offen offset:0 lds
    v_mfma_f32_16x16x32_bf16 v[56:59], a[40:43], v[68:71], v[56:59]
    ds_read_b128 v[168:171], v13 offset:3776
    v_mfma_f32_16x16x32_bf16 v[56:59], a[44:47], v[72:75], v[56:59]
    s_add_u32 s31, s70, 1353728
    ds_read_b128 v[172:175], v13 offset:3840
    v_mfma_f32_16x16x32_bf16 v[56:59], a[48:51], v[76:79], v[56:59]
    ds_read_b128 v[176:179], v13 offset:3904
    v_mfma_f32_16x16x32_bf16 v[56:59], a[52:55], v[80:83], v[56:59]
    ds_read_b128 v[180:183], v13 offset:3968
    buffer_load_dwordx4 v249, s[40:43], s31 offen offset:1024 lds
    v_mfma_f32_16x16x32_bf16 v[56:59], a[56:59], v[84:87], v[56:59]
    ds_read_b128 v[184:187], v13 offset:4032
    v_mfma_f32_16x16x32_bf16 v[56:59], a[60:63], v[88:91], v[56:59]
    s_waitcnt vmcnt(12) lgkmcnt(8)
    s_barrier
    ds_read_b64_tr_b16 v[222:223], v16 offset:0
    v_mfma_f32_16x16x32_bf16 v[56:59], a[64:67], v[92:95], v[56:59]
    ds_read_b128 v[60:63], v13 offset:3072
    ds_read_b128 v[64:67], v13 offset:3136
    v_mfma_f32_16x16x32_bf16 v[56:59], a[68:71], v[96:99], v[56:59]
    ds_read_b128 v[68:71], v13 offset:3200
    v_add_u32 v22, 81920, v250
    v_mfma_f32_16x16x32_bf16 v[56:59], a[72:75], v[100:103], v[56:59]
    ds_read_b128 v[72:75], v13 offset:3264
    ds_read_b64_tr_b16 a[0:1], v22 offset:0
    v_mfma_f32_16x16x32_bf16 v[56:59], a[76:79], v[104:107], v[56:59]
    ds_read_b128 v[76:79], v13 offset:3328
    ds_read_b64_tr_b16 a[2:3], v22 offset:512
    v_mfma_f32_16x16x32_bf16 v[56:59], a[80:83], v[108:111], v[56:59]
    ds_read_b128 v[80:83], v13 offset:3392
    ds_read_b64_tr_b16 a[4:5], v22 offset:20480
    v_mfma_f32_16x16x32_bf16 v[56:59], a[84:87], v[112:115], v[56:59]
    ds_read_b128 v[84:87], v13 offset:3456
    ds_read_b64_tr_b16 a[6:7], v22 offset:20992
    v_mfma_f32_16x16x32_bf16 v[56:59], a[88:91], v[116:119], v[56:59]
    ds_read_b128 v[88:91], v13 offset:3520
    ds_read_b64_tr_b16 a[8:9], v22 offset:4096
    v_mfma_f32_16x16x32_bf16 v[56:59], a[92:95], v[120:123], v[56:59]
    ds_read_b128 v[92:95], v13 offset:2560
    ds_read_b64_tr_b16 a[10:11], v22 offset:4608
    v_mfma_f32_16x16x32_bf16 v[56:59], a[96:99], v[124:127], v[56:59]
    ds_read_b128 v[96:99], v13 offset:2624
    ds_read_b64_tr_b16 a[12:13], v22 offset:24576
    v_mfma_f32_16x16x32_bf16 v[56:59], a[100:103], v[128:131], v[56:59]
    ds_read_b128 v[100:103], v13 offset:2688
    ds_read_b64_tr_b16 a[14:15], v22 offset:25088
    v_mfma_f32_16x16x32_bf16 v[56:59], a[104:107], v[132:135], v[56:59]
    ds_read_b128 v[104:107], v13 offset:2752
    ds_read_b64_tr_b16 a[16:17], v22 offset:8192
    v_mfma_f32_16x16x32_bf16 v[56:59], a[108:111], v[136:139], v[56:59]
    s_waitcnt lgkmcnt(14)
    ds_read_b128 v[108:111], v13 offset:2816
    ds_read_b64_tr_b16 a[18:19], v22 offset:8704
    v_mfma_f32_16x16x32_bf16 v[56:59], a[112:115], v[140:143], v[56:59]
    ds_read_b128 v[112:115], v13 offset:2880
    ds_read_b64_tr_b16 a[20:21], v22 offset:28672
    v_mfma_f32_16x16x32_bf16 v[56:59], a[116:119], v[144:147], v[56:59]
    ds_read_b128 v[116:119], v13 offset:2944
    ds_read_b64_tr_b16 a[22:23], v22 offset:29184
    v_mfma_f32_16x16x32_bf16 v[56:59], a[120:123], v[148:151], v[56:59]
    ds_read_b128 v[120:123], v13 offset:3008
    ds_read_b64_tr_b16 a[24:25], v22 offset:12288
    v_mfma_f32_16x16x32_bf16 v[56:59], a[124:127], v[152:155], v[56:59]
    s_waitcnt lgkmcnt(14)
    ds_read_b128 v[124:127], v13 offset:0
    ds_read_b64_tr_b16 a[26:27], v22 offset:12800
    v_mfma_f32_16x16x32_bf16 v[56:59], a[128:131], v[156:159], v[56:59]
    ds_read_b128 v[128:131], v13 offset:64
    ds_read_b64_tr_b16 a[28:29], v22 offset:32768
    v_mfma_f32_16x16x32_bf16 v[56:59], a[132:135], v[160:163], v[56:59]
    ds_read_b128 v[132:135], v13 offset:128
    ds_read_b64_tr_b16 a[30:31], v22 offset:33280
    v_mfma_f32_16x16x32_bf16 v[56:59], a[136:139], v[164:167], v[56:59]
    ds_read_b128 v[136:139], v13 offset:192
    ds_read_b64_tr_b16 a[32:33], v22 offset:16384
    v_mfma_f32_16x16x32_bf16 v[56:59], a[140:143], v[168:171], v[56:59]
    ds_read_b128 v[140:143], v13 offset:256
    ds_read_b64_tr_b16 a[34:35], v22 offset:16896
    v_mfma_f32_16x16x32_bf16 v[56:59], a[144:147], v[172:175], v[56:59]
    ds_read_b128 v[144:147], v13 offset:320
    ds_read_b64_tr_b16 a[36:37], v22 offset:36864
    v_mfma_f32_16x16x32_bf16 v[56:59], a[148:151], v[176:179], v[56:59]
    ds_read_b128 v[148:151], v13 offset:384
    ds_read_b64_tr_b16 a[38:39], v22 offset:37376
    v_mfma_f32_16x16x32_bf16 v[56:59], a[152:155], v[180:183], v[56:59]
    ds_read_b128 v[152:155], v13 offset:448
    v_lshl_or_b32 v224, v222, 16, s99
    v_mfma_f32_16x16x32_bf16 v[56:59], a[156:159], v[184:187], v[56:59]
    s_waitcnt lgkmcnt(14)
    v_bfi_b32 v225, v18, s99, v222
    v_lshl_or_b32 v226, v223, 16, s99
    v_mfma_f32_16x16x32_bf16 v[56:59], a[160:163], v[60:63], v[56:59]
    v_bfi_b32 v227, v18, s99, v223
    v_add_u32 v23, 122880, v250
    v_mfma_f32_16x16x32_bf16 v[56:59], a[164:167], v[64:67], v[56:59]
    buffer_store_dwordx4 v[224:227], v17, s[44:47], s69 offen sc1
    v_mfma_f32_16x16x32_bf16 v[56:59], a[168:171], v[68:71], v[56:59]
    s_add_u32 s69, s69, 655360
    ds_read_b64_tr_b16 a[40:41], v23 offset:0
    ds_read_b64_tr_b16 a[42:43], v23 offset:512
    v_mfma_f32_16x16x32_bf16 v[56:59], a[172:175], v[72:75], v[56:59]
    ds_read_b64_tr_b16 a[44:45], v23 offset:20480
    ds_read_b64_tr_b16 a[46:47], v23 offset:20992
    v_mfma_f32_16x16x32_bf16 v[56:59], a[176:179], v[76:79], v[56:59]
    s_waitcnt vmcnt(1) lgkmcnt(5)
    s_barrier
    ds_read_b64_tr_b16 a[48:49], v23 offset:4096
    v_mfma_f32_16x16x32_bf16 v[56:59], a[180:183], v[80:83], v[56:59]
    s_add_u32 m0, s71, 81920
    ds_read_b64_tr_b16 a[50:51], v23 offset:4608
    ds_read_b64_tr_b16 a[52:53], v23 offset:24576
    v_mfma_f32_16x16x32_bf16 v[56:59], a[184:187], v[84:87], v[56:59]
    s_add_u32 s31, s70, 1658880
    ds_read_b64_tr_b16 a[54:55], v23 offset:25088
    ds_read_b64_tr_b16 a[56:57], v23 offset:8192
    v_mfma_f32_16x16x32_bf16 v[56:59], a[188:191], v[88:91], v[56:59]
    s_waitcnt lgkmcnt(14)
    buffer_load_dwordx4 v248, s[40:43], s31 offen offset:0 lds
    ds_read_b64_tr_b16 a[58:59], v23 offset:8704
    v_mfma_f32_16x16x32_bf16 v[56:59], a[192:195], v[92:95], v[56:59]
    s_add_u32 s31, s70, 1685504
    ds_read_b64_tr_b16 a[60:61], v23 offset:28672
    ds_read_b64_tr_b16 a[62:63], v23 offset:29184
    v_mfma_f32_16x16x32_bf16 v[56:59], a[196:199], v[96:99], v[56:59]
    buffer_load_dwordx4 v249, s[40:43], s31 offen offset:1024 lds
    ds_read_b64_tr_b16 a[64:65], v23 offset:12288
    v_mfma_f32_16x16x32_bf16 v[56:59], a[200:203], v[100:103], v[56:59]
    s_add_u32 s31, s70, 1712128
    ds_read_b64_tr_b16 a[66:67], v23 offset:12800
    ds_read_b64_tr_b16 a[68:69], v23 offset:32768
    v_mfma_f32_16x16x32_bf16 v[56:59], a[204:207], v[104:107], v[56:59]
    buffer_load_dwordx4 v248, s[40:43], s31 offen offset:2048 lds
    ds_read_b64_tr_b16 a[70:71], v23 offset:33280
    v_mfma_f32_16x16x32_bf16 v[56:59], a[208:211], v[108:111], v[56:59]
    s_add_u32 s31, s70, 1738752
    ds_read_b64_tr_b16 a[72:73], v23 offset:16384
    ds_read_b64_tr_b16 a[74:75], v23 offset:16896
    v_mfma_f32_16x16x32_bf16 v[56:59], a[212:215], v[112:115], v[56:59]
    buffer_load_dwordx4 v249, s[40:43], s31 offen offset:3072 lds
    ds_read_b64_tr_b16 a[76:77], v23 offset:36864
    v_mfma_f32_16x16x32_bf16 v[56:59], a[216:219], v[116:119], v[56:59]
    s_add_u32 m0, s71, 86016
    ds_read_b64_tr_b16 a[78:79], v23 offset:37376
    v_mfma_f32_16x16x32_bf16 v[56:59], a[220:223], v[120:123], v[56:59]
    s_waitcnt lgkmcnt(14)
    s_add_u32 s31, s70, 1769472
    buffer_load_dwordx4 v248, s[40:43], s31 offen offset:0 lds
    v_mfma_f32_16x16x32_bf16 v[56:59], a[224:227], v[124:127], v[56:59]
    s_add_u32 s31, s70, 1796096
    v_mfma_f32_16x16x32_bf16 v[56:59], a[228:231], v[128:131], v[56:59]
    buffer_load_dwordx4 v249, s[40:43], s31 offen offset:1024 lds
    v_mfma_f32_16x16x32_bf16 v[56:59], a[232:235], v[132:135], v[56:59]
    s_add_u32 s31, s70, 1822720
    v_mfma_f32_16x16x32_bf16 v[56:59], a[236:239], v[136:139], v[56:59]
    buffer_load_dwordx4 v248, s[40:43], s31 offen offset:2048 lds
    v_mfma_f32_16x16x32_bf16 v[56:59], a[240:243], v[140:143], v[56:59]
    s_add_u32 s31, s70, 1849344
    v_mfma_f32_16x16x32_bf16 v[56:59], a[244:247], v[144:147], v[56:59]
    buffer_load_dwordx4 v249, s[40:43], s31 offen offset:3072 lds
    v_mfma_f32_16x16x32_bf16 v[56:59], a[248:251], v[148:151], v[56:59]
    s_add_u32 m0, s71, 90112
    v_mfma_f32_16x16x32_bf16 v[56:59], a[252:255], v[152:155], v[56:59]
    s_add_u32 s31, s70, 1880064
    buffer_load_dwordx4 v248, s[40:43], s31 offen offset:0 lds
    s_add_u32 s31, s70, 1906688
    buffer_load_dwordx4 v249, s[40:43], s31 offen offset:1024 lds
    v_mfma_f32_16x16x32_bf16 v[56:59], v[24:27], v[124:127], v[56:59]
    s_nop 7
    v_cvt_pk_bf16_f32 v220, v56, v57
    v_cvt_pk_bf16_f32 v221, v58, v59
    ds_write_b64 v15, v[220:221] offset:2304
    s_waitcnt lgkmcnt(0)
    s_barrier
    ds_read_b64_tr_b16 v[222:223], v16 offset:2304
    s_waitcnt lgkmcnt(0)
    v_lshl_or_b32 v224, v222, 16, s99
    v_bfi_b32 v225, v18, s99, v222
    v_lshl_or_b32 v226, v223, 16, s99
    v_bfi_b32 v227, v18, s99, v223
    buffer_store_dwordx4 v[224:227], v17, s[44:47], s69 offen sc1
    s_add_u32 s69, s69, 655360
    s_buffer_load_dword s6, s[44:47], s53 offset:0
    s_buffer_load_dword s7, s[44:47], s53 offset:1024
    v_add_u32 v22, 40960, v250
    ds_read_b64_tr_b16 a[80:81], v22 offset:0
    ds_read_b64_tr_b16 a[82:83], v22 offset:512
    ds_read_b64_tr_b16 a[84:85], v22 offset:20480
    ds_read_b64_tr_b16 a[86:87], v22 offset:20992
    ds_read_b64_tr_b16 a[88:89], v22 offset:4096
    ds_read_b64_tr_b16 a[90:91], v22 offset:4608
    ds_read_b64_tr_b16 a[92:93], v22 offset:24576
    ds_read_b64_tr_b16 a[94:95], v22 offset:25088
    ds_read_b64_tr_b16 a[96:97], v22 offset:8192
    ds_read_b64_tr_b16 a[98:99], v22 offset:8704
    ds_read_b64_tr_b16 a[100:101], v22 offset:28672
    ds_read_b64_tr_b16 a[102:103], v22 offset:29184
    ds_read_b64_tr_b16 a[104:105], v22 offset:12288
    ds_read_b64_tr_b16 a[106:107], v22 offset:12800
    ds_read_b64_tr_b16 a[108:109], v22 offset:32768
    ds_read_b64_tr_b16 a[110:111], v22 offset:33280
    ds_read_b64_tr_b16 a[112:113], v22 offset:16384
    ds_read_b64_tr_b16 a[114:115], v22 offset:16896
    ds_read_b64_tr_b16 a[116:117], v22 offset:36864
    ds_read_b64_tr_b16 a[118:119], v22 offset:37376
    s_waitcnt lgkmcnt(0)
    s_cmp_lg_u64 s[6:7], s[4:5]
    s_cbranch_scc1 L_g1l0cr
L_g1l0cb:
    s_add_u32 m0, s71, 122880
    s_add_u32 s55, s50, 0
    buffer_load_dwordx4 v10, s[44:47], s55 offen offset:0 sc1 lds
    buffer_load_dwordx4 v10, s[44:47], s55 offen offset:1024 sc1 lds
    buffer_load_dwordx4 v10, s[44:47], s55 offen offset:2048 sc1 lds
    buffer_load_dwordx4 v10, s[44:47], s55 offen offset:3072 sc1 lds
    s_add_u32 m0, s71, 126976
    s_add_u32 s55, s50, 4096
    buffer_load_dwordx4 v10, s[44:47], s55 offen offset:0 sc1 lds
    buffer_load_dwordx4 v10, s[44:47], s55 offen offset:1024 sc1 lds
    buffer_load_dwordx4 v10, s[44:47], s55 offen offset:2048 sc1 lds
    buffer_load_dwordx4 v10, s[44:47], s55 offen offset:3072 sc1 lds
    s_add_u32 m0, s71, 131072
    s_add_u32 s55, s50, 8192
    buffer_load_dwordx4 v10, s[44:47], s55 offen offset:0 sc1 lds
    buffer_load_dwordx4 v10, s[44:47], s55 offen offset:1024 sc1 lds
    s_waitcnt vmcnt(11)
    s_barrier
    v_add_u32 v23, 81920, v250
    ds_read_b64_tr_b16 a[120:121], v23 offset:0
    ds_read_b64_tr_b16 a[122:123], v23 offset:512
    ds_read_b64_tr_b16 a[124:125], v23 offset:20480
    ds_read_b64_tr_b16 a[126:127], v23 offset:20992
    ds_read_b64_tr_b16 a[128:129], v23 offset:4096
    ds_read_b64_tr_b16 a[130:131], v23 offset:4608
    ds_read_b64_tr_b16 a[132:133], v23 offset:24576
    ds_read_b64_tr_b16 a[134:135], v23 offset:25088
    ds_read_b64_tr_b16 a[136:137], v23 offset:8192
    ds_read_b64_tr_b16 a[138:139], v23 offset:8704
    ds_read_b64_tr_b16 a[140:141], v23 offset:28672
    ds_read_b64_tr_b16 a[142:143], v23 offset:29184
    ds_read_b64_tr_b16 a[144:145], v23 offset:12288
    ds_read_b64_tr_b16 a[146:147], v23 offset:12800
    ds_read_b64_tr_b16 a[148:149], v23 offset:32768
    ds_read_b64_tr_b16 a[150:151], v23 offset:33280
    ds_read_b64_tr_b16 a[152:153], v23 offset:16384
    ds_read_b64_tr_b16 a[154:155], v23 offset:16896
    ds_read_b64_tr_b16 a[156:157], v23 offset:36864
    ds_read_b64_tr_b16 a[158:159], v23 offset:37376
L_cw2b:
    s_buffer_load_dword s8, s[44:47], s53 offset:32768
    s_buffer_load_dword s9, s[44:47], s53 offset:33792
    s_waitcnt vmcnt(0) lgkmcnt(0)
    s_barrier
L_g1:
    ds_read_b128 v[56:59], v2 offset:0
    ds_read_b128 v[60:63], v2 offset:1024
    ds_read_b128 v[64:67], v2 offset:2048
    ds_read_b128 v[68:71], v2 offset:3072
    ds_read_b128 v[72:75], v2 offset:4096
    ds_read_b128 v[76:79], v2 offset:5120
    s_cmp_lg_u64 s[8:9], s[4:5]
    s_cbranch_scc1 L_g1l1r
L_g1l1b:
    s_add_u32 m0, s71, 40960
    s_add_u32 s55, s50, 327680
    buffer_load_dwordx4 v10, s[44:47], s55 offen offset:0 sc1 lds
    buffer_load_dwordx4 v10, s[44:47], s55 offen offset:1024 sc1 lds
    buffer_load_dwordx4 v10, s[44:47], s55 offen offset:2048 sc1 lds
    s_waitcnt lgkmcnt(4)
    ds_read_b128 v[80:83], v2 offset:6144
    v_mfma_f32_16x16x32_bf16 v[12:15], a[0:3], v[56:59], 0
    ds_read_b128 v[84:87], v2 offset:7168
    v_mfma_f32_16x16x32_bf16 v[12:15], a[8:11], v[60:63], v[12:15]
    v_min_u32 v89, 13, v1
    v_add_u32 v89, s74, v89
    v_mfma_f32_16x16x32_bf16 v[16:19], a[4:7], v[56:59], 0
    ds_read_b128 v[56:59], v2 offset:8192
    v_min_u32 v89, 53, v89
    v_mfma_f32_16x16x32_bf16 v[16:19], a[12:15], v[60:63], v[16:19]
    s_waitcnt lgkmcnt(5)
    ds_read_b128 v[60:63], v2 offset:9216
    v_lshlrev_b32 v89, 8, v89
    v_mfma_f32_16x16x32_bf16 v[12:15], a[16:19], v[64:67], v[12:15]
    s_mov_b32 s30, 41947136
    buffer_load_dword v88, v89, s[44:47], s30 offen sc1
    buffer_load_dwordx4 v10, s[44:47], s55 offen offset:3072 sc1 lds
    v_mfma_f32_16x16x32_bf16 v[12:15], a[24:27], v[68:71], v[12:15]
    s_add_u32 m0, s71, 45056
    v_mfma_f32_16x16x32_bf16 v[16:19], a[20:23], v[64:67], v[16:19]
    s_add_u32 s55, s50, 331776
    ds_read_b128 v[64:67], v2 offset:10240
    buffer_load_dwordx4 v10, s[44:47], s55 offen offset:0 sc1 lds
    v_mfma_f32_16x16x32_bf16 v[16:19], a[28:31], v[68:71], v[16:19]
    s_waitcnt lgkmcnt(5)
    ds_read_b128 v[68:71], v2 offset:11264
    v_mfma_f32_16x16x32_bf16 v[12:15], a[32:35], v[72:75], v[12:15]
    v_mfma_f32_16x16x32_bf16 v[12:15], a[40:43], v[76:79], v[12:15]
    v_mfma_f32_16x16x32_bf16 v[16:19], a[36:39], v[72:75], v[16:19]
    ds_read_b128 v[72:75], v2 offset:12288
    buffer_load_dwordx4 v10, s[44:47], s55 offen offset:1024 sc1 lds
    v_mfma_f32_16x16x32_bf16 v[16:19], a[44:47], v[76:79], v[16:19]
    s_waitcnt lgkmcnt(5)
    ds_read_b128 v[76:79], v2 offset:13312
    v_mfma_f32_16x16x32_bf16 v[12:15], a[48:51], v[80:83], v[12:15]
    v_mfma_f32_16x16x32_bf16 v[12:15], a[56:59], v[84:87], v[12:15]
    v_mfma_f32_16x16x32_bf16 v[16:19], a[52:55], v[80:83], v[16:19]
    ds_read_b128 v[80:83], v2 offset:14336
    buffer_load_dwordx4 v10, s[44:47], s55 offen offset:2048 sc1 lds
    v_mfma_f32_16x16x32_bf16 v[16:19], a[60:63], v[84:87], v[16:19]
    s_waitcnt lgkmcnt(5)
    ds_read_b128 v[84:87], v2 offset:15360
    v_mfma_f32_16x16x32_bf16 v[12:15], a[64:67], v[56:59], v[12:15]
    v_mfma_f32_16x16x32_bf16 v[12:15], a[72:75], v[60:63], v[12:15]
    v_mfma_f32_16x16x32_bf16 v[16:19], a[68:71], v[56:59], v[16:19]
    ds_read_b128 v[56:59], v2 offset:16384
    buffer_load_dwordx4 v10, s[44:47], s55 offen offset:3072 sc1 lds
    v_mfma_f32_16x16x32_bf16 v[16:19], a[76:79], v[60:63], v[16:19]
    s_waitcnt lgkmcnt(5)
    ds_read_b128 v[60:63], v2 offset:17408
    v_mfma_f32_16x16x32_bf16 v[12:15], a[80:83], v[64:67], v[12:15]
    s_add_u32 m0, s71, 49152
    v_mfma_f32_16x16x32_bf16 v[12:15], a[88:91], v[68:71], v[12:15]
    s_add_u32 s55, s50, 335872
    v_mfma_f32_16x16x32_bf16 v[16:19], a[84:87], v[64:67], v[16:19]
    ds_read_b128 v[64:67], v2 offset:18432
    buffer_load_dwordx4 v10, s[44:47], s55 offen offset:0 sc1 lds
    v_mfma_f32_16x16x32_bf16 v[16:19], a[92:95], v[68:71], v[16:19]
    s_waitcnt lgkmcnt(5)
    ds_read_b128 v[68:71], v2 offset:19456
    v_mfma_f32_16x16x32_bf16 v[12:15], a[96:99], v[72:75], v[12:15]
    v_mfma_f32_16x16x32_bf16 v[12:15], a[104:107], v[76:79], v[12:15]
    v_mfma_f32_16x16x32_bf16 v[16:19], a[100:103], v[72:75], v[16:19]
    ds_read_b128 v[72:75], v2 offset:20480
    buffer_load_dwordx4 v10, s[44:47], s55 offen offset:1024 sc1 lds
    v_mfma_f32_16x16x32_bf16 v[16:19], a[108:111], v[76:79], v[16:19]
    s_waitcnt lgkmcnt(5)
    ds_read_b128 v[76:79], v2 offset:21504
    v_mfma_f32_16x16x32_bf16 v[12:15], a[112:115], v[80:83], v[12:15]
    v_mfma_f32_16x16x32_bf16 v[12:15], a[120:123], v[84:87], v[12:15]
    v_mfma_f32_16x16x32_bf16 v[16:19], a[116:119], v[80:83], v[16:19]
    ds_read_b128 v[80:83], v2 offset:22528
    v_mfma_f32_16x16x32_bf16 v[16:19], a[124:127], v[84:87], v[16:19]
    s_waitcnt lgkmcnt(5)
    ds_read_b128 v[84:87], v2 offset:23552
    v_mfma_f32_16x16x32_bf16 v[12:15], a[128:131], v[56:59], v[12:15]
    v_mfma_f32_16x16x32_bf16 v[12:15], a[136:139], v[60:63], v[12:15]
    v_mfma_f32_16x16x32_bf16 v[16:19], a[132:135], v[56:59], v[16:19]
    ds_read_b128 v[56:59], v2 offset:24576
    v_mfma_f32_16x16x32_bf16 v[16:19], a[140:143], v[60:63], v[16:19]
    s_waitcnt lgkmcnt(5)
    ds_read_b128 v[60:63], v2 offset:25600
    v_mfma_f32_16x16x32_bf16 v[12:15], a[144:147], v[64:67], v[12:15]
    v_mfma_f32_16x16x32_bf16 v[12:15], a[152:155], v[68:71], v[12:15]
    v_mfma_f32_16x16x32_bf16 v[16:19], a[148:151], v[64:67], v[16:19]
    ds_read_b128 v[64:67], v2 offset:26624
    v_mfma_f32_16x16x32_bf16 v[16:19], a[156:159], v[68:71], v[16:19]
    s_waitcnt lgkmcnt(5)
    ds_read_b128 v[68:71], v2 offset:27648
    v_mfma_f32_16x16x32_bf16 v[20:23], a[0:3], v[72:75], 0
    v_mfma_f32_16x16x32_bf16 v[20:23], a[8:11], v[76:79], v[20:23]
    v_mfma_f32_16x16x32_bf16 v[24:27], a[4:7], v[72:75], 0
    ds_read_b128 v[72:75], v2 offset:28672
    v_mfma_f32_16x16x32_bf16 v[24:27], a[12:15], v[76:79], v[24:27]
    s_waitcnt lgkmcnt(5)
    ds_read_b128 v[76:79], v2 offset:29696
    s_waitcnt vmcnt(7)
    v_mfma_f32_16x16x32_bf16 v[20:23], a[16:19], v[80:83], v[20:23]
    v_cmp_ne_u32 vcc, v11, v88
    s_nop 0
    s_cbranch_vccnz L_g1w2r
L_g1w2b:
    v_mfma_f32_16x16x32_bf16 v[20:23], a[24:27], v[84:87], v[20:23]
    v_mul_f32 v44, s52, v12
    v_mul_f32 v45, s52, v13
    v_mfma_f32_16x16x32_bf16 v[24:27], a[20:23], v[80:83], v[24:27]
    s_buffer_load_dword s6, s[44:47], s53 offset:65536
    ds_read_b128 v[80:83], v2 offset:30720
    s_buffer_load_dword s7, s[44:47], s53 offset:66560
    v_mfma_f32_16x16x32_bf16 v[24:27], a[28:31], v[84:87], v[24:27]
    s_waitcnt lgkmcnt(5)
    ds_read_b128 v[84:87], v2 offset:31744
    v_mul_f32 v46, s52, v14
    v_mfma_f32_16x16x32_bf16 v[20:23], a[32:35], v[56:59], v[20:23]
    s_add_u32 s31, s72, 0
    v_exp_f32 v44, v44
    v_mfma_f32_16x16x32_bf16 v[20:23], a[40:43], v[60:63], v[20:23]
    v_exp_f32 v45, v45
    v_mfma_f32_16x16x32_bf16 v[24:27], a[36:39], v[56:59], v[24:27]
    ds_read_b128 v[56:59], v2 offset:32768
    buffer_load_dwordx4 v[96:99], v10, s[44:47], s31 offen offset:0 sc1
    v_mfma_f32_16x16x32_bf16 v[24:27], a[44:47], v[60:63], v[24:27]
    s_waitcnt lgkmcnt(5)
    ds_read_b128 v[60:63], v2 offset:33792
    v_add_f32 v44, 1.0, v44
    v_mfma_f32_16x16x32_bf16 v[20:23], a[48:51], v[64:67], v[20:23]
    v_add_f32 v45, 1.0, v45
    v_mul_f32 v47, s52, v15
    v_mfma_f32_16x16x32_bf16 v[20:23], a[56:59], v[68:71], v[20:23]
    v_rcp_f32 v44, v44
    v_mfma_f32_16x16x32_bf16 v[24:27], a[52:55], v[64:67], v[24:27]
    ds_read_b128 v[64:67], v2 offset:34816
    buffer_load_dwordx4 v[100:103], v10, s[44:47], s31 offen offset:1024 sc1
    v_mfma_f32_16x16x32_bf16 v[24:27], a[60:63], v[68:71], v[24:27]
    s_waitcnt lgkmcnt(5)
    ds_read_b128 v[68:71], v2 offset:35840
    v_mfma_f32_16x16x32_bf16 v[20:23], a[64:67], v[72:75], v[20:23]
    v_rcp_f32 v45, v45
    v_mfma_f32_16x16x32_bf16 v[20:23], a[72:75], v[76:79], v[20:23]
    v_mul_f32 v44, v44, v16
    v_mul_f32 v45, v45, v17
    v_mfma_f32_16x16x32_bf16 v[24:27], a[68:71], v[72:75], v[24:27]
    ds_read_b128 v[72:75], v2 offset:36864
    buffer_load_dwordx4 v[104:107], v10, s[44:47], s31 offen offset:2048 sc1
    v_mfma_f32_16x16x32_bf16 v[24:27], a[76:79], v[76:79], v[24:27]
    s_waitcnt lgkmcnt(5)
    ds_read_b128 v[76:79], v2 offset:37888
    v_cvt_pk_bf16_f32 v52, v44, v45
    v_mfma_f32_16x16x32_bf16 v[20:23], a[80:83], v[80:83], v[20:23]
    v_exp_f32 v46, v46
    v_mfma_f32_16x16x32_bf16 v[20:23], a[88:91], v[84:87], v[20:23]
    v_exp_f32 v47, v47
    v_mfma_f32_16x16x32_bf16 v[24:27], a[84:87], v[80:83], v[24:27]
    ds_read_b128 v[80:83], v2 offset:38912
    buffer_load_dwordx4 v[108:111], v10, s[44:47], s31 offen offset:3072 sc1
    v_mfma_f32_16x16x32_bf16 v[24:27], a[92:95], v[84:87], v[24:27]
    s_waitcnt lgkmcnt(5)
    ds_read_b128 v[84:87], v2 offset:39936
    v_add_f32 v46, 1.0, v46
    v_mfma_f32_16x16x32_bf16 v[20:23], a[96:99], v[56:59], v[20:23]
    s_add_u32 s31, s72, 4096
    v_add_f32 v47, 1.0, v47
    v_mfma_f32_16x16x32_bf16 v[20:23], a[104:107], v[60:63], v[20:23]
    v_rcp_f32 v46, v46
    v_mfma_f32_16x16x32_bf16 v[24:27], a[100:103], v[56:59], v[24:27]
    buffer_load_dwordx4 v[112:115], v10, s[44:47], s31 offen offset:0 sc1
    v_mfma_f32_16x16x32_bf16 v[24:27], a[108:111], v[60:63], v[24:27]
    s_waitcnt lgkmcnt(4)
    v_rcp_f32 v47, v47
    v_mfma_f32_16x16x32_bf16 v[20:23], a[112:115], v[64:67], v[20:23]
    v_mul_f32 v46, v46, v18
    v_mul_f32 v47, v47, v19
    v_mfma_f32_16x16x32_bf16 v[20:23], a[120:123], v[68:71], v[20:23]
    v_cvt_pk_bf16_f32 v53, v46, v47
    v_mfma_f32_16x16x32_bf16 v[24:27], a[116:119], v[64:67], v[24:27]
    s_waitcnt vmcnt(5) lgkmcnt(0)
    s_barrier
    ds_read_b128 v[56:59], v3 offset:0
    v_mfma_f32_16x16x32_bf16 v[24:27], a[124:127], v[68:71], v[24:27]
    ds_read_b128 v[60:63], v3 offset:1024
    buffer_load_dwordx4 v[116:119], v10, s[44:47], s31 offen offset:1024 sc1
    v_mfma_f32_16x16x32_bf16 v[20:23], a[128:131], v[72:75], v[20:23]
    s_cmp_lg_u64 s[6:7], s[4:5]
    s_cbranch_scc1 L_g1l2r
L_g1l2b:
    ds_read_b128 v[64:67], v3 offset:2048
    v_mfma_f32_16x16x32_bf16 v[20:23], a[136:139], v[76:79], v[20:23]
    s_add_u32 m0, s71, 81920
    ds_read_b128 v[68:71], v3 offset:3072
    v_mfma_f32_16x16x32_bf16 v[24:27], a[132:135], v[72:75], v[24:27]
    s_add_u32 s55, s50, 655360
    ds_read_b128 v[72:75], v3 offset:4096
    buffer_load_dwordx4 v10, s[44:47], s55 offen offset:0 sc1 lds
    v_mfma_f32_16x16x32_bf16 v[24:27], a[140:143], v[76:79], v[24:27]
    ds_read_b128 v[76:79], v3 offset:5120
    v_mfma_f32_16x16x32_bf16 v[20:23], a[144:147], v[80:83], v[20:23]
    v_mfma_f32_16x16x32_bf16 v[20:23], a[152:155], v[84:87], v[20:23]
    v_mfma_f32_16x16x32_bf16 v[24:27], a[148:151], v[80:83], v[24:27]
    buffer_load_dwordx4 v10, s[44:47], s55 offen offset:1024 sc1 lds
    v_mfma_f32_16x16x32_bf16 v[24:27], a[156:159], v[84:87], v[24:27]
    s_waitcnt lgkmcnt(4)
    ds_read_b128 v[80:83], v3 offset:6144
    v_mfma_f32_16x16x32_bf16 v[28:31], a[0:3], v[56:59], 0
    ds_read_b128 v[84:87], v3 offset:7168
    v_mfma_f32_16x16x32_bf16 v[28:31], a[8:11], v[60:63], v[28:31]
    v_mfma_f32_16x16x32_bf16 v[32:35], a[4:7], v[56:59], 0
    ds_read_b128 v[56:59], v3 offset:8192
    buffer_load_dwordx4 v10, s[44:47], s55 offen offset:2048 sc1 lds
    v_mfma_f32_16x16x32_bf16 v[32:35], a[12:15], v[60:63], v[32:35]
    s_waitcnt lgkmcnt(5)
    ds_read_b128 v[60:63], v3 offset:9216
    v_mul_f32 v48, s52, v20
    v_mfma_f32_16x16x32_bf16 v[28:31], a[16:19], v[64:67], v[28:31]
    v_mul_f32 v49, s52, v21
    v_mfma_f32_16x16x32_bf16 v[28:31], a[24:27], v[68:71], v[28:31]
    v_exp_f32 v48, v48
    v_mfma_f32_16x16x32_bf16 v[32:35], a[20:23], v[64:67], v[32:35]
    ds_read_b128 v[64:67], v3 offset:10240
    buffer_load_dwordx4 v10, s[44:47], s55 offen offset:3072 sc1 lds
    v_mfma_f32_16x16x32_bf16 v[32:35], a[28:31], v[68:71], v[32:35]
    s_waitcnt lgkmcnt(5)
    ds_read_b128 v[68:71], v3 offset:11264
    v_mul_f32 v50, s52, v22
    v_mfma_f32_16x16x32_bf16 v[28:31], a[32:35], v[72:75], v[28:31]
    s_add_u32 m0, s71, 86016
    v_exp_f32 v49, v49
    v_mfma_f32_16x16x32_bf16 v[28:31], a[40:43], v[76:79], v[28:31]
    s_add_u32 s55, s50, 659456
    v_add_f32 v48, 1.0, v48
    v_add_f32 v49, 1.0, v49
    v_mfma_f32_16x16x32_bf16 v[32:35], a[36:39], v[72:75], v[32:35]
    ds_read_b128 v[72:75], v3 offset:12288
    buffer_load_dwordx4 v10, s[44:47], s55 offen offset:0 sc1 lds
    v_mfma_f32_16x16x32_bf16 v[32:35], a[44:47], v[76:79], v[32:35]
    s_waitcnt lgkmcnt(5)
    ds_read_b128 v[76:79], v3 offset:13312
    v_mul_f32 v51, s52, v23
    v_mfma_f32_16x16x32_bf16 v[28:31], a[48:51], v[80:83], v[28:31]
    v_rcp_f32 v48, v48
    v_mfma_f32_16x16x32_bf16 v[28:31], a[56:59], v[84:87], v[28:31]
    v_rcp_f32 v49, v49
    v_mfma_f32_16x16x32_bf16 v[32:35], a[52:55], v[80:83], v[32:35]
    ds_read_b128 v[80:83], v3 offset:14336
    buffer_load_dwordx4 v10, s[44:47], s55 offen offset:1024 sc1 lds
    v_mfma_f32_16x16x32_bf16 v[32:35], a[60:63], v[84:87], v[32:35]
    s_waitcnt lgkmcnt(5)
    ds_read_b128 v[84:87], v3 offset:15360
    v_mul_f32 v48, v48, v24
    v_mfma_f32_16x16x32_bf16 v[28:31], a[64:67], v[56:59], v[28:31]
    v_mul_f32 v49, v49, v25
    v_cvt_pk_bf16_f32 v54, v48, v49
    v_mfma_f32_16x16x32_bf16 v[28:31], a[72:75], v[60:63], v[28:31]
    v_exp_f32 v50, v50
    v_mfma_f32_16x16x32_bf16 v[32:35], a[68:71], v[56:59], v[32:35]
    ds_read_b128 v[56:59], v3 offset:16384
    buffer_load_dwordx4 v10, s[44:47], s55 offen offset:2048 sc1 lds
    v_mfma_f32_16x16x32_bf16 v[32:35], a[76:79], v[60:63], v[32:35]
    s_waitcnt lgkmcnt(5)
    ds_read_b128 v[60:63], v3 offset:17408
    v_mfma_f32_16x16x32_bf16 v[28:31], a[80:83], v[64:67], v[28:31]
    v_exp_f32 v51, v51
    v_mfma_f32_16x16x32_bf16 v[28:31], a[88:91], v[68:71], v[28:31]
    v_add_f32 v50, 1.0, v50
    v_add_f32 v51, 1.0, v51
    v_mfma_f32_16x16x32_bf16 v[32:35], a[84:87], v[64:67], v[32:35]
    ds_read_b128 v[64:67], v3 offset:18432
    buffer_load_dwordx4 v10, s[44:47], s55 offen offset:3072 sc1 lds
    v_mfma_f32_16x16x32_bf16 v[32:35], a[92:95], v[68:71], v[32:35]
    s_waitcnt lgkmcnt(5)
    ds_read_b128 v[68:71], v3 offset:19456
    v_mfma_f32_16x16x32_bf16 v[28:31], a[96:99], v[72:75], v[28:31]
    s_add_u32 m0, s71, 90112
    v_rcp_f32 v50, v50
    v_mfma_f32_16x16x32_bf16 v[28:31], a[104:107], v[76:79], v[28:31]
    s_add_u32 s55, s50, 663552
    v_rcp_f32 v51, v51
    v_mfma_f32_16x16x32_bf16 v[32:35], a[100:103], v[72:75], v[32:35]
    ds_read_b128 v[72:75], v3 offset:20480
    buffer_load_dwordx4 v10, s[44:47], s55 offen offset:0 sc1 lds
    v_mfma_f32_16x16x32_bf16 v[32:35], a[108:111], v[76:79], v[32:35]
    s_waitcnt lgkmcnt(5)
    ds_read_b128 v[76:79], v3 offset:21504
    v_mul_f32 v50, v50, v26
    v_mfma_f32_16x16x32_bf16 v[28:31], a[112:115], v[80:83], v[28:31]
    v_mul_f32 v51, v51, v27
    v_cvt_pk_bf16_f32 v55, v50, v51
    v_mfma_f32_16x16x32_bf16 v[28:31], a[120:123], v[84:87], v[28:31]
    v_mfma_f32_16x16x32_bf16 v[32:35], a[116:119], v[80:83], v[32:35]
    ds_read_b128 v[80:83], v3 offset:22528
    buffer_load_dwordx4 v10, s[44:47], s55 offen offset:1024 sc1 lds
    v_mfma_f32_16x16x32_bf16 v[32:35], a[124:127], v[84:87], v[32:35]
    s_waitcnt lgkmcnt(5)
    ds_read_b128 v[84:87], v3 offset:23552
    v_mfma_f32_16x16x32_bf16 v[28:31], a[128:131], v[56:59], v[28:31]
    s_add_u32 m0, s71, 0
    v_mfma_f32_16x16x32_bf16 v[28:31], a[136:139], v[60:63], v[28:31]
    s_add_u32 s55, s72, 65536
    v_mfma_f32_16x16x32_bf16 v[32:35], a[132:135], v[56:59], v[32:35]
    ds_read_b128 v[56:59], v3 offset:24576
    buffer_load_dwordx4 v10, s[44:47], s55 offen offset:0 sc1 lds
    v_mfma_f32_16x16x32_bf16 v[32:35], a[140:143], v[60:63], v[32:35]
    s_waitcnt lgkmcnt(5)
    ds_read_b128 v[60:63], v3 offset:25600
    v_mfma_f32_16x16x32_bf16 v[28:31], a[144:147], v[64:67], v[28:31]
    v_permlane16_swap_b32 v52, v54
    v_mfma_f32_16x16x32_bf16 v[28:31], a[152:155], v[68:71], v[28:31]
    v_permlane16_swap_b32 v53, v55
    v_mfma_f32_16x16x32_bf16 v[32:35], a[148:151], v[64:67], v[32:35]
    ds_read_b128 v[64:67], v3 offset:26624
    buffer_load_dwordx4 v6, s[44:47], s55 offen offset:1024 sc1 lds
    v_mfma_f32_16x16x32_bf16 v[32:35], a[156:159], v[68:71], v[32:35]
    s_waitcnt lgkmcnt(5)
    ds_read_b128 v[68:71], v3 offset:27648
    v_mfma_f32_16x16x32_bf16 v[36:39], a[0:3], v[72:75], 0
    v_mfma_f32_16x16x32_bf16 v[36:39], a[8:11], v[76:79], v[36:39]
    v_mfma_f32_16x16x32_bf16 v[40:43], a[4:7], v[72:75], 0
    ds_read_b128 v[72:75], v3 offset:28672
    buffer_load_dwordx4 v6, s[44:47], s55 offen offset:2048 sc1 lds
    v_mfma_f32_16x16x32_bf16 v[40:43], a[12:15], v[76:79], v[40:43]
    s_waitcnt lgkmcnt(5)
    ds_read_b128 v[76:79], v3 offset:29696
    v_mfma_f32_16x16x32_bf16 v[36:39], a[16:19], v[80:83], v[36:39]
    v_mfma_f32_16x16x32_bf16 v[36:39], a[24:27], v[84:87], v[36:39]
    v_mul_f32 v44, s52, v28
    v_mul_f32 v45, s52, v29
    v_mfma_f32_16x16x32_bf16 v[40:43], a[20:23], v[80:83], v[40:43]
    s_buffer_load_dword s8, s[44:47], s53 offset:98304
    ds_read_b128 v[80:83], v3 offset:30720
    buffer_load_dwordx4 v6, s[44:47], s55 offen offset:3072 sc1 lds
    v_mfma_f32_16x16x32_bf16 v[40:43], a[28:31], v[84:87], v[40:43]
    s_waitcnt lgkmcnt(5)
    ds_read_b128 v[84:87], v3 offset:31744
    s_buffer_load_dword s9, s[44:47], s53 offset:99328
    v_mfma_f32_16x16x32_bf16 v[36:39], a[32:35], v[56:59], v[36:39]
    s_add_u32 m0, s71, 4096
    v_exp_f32 v44, v44
    v_mfma_f32_16x16x32_bf16 v[36:39], a[40:43], v[60:63], v[36:39]
    s_add_u32 s55, s72, 69632
    v_exp_f32 v45, v45
    v_mfma_f32_16x16x32_bf16 v[40:43], a[36:39], v[56:59], v[40:43]
    ds_read_b128 v[56:59], v3 offset:32768
    buffer_load_dwordx4 v6, s[44:47], s55 offen offset:0 sc1 lds
    v_mfma_f32_16x16x32_bf16 v[40:43], a[44:47], v[60:63], v[40:43]
    s_waitcnt lgkmcnt(5)
    ds_read_b128 v[60:63], v3 offset:33792
    v_add_f32 v44, 1.0, v44
    v_mfma_f32_16x16x32_bf16 v[36:39], a[48:51], v[64:67], v[36:39]
    v_add_f32 v45, 1.0, v45
    v_mul_f32 v46, s52, v30
    v_mfma_f32_16x16x32_bf16 v[36:39], a[56:59], v[68:71], v[36:39]
    v_rcp_f32 v44, v44
    v_mfma_f32_16x16x32_bf16 v[40:43], a[52:55], v[64:67], v[40:43]
    ds_read_b128 v[64:67], v3 offset:34816
    buffer_load_dwordx4 v6, s[44:47], s55 offen offset:1024 sc1 lds
    v_mfma_f32_16x16x32_bf16 v[40:43], a[60:63], v[68:71], v[40:43]
    s_waitcnt lgkmcnt(5)
    ds_read_b128 v[68:71], v3 offset:35840
    v_mul_f32 v47, s52, v31
    v_mfma_f32_16x16x32_bf16 v[36:39], a[64:67], v[72:75], v[36:39]
    v_rcp_f32 v45, v45
    v_mfma_f32_16x16x32_bf16 v[36:39], a[72:75], v[76:79], v[36:39]
    v_mul_f32 v44, v44, v32
    v_mul_f32 v45, v45, v33
    v_mfma_f32_16x16x32_bf16 v[40:43], a[68:71], v[72:75], v[40:43]
    ds_read_b128 v[72:75], v3 offset:36864
    buffer_load_dwordx4 v[120:123], v10, s[44:47], s31 offen offset:2048 sc1
    v_mfma_f32_16x16x32_bf16 v[40:43], a[76:79], v[76:79], v[40:43]
    s_waitcnt lgkmcnt(5)
    ds_read_b128 v[76:79], v3 offset:37888
    v_cvt_pk_bf16_f32 v92, v44, v45
    v_mfma_f32_16x16x32_bf16 v[36:39], a[80:83], v[80:83], v[36:39]
    v_exp_f32 v46, v46
    v_mfma_f32_16x16x32_bf16 v[36:39], a[88:91], v[84:87], v[36:39]
    v_exp_f32 v47, v47
    v_mfma_f32_16x16x32_bf16 v[40:43], a[84:87], v[80:83], v[40:43]
    ds_read_b128 v[80:83], v3 offset:38912
    buffer_load_dwordx4 v[124:127], v10, s[44:47], s31 offen offset:3072 sc1
    v_mfma_f32_16x16x32_bf16 v[40:43], a[92:95], v[84:87], v[40:43]
    s_waitcnt lgkmcnt(5)
    ds_read_b128 v[84:87], v3 offset:39936
    v_add_f32 v46, 1.0, v46
    v_mfma_f32_16x16x32_bf16 v[36:39], a[96:99], v[56:59], v[36:39]
    s_add_u32 s31, s72, 8192
    v_add_f32 v47, 1.0, v47
    v_mfma_f32_16x16x32_bf16 v[36:39], a[104:107], v[60:63], v[36:39]
    v_rcp_f32 v46, v46
    v_mfma_f32_16x16x32_bf16 v[40:43], a[100:103], v[56:59], v[40:43]
    buffer_load_dwordx4 v[128:131], v10, s[44:47], s31 offen offset:0 sc1
    v_mfma_f32_16x16x32_bf16 v[40:43], a[108:111], v[60:63], v[40:43]
    s_waitcnt lgkmcnt(4)
    v_rcp_f32 v47, v47
    v_mfma_f32_16x16x32_bf16 v[36:39], a[112:115], v[64:67], v[36:39]
    v_mul_f32 v46, v46, v34
    v_mul_f32 v47, v47, v35
    v_mfma_f32_16x16x32_bf16 v[36:39], a[120:123], v[68:71], v[36:39]
    v_cvt_pk_bf16_f32 v93, v46, v47
    v_mfma_f32_16x16x32_bf16 v[40:43], a[116:119], v[64:67], v[40:43]
    s_waitcnt vmcnt(9) lgkmcnt(0)
    s_barrier
    ds_read_b128 v[56:59], v4 offset:0
    v_mfma_f32_16x16x32_bf16 v[40:43], a[124:127], v[68:71], v[40:43]
    ds_read_b128 v[60:63], v4 offset:1024
    buffer_load_dwordx4 v[132:135], v10, s[44:47], s31 offen offset:1024 sc1
    v_mfma_f32_16x16x32_bf16 v[36:39], a[128:131], v[72:75], v[36:39]
    s_cmp_lg_u64 s[8:9], s[4:5]
    s_cbranch_scc1 L_g1l3r
L_g1l3b:
    ds_read_b128 v[64:67], v4 offset:2048
    v_mfma_f32_16x16x32_bf16 v[36:39], a[136:139], v[76:79], v[36:39]
    s_add_u32 m0, s71, 122880
    ds_read_b128 v[68:71], v4 offset:3072
    v_mfma_f32_16x16x32_bf16 v[40:43], a[132:135], v[72:75], v[40:43]
    s_add_u32 s55, s50, 983040
    ds_read_b128 v[72:75], v4 offset:4096
    buffer_load_dwordx4 v10, s[44:47], s55 offen offset:0 sc1 lds
    v_mfma_f32_16x16x32_bf16 v[40:43], a[140:143], v[76:79], v[40:43]
    ds_read_b128 v[76:79], v4 offset:5120
    v_mfma_f32_16x16x32_bf16 v[36:39], a[144:147], v[80:83], v[36:39]
    v_mfma_f32_16x16x32_bf16 v[36:39], a[152:155], v[84:87], v[36:39]
    v_mfma_f32_16x16x32_bf16 v[40:43], a[148:151], v[80:83], v[40:43]
    buffer_load_dwordx4 v10, s[44:47], s55 offen offset:1024 sc1 lds
    v_mfma_f32_16x16x32_bf16 v[40:43], a[156:159], v[84:87], v[40:43]
    s_waitcnt lgkmcnt(4)
    ds_read_b128 v[80:83], v4 offset:6144
    v_mfma_f32_16x16x32_bf16 v[12:15], a[0:3], v[56:59], 0
    ds_read_b128 v[84:87], v4 offset:7168
    v_mfma_f32_16x16x32_bf16 v[12:15], a[8:11], v[60:63], v[12:15]
    v_mfma_f32_16x16x32_bf16 v[16:19], a[4:7], v[56:59], 0
    ds_read_b128 v[56:59], v4 offset:8192
    buffer_load_dwordx4 v10, s[44:47], s55 offen offset:2048 sc1 lds
    v_mfma_f32_16x16x32_bf16 v[16:19], a[12:15], v[60:63], v[16:19]
    s_waitcnt lgkmcnt(5)
    ds_read_b128 v[60:63], v4 offset:9216
    v_mul_f32 v48, s52, v36
    v_mfma_f32_16x16x32_bf16 v[12:15], a[16:19], v[64:67], v[12:15]
    v_mul_f32 v49, s52, v37
    v_mfma_f32_16x16x32_bf16 v[12:15], a[24:27], v[68:71], v[12:15]
    v_exp_f32 v48, v48
    v_mfma_f32_16x16x32_bf16 v[16:19], a[20:23], v[64:67], v[16:19]
    ds_read_b128 v[64:67], v4 offset:10240
    buffer_load_dwordx4 v10, s[44:47], s55 offen offset:3072 sc1 lds
    v_mfma_f32_16x16x32_bf16 v[16:19], a[28:31], v[68:71], v[16:19]
    s_waitcnt lgkmcnt(5)
    ds_read_b128 v[68:71], v4 offset:11264
    v_mul_f32 v50, s52, v38
    v_mfma_f32_16x16x32_bf16 v[12:15], a[32:35], v[72:75], v[12:15]
    s_add_u32 m0, s71, 126976
    v_exp_f32 v49, v49
    v_mfma_f32_16x16x32_bf16 v[12:15], a[40:43], v[76:79], v[12:15]
    s_add_u32 s55, s50, 987136
    v_add_f32 v48, 1.0, v48
    v_add_f32 v49, 1.0, v49
    v_mfma_f32_16x16x32_bf16 v[16:19], a[36:39], v[72:75], v[16:19]
    ds_read_b128 v[72:75], v4 offset:12288
    buffer_load_dwordx4 v10, s[44:47], s55 offen offset:0 sc1 lds
    v_mfma_f32_16x16x32_bf16 v[16:19], a[44:47], v[76:79], v[16:19]
    s_waitcnt lgkmcnt(5)
    ds_read_b128 v[76:79], v4 offset:13312
    v_mul_f32 v51, s52, v39
    v_mfma_f32_16x16x32_bf16 v[12:15], a[48:51], v[80:83], v[12:15]
    v_rcp_f32 v48, v48
    v_mfma_f32_16x16x32_bf16 v[12:15], a[56:59], v[84:87], v[12:15]
    v_rcp_f32 v49, v49
    v_mfma_f32_16x16x32_bf16 v[16:19], a[52:55], v[80:83], v[16:19]
    ds_read_b128 v[80:83], v4 offset:14336
    buffer_load_dwordx4 v10, s[44:47], s55 offen offset:1024 sc1 lds
    v_mfma_f32_16x16x32_bf16 v[16:19], a[60:63], v[84:87], v[16:19]
    s_waitcnt lgkmcnt(5)
    ds_read_b128 v[84:87], v4 offset:15360
    v_mul_f32 v48, v48, v40
    v_mfma_f32_16x16x32_bf16 v[12:15], a[64:67], v[56:59], v[12:15]
    v_mul_f32 v49, v49, v41
    v_cvt_pk_bf16_f32 v94, v48, v49
    v_mfma_f32_16x16x32_bf16 v[12:15], a[72:75], v[60:63], v[12:15]
    v_exp_f32 v50, v50
    v_mfma_f32_16x16x32_bf16 v[16:19], a[68:71], v[56:59], v[16:19]
    ds_read_b128 v[56:59], v4 offset:16384
    buffer_load_dwordx4 v10, s[44:47], s55 offen offset:2048 sc1 lds
    v_mfma_f32_16x16x32_bf16 v[16:19], a[76:79], v[60:63], v[16:19]
    s_waitcnt lgkmcnt(5)
    ds_read_b128 v[60:63], v4 offset:17408
    v_mfma_f32_16x16x32_bf16 v[12:15], a[80:83], v[64:67], v[12:15]
    v_exp_f32 v51, v51
    v_mfma_f32_16x16x32_bf16 v[12:15], a[88:91], v[68:71], v[12:15]
    v_add_f32 v50, 1.0, v50
    v_add_f32 v51, 1.0, v51
    v_mfma_f32_16x16x32_bf16 v[16:19], a[84:87], v[64:67], v[16:19]
    ds_read_b128 v[64:67], v4 offset:18432
    buffer_load_dwordx4 v10, s[44:47], s55 offen offset:3072 sc1 lds
    v_mfma_f32_16x16x32_bf16 v[16:19], a[92:95], v[68:71], v[16:19]
    s_waitcnt lgkmcnt(5)
    ds_read_b128 v[68:71], v4 offset:19456
    v_mfma_f32_16x16x32_bf16 v[12:15], a[96:99], v[72:75], v[12:15]
    s_add_u32 m0, s71, 131072
    v_rcp_f32 v50, v50
    v_mfma_f32_16x16x32_bf16 v[12:15], a[104:107], v[76:79], v[12:15]
    s_add_u32 s55, s50, 991232
    v_rcp_f32 v51, v51
    v_mfma_f32_16x16x32_bf16 v[16:19], a[100:103], v[72:75], v[16:19]
    ds_read_b128 v[72:75], v4 offset:20480
    buffer_load_dwordx4 v10, s[44:47], s55 offen offset:0 sc1 lds
    v_mfma_f32_16x16x32_bf16 v[16:19], a[108:111], v[76:79], v[16:19]
    s_waitcnt lgkmcnt(5)
    ds_read_b128 v[76:79], v4 offset:21504
    v_mul_f32 v50, v50, v42
    v_mfma_f32_16x16x32_bf16 v[12:15], a[112:115], v[80:83], v[12:15]
    v_mul_f32 v51, v51, v43
    v_cvt_pk_bf16_f32 v95, v50, v51
    v_mfma_f32_16x16x32_bf16 v[12:15], a[120:123], v[84:87], v[12:15]
    v_mfma_f32_16x16x32_bf16 v[16:19], a[116:119], v[80:83], v[16:19]
    ds_read_b128 v[80:83], v4 offset:22528
    buffer_load_dwordx4 v10, s[44:47], s55 offen offset:1024 sc1 lds
    v_mfma_f32_16x16x32_bf16 v[16:19], a[124:127], v[84:87], v[16:19]
    s_waitcnt lgkmcnt(5)
    ds_read_b128 v[84:87], v4 offset:23552
    v_mfma_f32_16x16x32_bf16 v[12:15], a[128:131], v[56:59], v[12:15]
    v_mfma_f32_16x16x32_bf16 v[12:15], a[136:139], v[60:63], v[12:15]
    v_mfma_f32_16x16x32_bf16 v[16:19], a[132:135], v[56:59], v[16:19]
    s_buffer_load_dword s6, s[44:47], s53 offset:131072
    ds_read_b128 v[56:59], v4 offset:24576
    buffer_load_dwordx4 v[136:139], v10, s[44:47], s31 offen offset:2048 sc1
    v_mfma_f32_16x16x32_bf16 v[16:19], a[140:143], v[60:63], v[16:19]
    s_waitcnt lgkmcnt(5)
    ds_read_b128 v[60:63], v4 offset:25600
    s_buffer_load_dword s7, s[44:47], s53 offset:132096
    v_mfma_f32_16x16x32_bf16 v[12:15], a[144:147], v[64:67], v[12:15]
    v_permlane16_swap_b32 v92, v94
    v_mfma_f32_16x16x32_bf16 v[12:15], a[152:155], v[68:71], v[12:15]
    v_permlane16_swap_b32 v93, v95
    v_mfma_f32_16x16x32_bf16 v[16:19], a[148:151], v[64:67], v[16:19]
    ds_read_b128 v[64:67], v4 offset:26624
    buffer_load_dwordx4 v[140:143], v10, s[44:47], s31 offen offset:3072 sc1
    v_mfma_f32_16x16x32_bf16 v[16:19], a[156:159], v[68:71], v[16:19]
    s_waitcnt lgkmcnt(5)
    ds_read_b128 v[68:71], v4 offset:27648
    v_mfma_f32_16x16x32_bf16 v[20:23], a[0:3], v[72:75], 0
    s_add_u32 s31, s72, 12288
    v_mfma_f32_16x16x32_bf16 v[20:23], a[8:11], v[76:79], v[20:23]
    v_mfma_f32_16x16x32_bf16 v[24:27], a[4:7], v[72:75], 0
    ds_read_b128 v[72:75], v4 offset:28672
    buffer_load_dwordx4 v[144:147], v10, s[44:47], s31 offen offset:0 sc1
    v_mfma_f32_16x16x32_bf16 v[24:27], a[12:15], v[76:79], v[24:27]
    s_waitcnt lgkmcnt(5)
    ds_read_b128 v[76:79], v4 offset:29696
    v_mfma_f32_16x16x32_bf16 v[20:23], a[16:19], v[80:83], v[20:23]
    v_mfma_f32_16x16x32_bf16 v[20:23], a[24:27], v[84:87], v[20:23]
    v_mfma_f32_16x16x32_bf16 v[24:27], a[20:23], v[80:83], v[24:27]
    ds_read_b128 v[80:83], v4 offset:30720
    buffer_load_dwordx4 v[148:151], v10, s[44:47], s31 offen offset:1024 sc1
    v_mfma_f32_16x16x32_bf16 v[24:27], a[28:31], v[84:87], v[24:27]
    s_waitcnt lgkmcnt(5)
    ds_read_b128 v[84:87], v4 offset:31744
    v_mfma_f32_16x16x32_bf16 v[20:23], a[32:35], v[56:59], v[20:23]
    v_mfma_f32_16x16x32_bf16 v[20:23], a[40:43], v[60:63], v[20:23]
    v_mfma_f32_16x16x32_bf16 v[24:27], a[36:39], v[56:59], v[24:27]
    ds_read_b128 v[56:59], v4 offset:32768
    buffer_load_dwordx4 v[152:155], v10, s[44:47], s31 offen offset:2048 sc1
    v_mfma_f32_16x16x32_bf16 v[24:27], a[44:47], v[60:63], v[24:27]
    s_waitcnt lgkmcnt(5)
    ds_read_b128 v[60:63], v4 offset:33792
    v_mfma_f32_16x16x32_bf16 v[20:23], a[48:51], v[64:67], v[20:23]
    v_mfma_f32_16x16x32_bf16 v[20:23], a[56:59], v[68:71], v[20:23]
    v_mfma_f32_16x16x32_bf16 v[24:27], a[52:55], v[64:67], v[24:27]
    ds_read_b128 v[64:67], v4 offset:34816
    buffer_load_dwordx4 v[156:159], v10, s[44:47], s31 offen offset:3072 sc1
    v_mfma_f32_16x16x32_bf16 v[24:27], a[60:63], v[68:71], v[24:27]
    s_waitcnt lgkmcnt(5)
    ds_read_b128 v[68:71], v4 offset:35840
    v_mfma_f32_16x16x32_bf16 v[20:23], a[64:67], v[72:75], v[20:23]
    s_add_u32 s31, s72, 16384
    v_mfma_f32_16x16x32_bf16 v[20:23], a[72:75], v[76:79], v[20:23]
    v_mfma_f32_16x16x32_bf16 v[24:27], a[68:71], v[72:75], v[24:27]
    ds_read_b128 v[72:75], v4 offset:36864
    buffer_load_dwordx4 v[160:163], v10, s[44:47], s31 offen offset:0 sc1
    v_mfma_f32_16x16x32_bf16 v[24:27], a[76:79], v[76:79], v[24:27]
    s_waitcnt lgkmcnt(5)
    ds_read_b128 v[76:79], v4 offset:37888
    v_mfma_f32_16x16x32_bf16 v[20:23], a[80:83], v[80:83], v[20:23]
    v_mfma_f32_16x16x32_bf16 v[20:23], a[88:91], v[84:87], v[20:23]
    v_mfma_f32_16x16x32_bf16 v[24:27], a[84:87], v[80:83], v[24:27]
    ds_read_b128 v[80:83], v4 offset:38912
    buffer_load_dwordx4 v[164:167], v10, s[44:47], s31 offen offset:1024 sc1
    v_mfma_f32_16x16x32_bf16 v[24:27], a[92:95], v[84:87], v[24:27]
    s_waitcnt lgkmcnt(5)
    ds_read_b128 v[84:87], v4 offset:39936
    v_mfma_f32_16x16x32_bf16 v[20:23], a[96:99], v[56:59], v[20:23]
    v_mfma_f32_16x16x32_bf16 v[20:23], a[104:107], v[60:63], v[20:23]
    v_mfma_f32_16x16x32_bf16 v[24:27], a[100:103], v[56:59], v[24:27]
    v_mfma_f32_16x16x32_bf16 v[24:27], a[108:111], v[60:63], v[24:27]
    s_waitcnt lgkmcnt(4)
    v_mfma_f32_16x16x32_bf16 v[20:23], a[112:115], v[64:67], v[20:23]
    v_mfma_f32_16x16x32_bf16 v[20:23], a[120:123], v[68:71], v[20:23]
    s_add_u32 s56, s51, 0
    v_mfma_f32_16x16x32_bf16 v[24:27], a[116:119], v[64:67], v[24:27]
    s_waitcnt vmcnt(8) lgkmcnt(0)
    s_barrier
    ds_read_b128 v[56:59], v2 offset:0
    v_mfma_f32_16x16x32_bf16 v[24:27], a[124:127], v[68:71], v[24:27]
    ds_read_b128 v[60:63], v2 offset:1024
    buffer_load_dwordx4 v[168:171], v10, s[44:47], s31 offen offset:2048 sc1
    v_mfma_f32_16x16x32_bf16 v[20:23], a[128:131], v[72:75], v[20:23]
    s_cmp_lg_u64 s[6:7], s[4:5]
    s_cbranch_scc1 L_g1l4r
L_g1l4b:
    ds_read_b128 v[64:67], v2 offset:2048
    v_mfma_f32_16x16x32_bf16 v[20:23], a[136:139], v[76:79], v[20:23]
    ds_read_b128 v[68:71], v2 offset:3072
    v_mfma_f32_16x16x32_bf16 v[24:27], a[132:135], v[72:75], v[24:27]
    ds_read_b128 v[72:75], v2 offset:4096
    v_mfma_f32_16x16x32_bf16 v[24:27], a[140:143], v[76:79], v[24:27]
    ds_read_b128 v[76:79], v2 offset:5120
    v_mfma_f32_16x16x32_bf16 v[20:23], a[144:147], v[80:83], v[20:23]
    buffer_store_dwordx4 v[52:55], v5, s[44:47], s56 offen sc1
    s_add_u32 s56, s51, 884736
    buffer_store_dwordx4 v[92:95], v5, s[44:47], s56 offen sc1
    v_mfma_f32_16x16x32_bf16 v[20:23], a[152:155], v[84:87], v[20:23]
    v_mfma_f32_16x16x32_bf16 v[24:27], a[148:151], v[80:83], v[24:27]
    v_mfma_f32_16x16x32_bf16 v[24:27], a[156:159], v[84:87], v[24:27]
    s_waitcnt lgkmcnt(4)
    ds_read_b128 v[80:83], v2 offset:6144
    v_mfma_f32_16x16x32_bf16 v[28:31], a[0:3], v[56:59], 0
    s_add_u32 m0, s71, 40960
    ds_read_b128 v[84:87], v2 offset:7168
    v_mfma_f32_16x16x32_bf16 v[28:31], a[8:11], v[60:63], v[28:31]
    s_add_u32 s55, s50, 1310720
    v_mfma_f32_16x16x32_bf16 v[32:35], a[4:7], v[56:59], 0
    ds_read_b128 v[56:59], v2 offset:8192
    buffer_load_dwordx4 v10, s[44:47], s55 offen offset:0 sc1 lds
    v_mfma_f32_16x16x32_bf16 v[32:35], a[12:15], v[60:63], v[32:35]
    s_waitcnt lgkmcnt(5)
    ds_read_b128 v[60:63], v2 offset:9216
    v_mul_f32 v44, s52, v12
    v_mfma_f32_16x16x32_bf16 v[28:31], a[16:19], v[64:67], v[28:31]
    v_mul_f32 v45, s52, v13
    v_mfma_f32_16x16x32_bf16 v[28:31], a[24:27], v[68:71], v[28:31]
    v_exp_f32 v44, v44
    v_mfma_f32_16x16x32_bf16 v[32:35], a[20:23], v[64:67], v[32:35]
    ds_read_b128 v[64:67], v2 offset:10240
    buffer_load_dwordx4 v10, s[44:47], s55 offen offset:1024 sc1 lds
    v_mfma_f32_16x16x32_bf16 v[32:35], a[28:31], v[68:71], v[32:35]
    s_waitcnt lgkmcnt(5)
    ds_read_b128 v[68:71], v2 offset:11264
    v_mul_f32 v46, s52, v14
    v_mfma_f32_16x16x32_bf16 v[28:31], a[32:35], v[72:75], v[28:31]
    v_exp_f32 v45, v45
    v_mfma_f32_16x16x32_bf16 v[28:31], a[40:43], v[76:79], v[28:31]
    v_add_f32 v44, 1.0, v44
    v_add_f32 v45, 1.0, v45
    v_mfma_f32_16x16x32_bf16 v[32:35], a[36:39], v[72:75], v[32:35]
    ds_read_b128 v[72:75], v2 offset:12288
    buffer_load_dwordx4 v10, s[44:47], s55 offen offset:2048 sc1 lds
    v_mfma_f32_16x16x32_bf16 v[32:35], a[44:47], v[76:79], v[32:35]
    s_waitcnt lgkmcnt(5)
    ds_read_b128 v[76:79], v2 offset:13312
    v_mul_f32 v47, s52, v15
    v_mfma_f32_16x16x32_bf16 v[28:31], a[48:51], v[80:83], v[28:31]
    v_rcp_f32 v44, v44
    v_mfma_f32_16x16x32_bf16 v[28:31], a[56:59], v[84:87], v[28:31]
    v_rcp_f32 v45, v45
    v_mfma_f32_16x16x32_bf16 v[32:35], a[52:55], v[80:83], v[32:35]
    ds_read_b128 v[80:83], v2 offset:14336
    buffer_load_dwordx4 v10, s[44:47], s55 offen offset:3072 sc1 lds
    v_mfma_f32_16x16x32_bf16 v[32:35], a[60:63], v[84:87], v[32:35]
    s_waitcnt lgkmcnt(5)
    ds_read_b128 v[84:87], v2 offset:15360
    v_mul_f32 v44, v44, v16
    v_mfma_f32_16x16x32_bf16 v[28:31], a[64:67], v[56:59], v[28:31]
    s_add_u32 m0, s71, 45056
    v_mul_f32 v45, v45, v17
    v_cvt_pk_bf16_f32 v52, v44, v45
    v_mfma_f32_16x16x32_bf16 v[28:31], a[72:75], v[60:63], v[28:31]
    s_add_u32 s55, s50, 1314816
    v_exp_f32 v46, v46
    v_mfma_f32_16x16x32_bf16 v[32:35], a[68:71], v[56:59], v[32:35]
    ds_read_b128 v[56:59], v2 offset:16384
    buffer_load_dwordx4 v10, s[44:47], s55 offen offset:0 sc1 lds
    v_mfma_f32_16x16x32_bf16 v[32:35], a[76:79], v[60:63], v[32:35]
    s_waitcnt lgkmcnt(5)
    ds_read_b128 v[60:63], v2 offset:17408
    v_mul_f32 v48, s52, v20
    v_mfma_f32_16x16x32_bf16 v[28:31], a[80:83], v[64:67], v[28:31]
    v_exp_f32 v47, v47
    v_mfma_f32_16x16x32_bf16 v[28:31], a[88:91], v[68:71], v[28:31]
    v_add_f32 v46, 1.0, v46
    v_add_f32 v47, 1.0, v47
    v_mfma_f32_16x16x32_bf16 v[32:35], a[84:87], v[64:67], v[32:35]
    ds_read_b128 v[64:67], v2 offset:18432
    buffer_load_dwordx4 v10, s[44:47], s55 offen offset:1024 sc1 lds
    v_mfma_f32_16x16x32_bf16 v[32:35], a[92:95], v[68:71], v[32:35]
    s_waitcnt lgkmcnt(5)
    ds_read_b128 v[68:71], v2 offset:19456
    v_mul_f32 v49, s52, v21
    v_mfma_f32_16x16x32_bf16 v[28:31], a[96:99], v[72:75], v[28:31]
    v_rcp_f32 v46, v46
    v_mfma_f32_16x16x32_bf16 v[28:31], a[104:107], v[76:79], v[28:31]
    v_rcp_f32 v47, v47
    v_mfma_f32_16x16x32_bf16 v[32:35], a[100:103], v[72:75], v[32:35]
    ds_read_b128 v[72:75], v2 offset:20480
    buffer_load_dwordx4 v10, s[44:47], s55 offen offset:2048 sc1 lds
    v_mfma_f32_16x16x32_bf16 v[32:35], a[108:111], v[76:79], v[32:35]
    s_waitcnt lgkmcnt(5)
    ds_read_b128 v[76:79], v2 offset:21504
    v_mul_f32 v46, v46, v18
    v_mfma_f32_16x16x32_bf16 v[28:31], a[112:115], v[80:83], v[28:31]
    v_mul_f32 v47, v47, v19
    v_cvt_pk_bf16_f32 v53, v46, v47
    v_mfma_f32_16x16x32_bf16 v[28:31], a[120:123], v[84:87], v[28:31]
    v_exp_f32 v48, v48
    v_mfma_f32_16x16x32_bf16 v[32:35], a[116:119], v[80:83], v[32:35]
    ds_read_b128 v[80:83], v2 offset:22528
    buffer_load_dwordx4 v10, s[44:47], s55 offen offset:3072 sc1 lds
    v_mfma_f32_16x16x32_bf16 v[32:35], a[124:127], v[84:87], v[32:35]
    s_waitcnt lgkmcnt(5)
    ds_read_b128 v[84:87], v2 offset:23552
    v_mul_f32 v50, s52, v22
    v_mfma_f32_16x16x32_bf16 v[28:31], a[128:131], v[56:59], v[28:31]
    s_add_u32 m0, s71, 49152
    v_exp_f32 v49, v49
    v_mfma_f32_16x16x32_bf16 v[28:31], a[136:139], v[60:63], v[28:31]
    s_add_u32 s55, s50, 1318912
    v_add_f32 v48, 1.0, v48
    v_add_f32 v49, 1.0, v49
    v_mfma_f32_16x16x32_bf16 v[32:35], a[132:135], v[56:59], v[32:35]
    s_buffer_load_dword s8, s[44:47], s53 offset:163840
    ds_read_b128 v[56:59], v2 offset:24576
    buffer_load_dwordx4 v10, s[44:47], s55 offen offset:0 sc1 lds
    v_mfma_f32_16x16x32_bf16 v[32:35], a[140:143], v[60:63], v[32:35]
    s_waitcnt lgkmcnt(5)
    ds_read_b128 v[60:63], v2 offset:25600
    s_buffer_load_dword s9, s[44:47], s53 offset:164864
    v_mfma_f32_16x16x32_bf16 v[28:31], a[144:147], v[64:67], v[28:31]
    v_rcp_f32 v48, v48
    v_mfma_f32_16x16x32_bf16 v[28:31], a[152:155], v[68:71], v[28:31]
    v_rcp_f32 v49, v49
    v_mfma_f32_16x16x32_bf16 v[32:35], a[148:151], v[64:67], v[32:35]
    ds_read_b128 v[64:67], v2 offset:26624
    buffer_load_dwordx4 v10, s[44:47], s55 offen offset:1024 sc1 lds
    v_mfma_f32_16x16x32_bf16 v[32:35], a[156:159], v[68:71], v[32:35]
    s_waitcnt lgkmcnt(5)
    ds_read_b128 v[68:71], v2 offset:27648
    v_mul_f32 v48, v48, v24
    v_mfma_f32_16x16x32_bf16 v[36:39], a[0:3], v[72:75], 0
    v_mul_f32 v49, v49, v25
    v_cvt_pk_bf16_f32 v54, v48, v49
    v_mfma_f32_16x16x32_bf16 v[36:39], a[8:11], v[76:79], v[36:39]
    v_mul_f32 v51, s52, v23
    v_mfma_f32_16x16x32_bf16 v[40:43], a[4:7], v[72:75], 0
    ds_read_b128 v[72:75], v2 offset:28672
    buffer_load_dwordx4 v[172:175], v10, s[44:47], s31 offen offset:3072 sc1
    v_mfma_f32_16x16x32_bf16 v[40:43], a[12:15], v[76:79], v[40:43]
    s_waitcnt lgkmcnt(5)
    ds_read_b128 v[76:79], v2 offset:29696
    v_mfma_f32_16x16x32_bf16 v[36:39], a[16:19], v[80:83], v[36:39]
    s_add_u32 s31, s72, 20480
    v_exp_f32 v50, v50
    v_mfma_f32_16x16x32_bf16 v[36:39], a[24:27], v[84:87], v[36:39]
    v_mul_f32 v44, s52, v28
    v_mul_f32 v45, s52, v29
    v_mfma_f32_16x16x32_bf16 v[40:43], a[20:23], v[80:83], v[40:43]
    ds_read_b128 v[80:83], v2 offset:30720
    buffer_load_dwordx4 v[176:179], v10, s[44:47], s31 offen offset:0 sc1
    v_mfma_f32_16x16x32_bf16 v[40:43], a[28:31], v[84:87], v[40:43]
    s_waitcnt lgkmcnt(5)
    ds_read_b128 v[84:87], v2 offset:31744
    v_mul_f32 v46, s52, v30
    v_mfma_f32_16x16x32_bf16 v[36:39], a[32:35], v[56:59], v[36:39]
    v_exp_f32 v44, v44
    v_mfma_f32_16x16x32_bf16 v[36:39], a[40:43], v[60:63], v[36:39]
    v_exp_f32 v45, v45
    v_mfma_f32_16x16x32_bf16 v[40:43], a[36:39], v[56:59], v[40:43]
    ds_read_b128 v[56:59], v2 offset:32768
    buffer_load_dwordx4 v[180:183], v10, s[44:47], s31 offen offset:1024 sc1
    v_mfma_f32_16x16x32_bf16 v[40:43], a[44:47], v[60:63], v[40:43]
    s_waitcnt lgkmcnt(5)
    ds_read_b128 v[60:63], v2 offset:33792
    v_add_f32 v44, 1.0, v44
    v_mfma_f32_16x16x32_bf16 v[36:39], a[48:51], v[64:67], v[36:39]
    v_add_f32 v45, 1.0, v45
    v_mul_f32 v47, s52, v31
    v_mfma_f32_16x16x32_bf16 v[36:39], a[56:59], v[68:71], v[36:39]
    v_rcp_f32 v44, v44
    v_mfma_f32_16x16x32_bf16 v[40:43], a[52:55], v[64:67], v[40:43]
    ds_read_b128 v[64:67], v2 offset:34816
    buffer_load_dwordx4 v[184:187], v10, s[44:47], s31 offen offset:2048 sc1
    v_mfma_f32_16x16x32_bf16 v[40:43], a[60:63], v[68:71], v[40:43]
    s_waitcnt lgkmcnt(5)
    ds_read_b128 v[68:71], v2 offset:35840
    v_mfma_f32_16x16x32_bf16 v[36:39], a[64:67], v[72:75], v[36:39]
    v_rcp_f32 v45, v45
    v_mfma_f32_16x16x32_bf16 v[36:39], a[72:75], v[76:79], v[36:39]
    v_mul_f32 v44, v44, v32
    v_mul_f32 v45, v45, v33
    v_mfma_f32_16x16x32_bf16 v[40:43], a[68:71], v[72:75], v[40:43]
    ds_read_b128 v[72:75], v2 offset:36864
    buffer_load_dwordx4 v[188:191], v10, s[44:47], s31 offen offset:3072 sc1
    v_mfma_f32_16x16x32_bf16 v[40:43], a[76:79], v[76:79], v[40:43]
    s_waitcnt lgkmcnt(5)
    ds_read_b128 v[76:79], v2 offset:37888
    v_exp_f32 v51, v51
    v_add_f32 v50, 1.0, v50
    v_add_f32 v51, 1.0, v51
    v_rcp_f32 v50, v50
    v_rcp_f32 v51, v51
    v_mul_f32 v50, v50, v26
    v_mul_f32 v51, v51, v27
    v_cvt_pk_bf16_f32 v55, v50, v51
    v_mfma_f32_16x16x32_bf16 v[36:39], a[80:83], v[80:83], v[36:39]
    s_add_u32 s31, s72, 24576
    v_permlane16_swap_b32 v52, v54
    v_mfma_f32_16x16x32_bf16 v[36:39], a[88:91], v[84:87], v[36:39]
    v_permlane16_swap_b32 v53, v55
    v_mfma_f32_16x16x32_bf16 v[40:43], a[84:87], v[80:83], v[40:43]
    ds_read_b128 v[80:83], v2 offset:38912
    buffer_load_dwordx4 v[192:195], v10, s[44:47], s31 offen offset:0 sc1
    v_mfma_f32_16x16x32_bf16 v[40:43], a[92:95], v[84:87], v[40:43]
    s_waitcnt lgkmcnt(5)
    ds_read_b128 v[84:87], v2 offset:39936
    v_cvt_pk_bf16_f32 v92, v44, v45
    v_mfma_f32_16x16x32_bf16 v[36:39], a[96:99], v[56:59], v[36:39]
    v_exp_f32 v46, v46
    v_mfma_f32_16x16x32_bf16 v[36:39], a[104:107], v[60:63], v[36:39]
    v_exp_f32 v47, v47
    v_mfma_f32_16x16x32_bf16 v[40:43], a[100:103], v[56:59], v[40:43]
    buffer_load_dwordx4 v[196:199], v10, s[44:47], s31 offen offset:1024 sc1
    v_add_f32 v46, 1.0, v46
    v_mfma_f32_16x16x32_bf16 v[40:43], a[108:111], v[60:63], v[40:43]
    s_waitcnt lgkmcnt(4)
    v_add_f32 v47, 1.0, v47
    v_mfma_f32_16x16x32_bf16 v[36:39], a[112:115], v[64:67], v[36:39]
    v_rcp_f32 v46, v46
    v_mfma_f32_16x16x32_bf16 v[36:39], a[120:123], v[68:71], v[36:39]
    v_rcp_f32 v47, v47
    v_mfma_f32_16x16x32_bf16 v[40:43], a[116:119], v[64:67], v[40:43]
    s_waitcnt vmcnt(7) lgkmcnt(0)
    s_barrier
    ds_read_b128 v[56:59], v3 offset:0
    v_mfma_f32_16x16x32_bf16 v[40:43], a[124:127], v[68:71], v[40:43]
    ds_read_b128 v[60:63], v3 offset:1024
    buffer_load_dwordx4 v[200:203], v10, s[44:47], s31 offen offset:2048 sc1
    v_mfma_f32_16x16x32_bf16 v[36:39], a[128:131], v[72:75], v[36:39]
    s_cmp_lg_u64 s[8:9], s[4:5]
    s_cbranch_scc1 L_g1l5r
L_g1l5b:
    ds_read_b128 v[64:67], v3 offset:2048
    v_mfma_f32_16x16x32_bf16 v[36:39], a[136:139], v[76:79], v[36:39]
    s_add_u32 m0, s71, 81920
    ds_read_b128 v[68:71], v3 offset:3072
    v_mul_f32 v46, v46, v34
    v_mfma_f32_16x16x32_bf16 v[40:43], a[132:135], v[72:75], v[40:43]
    s_add_u32 s55, s50, 1638400
    ds_read_b128 v[72:75], v3 offset:4096
    buffer_load_dwordx4 v10, s[44:47], s55 offen offset:0 sc1 lds
    v_mfma_f32_16x16x32_bf16 v[40:43], a[140:143], v[76:79], v[40:43]
    ds_read_b128 v[76:79], v3 offset:5120
    v_mul_f32 v47, v47, v35
    v_mfma_f32_16x16x32_bf16 v[36:39], a[144:147], v[80:83], v[36:39]
    v_cvt_pk_bf16_f32 v93, v46, v47
    v_mfma_f32_16x16x32_bf16 v[36:39], a[152:155], v[84:87], v[36:39]
    v_mfma_f32_16x16x32_bf16 v[40:43], a[148:151], v[80:83], v[40:43]
    buffer_load_dwordx4 v10, s[44:47], s55 offen offset:1024 sc1 lds
    v_mfma_f32_16x16x32_bf16 v[40:43], a[156:159], v[84:87], v[40:43]
    s_waitcnt lgkmcnt(4)
    ds_read_b128 v[80:83], v3 offset:6144
    v_mfma_f32_16x16x32_bf16 v[12:15], a[0:3], v[56:59], 0
    ds_read_b128 v[84:87], v3 offset:7168
    v_mfma_f32_16x16x32_bf16 v[12:15], a[8:11], v[60:63], v[12:15]
    v_mfma_f32_16x16x32_bf16 v[16:19], a[4:7], v[56:59], 0
    ds_read_b128 v[56:59], v3 offset:8192
    buffer_load_dwordx4 v10, s[44:47], s55 offen offset:2048 sc1 lds
    v_mfma_f32_16x16x32_bf16 v[16:19], a[12:15], v[60:63], v[16:19]
    s_waitcnt lgkmcnt(5)
    ds_read_b128 v[60:63], v3 offset:9216
    v_mul_f32 v48, s52, v36
    v_mfma_f32_16x16x32_bf16 v[12:15], a[16:19], v[64:67], v[12:15]
    v_mul_f32 v49, s52, v37
    v_mfma_f32_16x16x32_bf16 v[12:15], a[24:27], v[68:71], v[12:15]
    v_exp_f32 v48, v48
    v_mfma_f32_16x16x32_bf16 v[16:19], a[20:23], v[64:67], v[16:19]
    ds_read_b128 v[64:67], v3 offset:10240
    buffer_load_dwordx4 v10, s[44:47], s55 offen offset:3072 sc1 lds
    v_mfma_f32_16x16x32_bf16 v[16:19], a[28:31], v[68:71], v[16:19]
    s_waitcnt lgkmcnt(5)
    ds_read_b128 v[68:71], v3 offset:11264
    v_mul_f32 v50, s52, v38
    v_mfma_f32_16x16x32_bf16 v[12:15], a[32:35], v[72:75], v[12:15]
    s_add_u32 m0, s71, 86016
    v_exp_f32 v49, v49
    v_mfma_f32_16x16x32_bf16 v[12:15], a[40:43], v[76:79], v[12:15]
    s_add_u32 s55, s50, 1642496
    v_add_f32 v48, 1.0, v48
    v_add_f32 v49, 1.0, v49
    v_mfma_f32_16x16x32_bf16 v[16:19], a[36:39], v[72:75], v[16:19]
    ds_read_b128 v[72:75], v3 offset:12288
    buffer_load_dwordx4 v10, s[44:47], s55 offen offset:0 sc1 lds
    v_mfma_f32_16x16x32_bf16 v[16:19], a[44:47], v[76:79], v[16:19]
    s_waitcnt lgkmcnt(5)
    ds_read_b128 v[76:79], v3 offset:13312
    v_mul_f32 v51, s52, v39
    v_mfma_f32_16x16x32_bf16 v[12:15], a[48:51], v[80:83], v[12:15]
    v_rcp_f32 v48, v48
    v_mfma_f32_16x16x32_bf16 v[12:15], a[56:59], v[84:87], v[12:15]
    v_rcp_f32 v49, v49
    v_mfma_f32_16x16x32_bf16 v[16:19], a[52:55], v[80:83], v[16:19]
    ds_read_b128 v[80:83], v3 offset:14336
    buffer_load_dwordx4 v10, s[44:47], s55 offen offset:1024 sc1 lds
    v_mfma_f32_16x16x32_bf16 v[16:19], a[60:63], v[84:87], v[16:19]
    s_waitcnt lgkmcnt(5)
    ds_read_b128 v[84:87], v3 offset:15360
    v_mul_f32 v48, v48, v40
    v_mfma_f32_16x16x32_bf16 v[12:15], a[64:67], v[56:59], v[12:15]
    v_mul_f32 v49, v49, v41
    v_cvt_pk_bf16_f32 v94, v48, v49
    v_mfma_f32_16x16x32_bf16 v[12:15], a[72:75], v[60:63], v[12:15]
    v_exp_f32 v50, v50
    v_mfma_f32_16x16x32_bf16 v[16:19], a[68:71], v[56:59], v[16:19]
    ds_read_b128 v[56:59], v3 offset:16384
    buffer_load_dwordx4 v10, s[44:47], s55 offen offset:2048 sc1 lds
    v_mfma_f32_16x16x32_bf16 v[16:19], a[76:79], v[60:63], v[16:19]
    s_waitcnt lgkmcnt(5)
    ds_read_b128 v[60:63], v3 offset:17408
    v_mfma_f32_16x16x32_bf16 v[12:15], a[80:83], v[64:67], v[12:15]
    v_exp_f32 v51, v51
    v_mfma_f32_16x16x32_bf16 v[12:15], a[88:91], v[68:71], v[12:15]
    v_add_f32 v50, 1.0, v50
    v_add_f32 v51, 1.0, v51
    v_mfma_f32_16x16x32_bf16 v[16:19], a[84:87], v[64:67], v[16:19]
    ds_read_b128 v[64:67], v3 offset:18432
    buffer_load_dwordx4 v10, s[44:47], s55 offen offset:3072 sc1 lds
    v_mfma_f32_16x16x32_bf16 v[16:19], a[92:95], v[68:71], v[16:19]
    s_waitcnt lgkmcnt(5)
    ds_read_b128 v[68:71], v3 offset:19456
    v_mfma_f32_16x16x32_bf16 v[12:15], a[96:99], v[72:75], v[12:15]
    s_add_u32 m0, s71, 90112
    v_rcp_f32 v50, v50
    v_mfma_f32_16x16x32_bf16 v[12:15], a[104:107], v[76:79], v[12:15]
    s_add_u32 s55, s50, 1646592
    v_rcp_f32 v51, v51
    v_mfma_f32_16x16x32_bf16 v[16:19], a[100:103], v[72:75], v[16:19]
    ds_read_b128 v[72:75], v3 offset:20480
    buffer_load_dwordx4 v10, s[44:47], s55 offen offset:0 sc1 lds
    v_mfma_f32_16x16x32_bf16 v[16:19], a[108:111], v[76:79], v[16:19]
    s_waitcnt lgkmcnt(5)
    ds_read_b128 v[76:79], v3 offset:21504
    v_mul_f32 v50, v50, v42
    v_mfma_f32_16x16x32_bf16 v[12:15], a[112:115], v[80:83], v[12:15]
    v_mul_f32 v51, v51, v43
    v_cvt_pk_bf16_f32 v95, v50, v51
    v_mfma_f32_16x16x32_bf16 v[12:15], a[120:123], v[84:87], v[12:15]
    v_mfma_f32_16x16x32_bf16 v[16:19], a[116:119], v[80:83], v[16:19]
    ds_read_b128 v[80:83], v3 offset:22528
    buffer_load_dwordx4 v10, s[44:47], s55 offen offset:1024 sc1 lds
    v_mfma_f32_16x16x32_bf16 v[16:19], a[124:127], v[84:87], v[16:19]
    s_waitcnt lgkmcnt(5)
    ds_read_b128 v[84:87], v3 offset:23552
    v_mfma_f32_16x16x32_bf16 v[12:15], a[128:131], v[56:59], v[12:15]
    v_mfma_f32_16x16x32_bf16 v[12:15], a[136:139], v[60:63], v[12:15]
    v_mfma_f32_16x16x32_bf16 v[16:19], a[132:135], v[56:59], v[16:19]
    s_buffer_load_dword s6, s[44:47], s53 offset:196608
    ds_read_b128 v[56:59], v3 offset:24576
    buffer_load_dwordx4 v[204:207], v10, s[44:47], s31 offen offset:3072 sc1
    v_mfma_f32_16x16x32_bf16 v[16:19], a[140:143], v[60:63], v[16:19]
    s_waitcnt lgkmcnt(5)
    ds_read_b128 v[60:63], v3 offset:25600
    s_buffer_load_dword s7, s[44:47], s53 offset:197632
    v_mfma_f32_16x16x32_bf16 v[12:15], a[144:147], v[64:67], v[12:15]
    s_add_u32 s31, s72, 28672
    s_buffer_load_dword s8, s[44:47], s53 offset:229376
    s_buffer_load_dword s9, s[44:47], s53 offset:230400
    v_mfma_f32_16x16x32_bf16 v[12:15], a[152:155], v[68:71], v[12:15]
    v_permlane16_swap_b32 v92, v94
    v_mfma_f32_16x16x32_bf16 v[16:19], a[148:151], v[64:67], v[16:19]
    ds_read_b128 v[64:67], v3 offset:26624
    buffer_load_dwordx4 v[208:211], v10, s[44:47], s31 offen offset:0 sc1
    v_mfma_f32_16x16x32_bf16 v[16:19], a[156:159], v[68:71], v[16:19]
    s_waitcnt lgkmcnt(5)
    ds_read_b128 v[68:71], v3 offset:27648
    v_permlane16_swap_b32 v93, v95
    v_mfma_f32_16x16x32_bf16 v[20:23], a[0:3], v[72:75], 0
    v_mfma_f32_16x16x32_bf16 v[20:23], a[8:11], v[76:79], v[20:23]
    v_mfma_f32_16x16x32_bf16 v[24:27], a[4:7], v[72:75], 0
    ds_read_b128 v[72:75], v3 offset:28672
    buffer_load_dwordx4 v[212:215], v10, s[44:47], s31 offen offset:1024 sc1
    v_mfma_f32_16x16x32_bf16 v[24:27], a[12:15], v[76:79], v[24:27]
    s_waitcnt lgkmcnt(5)
    ds_read_b128 v[76:79], v3 offset:29696
    v_mfma_f32_16x16x32_bf16 v[20:23], a[16:19], v[80:83], v[20:23]
    v_mfma_f32_16x16x32_bf16 v[20:23], a[24:27], v[84:87], v[20:23]
    v_mfma_f32_16x16x32_bf16 v[24:27], a[20:23], v[80:83], v[24:27]
    ds_read_b128 v[80:83], v3 offset:30720
    buffer_load_dwordx4 v[216:219], v10, s[44:47], s31 offen offset:2048 sc1
    v_mfma_f32_16x16x32_bf16 v[24:27], a[28:31], v[84:87], v[24:27]
    s_waitcnt lgkmcnt(5)
    ds_read_b128 v[84:87], v3 offset:31744
    v_mfma_f32_16x16x32_bf16 v[20:23], a[32:35], v[56:59], v[20:23]
    v_mfma_f32_16x16x32_bf16 v[20:23], a[40:43], v[60:63], v[20:23]
    v_mfma_f32_16x16x32_bf16 v[24:27], a[36:39], v[56:59], v[24:27]
    ds_read_b128 v[56:59], v3 offset:32768
    buffer_load_dwordx4 v[220:223], v10, s[44:47], s31 offen offset:3072 sc1
    v_mfma_f32_16x16x32_bf16 v[24:27], a[44:47], v[60:63], v[24:27]
    s_waitcnt lgkmcnt(5)
    ds_read_b128 v[60:63], v3 offset:33792
    v_mfma_f32_16x16x32_bf16 v[20:23], a[48:51], v[64:67], v[20:23]
    s_add_u32 s31, s72, 32768
    v_mfma_f32_16x16x32_bf16 v[20:23], a[56:59], v[68:71], v[20:23]
    v_mfma_f32_16x16x32_bf16 v[24:27], a[52:55], v[64:67], v[24:27]
    ds_read_b128 v[64:67], v3 offset:34816
    buffer_load_dwordx4 v[224:227], v10, s[44:47], s31 offen offset:0 sc1
    v_mfma_f32_16x16x32_bf16 v[24:27], a[60:63], v[68:71], v[24:27]
    s_waitcnt lgkmcnt(5)
    ds_read_b128 v[68:71], v3 offset:35840
    v_mfma_f32_16x16x32_bf16 v[20:23], a[64:67], v[72:75], v[20:23]
    v_mfma_f32_16x16x32_bf16 v[20:23], a[72:75], v[76:79], v[20:23]
    v_mfma_f32_16x16x32_bf16 v[24:27], a[68:71], v[72:75], v[24:27]
    ds_read_b128 v[72:75], v3 offset:36864
    buffer_load_dwordx4 v[228:231], v10, s[44:47], s31 offen offset:1024 sc1
    v_mfma_f32_16x16x32_bf16 v[24:27], a[76:79], v[76:79], v[24:27]
    s_waitcnt lgkmcnt(5)
    ds_read_b128 v[76:79], v3 offset:37888
    v_mfma_f32_16x16x32_bf16 v[20:23], a[80:83], v[80:83], v[20:23]
    v_mfma_f32_16x16x32_bf16 v[20:23], a[88:91], v[84:87], v[20:23]
    v_mfma_f32_16x16x32_bf16 v[24:27], a[84:87], v[80:83], v[24:27]
    ds_read_b128 v[80:83], v3 offset:38912
    buffer_load_dwordx4 v[232:235], v10, s[44:47], s31 offen offset:2048 sc1
    v_mfma_f32_16x16x32_bf16 v[24:27], a[92:95], v[84:87], v[24:27]
    s_waitcnt lgkmcnt(5)
    ds_read_b128 v[84:87], v3 offset:39936
    v_mfma_f32_16x16x32_bf16 v[20:23], a[96:99], v[56:59], v[20:23]
    v_mfma_f32_16x16x32_bf16 v[20:23], a[104:107], v[60:63], v[20:23]
    v_mfma_f32_16x16x32_bf16 v[24:27], a[100:103], v[56:59], v[24:27]
    buffer_load_dwordx4 v[236:239], v10, s[44:47], s31 offen offset:3072 sc1
    v_mfma_f32_16x16x32_bf16 v[24:27], a[108:111], v[60:63], v[24:27]
    s_waitcnt lgkmcnt(4)
    v_mfma_f32_16x16x32_bf16 v[20:23], a[112:115], v[64:67], v[20:23]
    s_add_u32 s31, s72, 36864
    v_mfma_f32_16x16x32_bf16 v[20:23], a[120:123], v[68:71], v[20:23]
    s_add_u32 s56, s51, 1769472
    v_mfma_f32_16x16x32_bf16 v[24:27], a[116:119], v[64:67], v[24:27]
    s_waitcnt vmcnt(9) lgkmcnt(0)
    s_barrier
    ds_read_b128 v[56:59], v4 offset:0
    v_mfma_f32_16x16x32_bf16 v[24:27], a[124:127], v[68:71], v[24:27]
    ds_read_b128 v[60:63], v4 offset:1024
    buffer_load_dwordx4 v[240:243], v10, s[44:47], s31 offen offset:0 sc1
    v_mfma_f32_16x16x32_bf16 v[20:23], a[128:131], v[72:75], v[20:23]
    s_cmp_lg_u64 s[6:7], s[4:5]
    s_cbranch_scc1 L_g1l6r
L_g1l6b:
    ds_read_b128 v[64:67], v4 offset:2048
    v_mfma_f32_16x16x32_bf16 v[20:23], a[136:139], v[76:79], v[20:23]
    s_cmp_lg_u64 s[8:9], s[4:5]
    s_cbranch_scc1 L_g1l7r
L_g1l7b:
    ds_read_b128 v[68:71], v4 offset:3072
    v_mfma_f32_16x16x32_bf16 v[24:27], a[132:135], v[72:75], v[24:27]
    ds_read_b128 v[72:75], v4 offset:4096
    v_mfma_f32_16x16x32_bf16 v[24:27], a[140:143], v[76:79], v[24:27]
    ds_read_b128 v[76:79], v4 offset:5120
    v_mfma_f32_16x16x32_bf16 v[20:23], a[144:147], v[80:83], v[20:23]
    buffer_store_dwordx4 v[52:55], v5, s[44:47], s56 offen sc1
    s_add_u32 s56, s51, 2654208
    buffer_store_dwordx4 v[92:95], v5, s[44:47], s56 offen sc1
    v_mfma_f32_16x16x32_bf16 v[20:23], a[152:155], v[84:87], v[20:23]
    s_add_u32 s57, s54, 0
    buffer_store_dword v11, v9, s[44:47], s57 offen sc1
    v_mfma_f32_16x16x32_bf16 v[24:27], a[148:151], v[80:83], v[24:27]
    s_add_u32 s57, s54, 65536
    buffer_store_dword v11, v9, s[44:47], s57 offen sc1
    v_mfma_f32_16x16x32_bf16 v[24:27], a[156:159], v[84:87], v[24:27]
    s_waitcnt lgkmcnt(4)
    ds_read_b128 v[80:83], v4 offset:6144
    v_mfma_f32_16x16x32_bf16 v[28:31], a[0:3], v[56:59], 0
    s_add_u32 m0, s71, 122880
    ds_read_b128 v[84:87], v4 offset:7168
    v_mfma_f32_16x16x32_bf16 v[28:31], a[8:11], v[60:63], v[28:31]
    s_add_u32 s55, s50, 1966080
    v_mfma_f32_16x16x32_bf16 v[32:35], a[4:7], v[56:59], 0
    ds_read_b128 v[56:59], v4 offset:8192
    buffer_load_dwordx4 v10, s[44:47], s55 offen offset:0 sc1 lds
    v_mfma_f32_16x16x32_bf16 v[32:35], a[12:15], v[60:63], v[32:35]
    s_waitcnt lgkmcnt(5)
    ds_read_b128 v[60:63], v4 offset:9216
    v_mul_f32 v44, s52, v12
    v_mfma_f32_16x16x32_bf16 v[28:31], a[16:19], v[64:67], v[28:31]
    v_mul_f32 v45, s52, v13
    v_mfma_f32_16x16x32_bf16 v[28:31], a[24:27], v[68:71], v[28:31]
    v_exp_f32 v44, v44
    v_mfma_f32_16x16x32_bf16 v[32:35], a[20:23], v[64:67], v[32:35]
    ds_read_b128 v[64:67], v4 offset:10240
    buffer_load_dwordx4 v10, s[44:47], s55 offen offset:1024 sc1 lds
    v_mfma_f32_16x16x32_bf16 v[32:35], a[28:31], v[68:71], v[32:35]
    s_waitcnt lgkmcnt(5)
    ds_read_b128 v[68:71], v4 offset:11264
    v_mul_f32 v46, s52, v14
    v_mfma_f32_16x16x32_bf16 v[28:31], a[32:35], v[72:75], v[28:31]
    v_exp_f32 v45, v45
    v_mfma_f32_16x16x32_bf16 v[28:31], a[40:43], v[76:79], v[28:31]
    v_add_f32 v44, 1.0, v44
    v_add_f32 v45, 1.0, v45
    v_mfma_f32_16x16x32_bf16 v[32:35], a[36:39], v[72:75], v[32:35]
    ds_read_b128 v[72:75], v4 offset:12288
    buffer_load_dwordx4 v10, s[44:47], s55 offen offset:2048 sc1 lds
    v_mfma_f32_16x16x32_bf16 v[32:35], a[44:47], v[76:79], v[32:35]
    s_waitcnt lgkmcnt(5)
    ds_read_b128 v[76:79], v4 offset:13312
    v_mul_f32 v47, s52, v15
    v_mfma_f32_16x16x32_bf16 v[28:31], a[48:51], v[80:83], v[28:31]
    v_rcp_f32 v44, v44
    v_mfma_f32_16x16x32_bf16 v[28:31], a[56:59], v[84:87], v[28:31]
    v_rcp_f32 v45, v45
    v_mfma_f32_16x16x32_bf16 v[32:35], a[52:55], v[80:83], v[32:35]
    ds_read_b128 v[80:83], v4 offset:14336
    buffer_load_dwordx4 v10, s[44:47], s55 offen offset:3072 sc1 lds
    v_mfma_f32_16x16x32_bf16 v[32:35], a[60:63], v[84:87], v[32:35]
    s_waitcnt lgkmcnt(5)
    ds_read_b128 v[84:87], v4 offset:15360
    v_mul_f32 v44, v44, v16
    v_mfma_f32_16x16x32_bf16 v[28:31], a[64:67], v[56:59], v[28:31]
    s_add_u32 m0, s71, 126976
    v_mul_f32 v45, v45, v17
    v_cvt_pk_bf16_f32 v52, v44, v45
    v_mfma_f32_16x16x32_bf16 v[28:31], a[72:75], v[60:63], v[28:31]
    s_add_u32 s55, s50, 1970176
    s_lshr_b32 s59, s76, 1
    s_lshl_b32 s59, s59, 5
    v_mfma_f32_16x16x32_bf16 v[32:35], a[68:71], v[56:59], v[32:35]
    s_lshr_b32 s48, s74, 1
    ds_read_b128 v[56:59], v4 offset:16384
    buffer_load_dwordx4 v10, s[44:47], s55 offen offset:0 sc1 lds
    v_mfma_f32_16x16x32_bf16 v[32:35], a[76:79], v[60:63], v[32:35]
    s_waitcnt lgkmcnt(5)
    ds_read_b128 v[60:63], v4 offset:17408
    s_add_u32 s59, s59, s48
    v_mfma_f32_16x16x32_bf16 v[28:31], a[80:83], v[64:67], v[28:31]
    s_lshl_b32 s59, s59, 1
    s_and_b32 s48, s97, 1
    s_add_u32 s59, s59, s48
    v_mfma_f32_16x16x32_bf16 v[28:31], a[88:91], v[68:71], v[28:31]
    s_lshl_b32 s59, s59, 7
    s_add_u32 s59, s59, 42205184
    v_min_u32 v7, 6, v1
    v_mfma_f32_16x16x32_bf16 v[32:35], a[84:87], v[64:67], v[32:35]
    ds_read_b128 v[64:67], v4 offset:18432
    buffer_load_dwordx4 v10, s[44:47], s55 offen offset:1024 sc1 lds
    v_mfma_f32_16x16x32_bf16 v[32:35], a[92:95], v[68:71], v[32:35]
    s_waitcnt lgkmcnt(5)
    ds_read_b128 v[68:71], v4 offset:19456
    v_lshlrev_b32 v7, 8, v7
    v_mfma_f32_16x16x32_bf16 v[28:31], a[96:99], v[72:75], v[28:31]
    v_exp_f32 v46, v46
    v_mfma_f32_16x16x32_bf16 v[28:31], a[104:107], v[76:79], v[28:31]
    v_exp_f32 v47, v47
    v_mfma_f32_16x16x32_bf16 v[32:35], a[100:103], v[72:75], v[32:35]
    ds_read_b128 v[72:75], v4 offset:20480
    buffer_load_dwordx4 v10, s[44:47], s55 offen offset:2048 sc1 lds
    v_mfma_f32_16x16x32_bf16 v[32:35], a[108:111], v[76:79], v[32:35]
    s_waitcnt lgkmcnt(5)
    ds_read_b128 v[76:79], v4 offset:21504
    v_add_f32 v46, 1.0, v46
    v_mfma_f32_16x16x32_bf16 v[28:31], a[112:115], v[80:83], v[28:31]
    v_add_f32 v47, 1.0, v47
    v_mul_f32 v48, s52, v20
    v_mfma_f32_16x16x32_bf16 v[28:31], a[120:123], v[84:87], v[28:31]
    v_rcp_f32 v46, v46
    v_mfma_f32_16x16x32_bf16 v[32:35], a[116:119], v[80:83], v[32:35]
    ds_read_b128 v[80:83], v4 offset:22528
    buffer_load_dwordx4 v10, s[44:47], s55 offen offset:3072 sc1 lds
    v_mfma_f32_16x16x32_bf16 v[32:35], a[124:127], v[84:87], v[32:35]
    s_waitcnt lgkmcnt(5)
    ds_read_b128 v[84:87], v4 offset:23552
    v_mul_f32 v49, s52, v21
    v_mfma_f32_16x16x32_bf16 v[28:31], a[128:131], v[56:59], v[28:31]
    s_add_u32 m0, s71, 131072
    v_rcp_f32 v47, v47
    v_mfma_f32_16x16x32_bf16 v[28:31], a[136:139], v[60:63], v[28:31]
    s_add_u32 s55, s50, 1974272
    v_mul_f32 v46, v46, v18
    v_mul_f32 v47, v47, v19
    v_mfma_f32_16x16x32_bf16 v[32:35], a[132:135], v[56:59], v[32:35]
    ds_read_b128 v[56:59], v4 offset:24576
    buffer_load_dwordx4 v10, s[44:47], s55 offen offset:0 sc1 lds
    v_mfma_f32_16x16x32_bf16 v[32:35], a[140:143], v[60:63], v[32:35]
    s_waitcnt lgkmcnt(5)
    ds_read_b128 v[60:63], v4 offset:25600
    v_cvt_pk_bf16_f32 v53, v46, v47
    v_mfma_f32_16x16x32_bf16 v[28:31], a[144:147], v[64:67], v[28:31]
    v_exp_f32 v48, v48
    v_mfma_f32_16x16x32_bf16 v[28:31], a[152:155], v[68:71], v[28:31]
    v_exp_f32 v49, v49
    v_mfma_f32_16x16x32_bf16 v[32:35], a[148:151], v[64:67], v[32:35]
    ds_read_b128 v[64:67], v4 offset:26624
    buffer_load_dwordx4 v10, s[44:47], s55 offen offset:1024 sc1 lds
    v_mfma_f32_16x16x32_bf16 v[32:35], a[156:159], v[68:71], v[32:35]
    s_waitcnt lgkmcnt(5)
    ds_read_b128 v[68:71], v4 offset:27648
    v_add_f32 v48, 1.0, v48
    v_mfma_f32_16x16x32_bf16 v[36:39], a[0:3], v[72:75], 0
    s_add_u32 m0, s71, 40960
    v_add_f32 v49, 1.0, v49
    v_mul_f32 v50, s52, v22
    v_mfma_f32_16x16x32_bf16 v[36:39], a[8:11], v[76:79], v[36:39]
    s_add_u32 s55, s50, 2293760
    v_rcp_f32 v48, v48
    v_mfma_f32_16x16x32_bf16 v[40:43], a[4:7], v[72:75], 0
    ds_read_b128 v[72:75], v4 offset:28672
    buffer_load_dwordx4 v10, s[44:47], s55 offen offset:0 sc1 lds
    v_mfma_f32_16x16x32_bf16 v[40:43], a[12:15], v[76:79], v[40:43]
    s_waitcnt lgkmcnt(5)
    ds_read_b128 v[76:79], v4 offset:29696
    v_mul_f32 v51, s52, v23
    v_mfma_f32_16x16x32_bf16 v[36:39], a[16:19], v[80:83], v[36:39]
    v_rcp_f32 v49, v49
    v_mfma_f32_16x16x32_bf16 v[36:39], a[24:27], v[84:87], v[36:39]
    v_mul_f32 v44, s52, v28
    v_mul_f32 v45, s52, v29
    v_mfma_f32_16x16x32_bf16 v[40:43], a[20:23], v[80:83], v[40:43]
    ds_read_b128 v[80:83], v4 offset:30720
    buffer_load_dwordx4 v10, s[44:47], s55 offen offset:1024 sc1 lds
    v_mfma_f32_16x16x32_bf16 v[40:43], a[28:31], v[84:87], v[40:43]
    s_waitcnt lgkmcnt(5)
    ds_read_b128 v[84:87], v4 offset:31744
    v_mul_f32 v46, s52, v30
    v_mfma_f32_16x16x32_bf16 v[36:39], a[32:35], v[56:59], v[36:39]
    v_exp_f32 v44, v44
    v_mfma_f32_16x16x32_bf16 v[36:39], a[40:43], v[60:63], v[36:39]
    v_exp_f32 v45, v45
    v_mfma_f32_16x16x32_bf16 v[40:43], a[36:39], v[56:59], v[40:43]
    ds_read_b128 v[56:59], v4 offset:32768
    buffer_load_dwordx4 v10, s[44:47], s55 offen offset:2048 sc1 lds
    v_mfma_f32_16x16x32_bf16 v[40:43], a[44:47], v[60:63], v[40:43]
    s_waitcnt lgkmcnt(5)
    ds_read_b128 v[60:63], v4 offset:33792
    v_add_f32 v44, 1.0, v44
    v_mfma_f32_16x16x32_bf16 v[36:39], a[48:51], v[64:67], v[36:39]
    v_add_f32 v45, 1.0, v45
    v_mul_f32 v47, s52, v31
    v_mfma_f32_16x16x32_bf16 v[36:39], a[56:59], v[68:71], v[36:39]
    v_rcp_f32 v44, v44
    v_mfma_f32_16x16x32_bf16 v[40:43], a[52:55], v[64:67], v[40:43]
    ds_read_b128 v[64:67], v4 offset:34816
    buffer_load_dwordx4 v10, s[44:47], s55 offen offset:3072 sc1 lds
    v_mfma_f32_16x16x32_bf16 v[40:43], a[60:63], v[68:71], v[40:43]
    s_waitcnt lgkmcnt(5)
    ds_read_b128 v[68:71], v4 offset:35840
    v_mul_f32 v48, v48, v24
    v_mfma_f32_16x16x32_bf16 v[36:39], a[64:67], v[72:75], v[36:39]
    s_add_u32 m0, s71, 45056
    v_rcp_f32 v45, v45
    v_mfma_f32_16x16x32_bf16 v[36:39], a[72:75], v[76:79], v[36:39]
    s_add_u32 s55, s50, 2297856
    v_mul_f32 v44, v44, v32
    v_mul_f32 v45, v45, v33
    v_mfma_f32_16x16x32_bf16 v[40:43], a[68:71], v[72:75], v[40:43]
    ds_read_b128 v[72:75], v4 offset:36864
    buffer_load_dwordx4 v10, s[44:47], s55 offen offset:0 sc1 lds
    v_mfma_f32_16x16x32_bf16 v[40:43], a[76:79], v[76:79], v[40:43]
    s_waitcnt lgkmcnt(5)
    ds_read_b128 v[76:79], v4 offset:37888
    v_mul_f32 v49, v49, v25
    v_cvt_pk_bf16_f32 v54, v48, v49
    v_exp_f32 v50, v50
    v_exp_f32 v51, v51
    v_add_f32 v50, 1.0, v50
    v_add_f32 v51, 1.0, v51
    v_rcp_f32 v50, v50
    v_rcp_f32 v51, v51
    v_mul_f32 v50, v50, v26
    v_mul_f32 v51, v51, v27
    v_cvt_pk_bf16_f32 v55, v50, v51
    v_mfma_f32_16x16x32_bf16 v[36:39], a[80:83], v[80:83], v[36:39]
    v_permlane16_swap_b32 v52, v54
    v_mfma_f32_16x16x32_bf16 v[36:39], a[88:91], v[84:87], v[36:39]
    v_permlane16_swap_b32 v53, v55
    v_mfma_f32_16x16x32_bf16 v[40:43], a[84:87], v[80:83], v[40:43]
    ds_read_b128 v[80:83], v4 offset:38912
    buffer_load_dwordx4 v10, s[44:47], s55 offen offset:1024 sc1 lds
    v_mfma_f32_16x16x32_bf16 v[40:43], a[92:95], v[84:87], v[40:43]
    s_waitcnt lgkmcnt(5)
    ds_read_b128 v[84:87], v4 offset:39936
    v_cvt_pk_bf16_f32 v92, v44, v45
    v_mfma_f32_16x16x32_bf16 v[36:39], a[96:99], v[56:59], v[36:39]
    v_exp_f32 v46, v46
    v_mfma_f32_16x16x32_bf16 v[36:39], a[104:107], v[60:63], v[36:39]
    v_exp_f32 v47, v47
    v_mfma_f32_16x16x32_bf16 v[40:43], a[100:103], v[56:59], v[40:43]
    buffer_load_dwordx4 v10, s[44:47], s55 offen offset:2048 sc1 lds
    v_add_f32 v46, 1.0, v46
    v_mfma_f32_16x16x32_bf16 v[40:43], a[108:111], v[60:63], v[40:43]
    s_waitcnt lgkmcnt(4)
    v_add_f32 v47, 1.0, v47
    v_mfma_f32_16x16x32_bf16 v[36:39], a[112:115], v[64:67], v[36:39]
    v_rcp_f32 v46, v46
    v_mfma_f32_16x16x32_bf16 v[36:39], a[120:123], v[68:71], v[36:39]
    s_add_u32 s56, s51, 3538944
    v_rcp_f32 v47, v47
    v_mfma_f32_16x16x32_bf16 v[40:43], a[116:119], v[64:67], v[40:43]
    s_waitcnt vmcnt(7) lgkmcnt(0)
    s_barrier
    ds_read_b128 v[56:59], v2 offset:0
    v_mfma_f32_16x16x32_bf16 v[40:43], a[124:127], v[68:71], v[40:43]
    ds_read_b128 v[60:63], v2 offset:1024
    buffer_load_dwordx4 v10, s[44:47], s55 offen offset:3072 sc1 lds
    v_mfma_f32_16x16x32_bf16 v[36:39], a[128:131], v[72:75], v[36:39]
    ds_read_b128 v[64:67], v2 offset:2048
    v_mul_f32 v46, v46, v34
    v_mfma_f32_16x16x32_bf16 v[36:39], a[136:139], v[76:79], v[36:39]
    ds_read_b128 v[68:71], v2 offset:3072
    v_mul_f32 v47, v47, v35
    v_mfma_f32_16x16x32_bf16 v[40:43], a[132:135], v[72:75], v[40:43]
    ds_read_b128 v[72:75], v2 offset:4096
    v_cvt_pk_bf16_f32 v93, v46, v47
    v_mfma_f32_16x16x32_bf16 v[40:43], a[140:143], v[76:79], v[40:43]
    ds_read_b128 v[76:79], v2 offset:5120
    v_mfma_f32_16x16x32_bf16 v[36:39], a[144:147], v[80:83], v[36:39]
    s_add_u32 m0, s71, 49152
    buffer_store_dwordx4 v[52:55], v5, s[44:47], s56 offen sc1
    v_mfma_f32_16x16x32_bf16 v[36:39], a[152:155], v[84:87], v[36:39]
    s_add_u32 s55, s50, 2301952
    s_add_u32 s57, s54, 131072
    v_mfma_f32_16x16x32_bf16 v[40:43], a[148:151], v[80:83], v[40:43]
    buffer_load_dwordx4 v10, s[44:47], s55 offen offset:0 sc1 lds
    v_mfma_f32_16x16x32_bf16 v[40:43], a[156:159], v[84:87], v[40:43]
    s_waitcnt lgkmcnt(4)
    ds_read_b128 v[80:83], v2 offset:6144
    v_mfma_f32_16x16x32_bf16 v[12:15], a[0:3], v[56:59], 0
    ds_read_b128 v[84:87], v2 offset:7168
    v_mfma_f32_16x16x32_bf16 v[12:15], a[8:11], v[60:63], v[12:15]
    buffer_store_dword v11, v9, s[44:47], s57 offen sc1
    v_mfma_f32_16x16x32_bf16 v[16:19], a[4:7], v[56:59], 0
    s_add_u32 s57, s54, 196608
    ds_read_b128 v[56:59], v2 offset:8192
    buffer_load_dwordx4 v10, s[44:47], s55 offen offset:1024 sc1 lds
    v_mfma_f32_16x16x32_bf16 v[16:19], a[12:15], v[60:63], v[16:19]
    s_waitcnt lgkmcnt(5)
    ds_read_b128 v[60:63], v2 offset:9216
    v_mul_f32 v48, s52, v36
    v_mfma_f32_16x16x32_bf16 v[12:15], a[16:19], v[64:67], v[12:15]
    buffer_store_dword v11, v9, s[44:47], s57 offen sc1
    v_mfma_f32_16x16x32_bf16 v[12:15], a[24:27], v[68:71], v[12:15]
    v_mul_f32 v49, s52, v37
    v_mul_f32 v50, s52, v38
    v_mfma_f32_16x16x32_bf16 v[16:19], a[20:23], v[64:67], v[16:19]
    ds_read_b128 v[64:67], v2 offset:10240
    buffer_load_dwordx4 v[244:247], v10, s[44:47], s31 offen offset:1024 sc1
    v_mfma_f32_16x16x32_bf16 v[16:19], a[28:31], v[68:71], v[16:19]
    s_waitcnt lgkmcnt(5)
    ds_read_b128 v[68:71], v2 offset:11264
    v_mul_f32 v51, s52, v39
    v_mfma_f32_16x16x32_bf16 v[12:15], a[32:35], v[72:75], v[12:15]
    v_exp_f32 v48, v48
    v_mfma_f32_16x16x32_bf16 v[12:15], a[40:43], v[76:79], v[12:15]
    v_exp_f32 v49, v49
    v_mfma_f32_16x16x32_bf16 v[16:19], a[36:39], v[72:75], v[16:19]
    ds_read_b128 v[72:75], v2 offset:12288
    buffer_load_dwordx4 v[248:251], v10, s[44:47], s31 offen offset:2048 sc1
    v_mfma_f32_16x16x32_bf16 v[16:19], a[44:47], v[76:79], v[16:19]
    s_waitcnt lgkmcnt(5)
    ds_read_b128 v[76:79], v2 offset:13312
    v_add_f32 v48, 1.0, v48
    v_mfma_f32_16x16x32_bf16 v[12:15], a[48:51], v[80:83], v[12:15]
    v_add_f32 v49, 1.0, v49
    v_mfma_f32_16x16x32_bf16 v[12:15], a[56:59], v[84:87], v[12:15]
    v_rcp_f32 v48, v48
    v_mfma_f32_16x16x32_bf16 v[16:19], a[52:55], v[80:83], v[16:19]
    ds_read_b128 v[80:83], v2 offset:14336
    buffer_load_dwordx4 v[252:255], v10, s[44:47], s31 offen offset:3072 sc1
    v_mfma_f32_16x16x32_bf16 v[16:19], a[60:63], v[84:87], v[16:19]
    s_waitcnt lgkmcnt(5)
    ds_read_b128 v[84:87], v2 offset:15360
    v_mfma_f32_16x16x32_bf16 v[12:15], a[64:67], v[56:59], v[12:15]
    s_add_u32 s31, s72, 40960
    v_rcp_f32 v49, v49
    v_mfma_f32_16x16x32_bf16 v[12:15], a[72:75], v[60:63], v[12:15]
    v_mul_f32 v48, v48, v40
    v_mul_f32 v49, v49, v41
    v_mfma_f32_16x16x32_bf16 v[16:19], a[68:71], v[56:59], v[16:19]
    ds_read_b128 v[56:59], v2 offset:16384
    buffer_load_dwordx4 a[160:163], v10, s[44:47], s31 offen offset:0 sc1
    v_mfma_f32_16x16x32_bf16 v[16:19], a[76:79], v[60:63], v[16:19]
    s_waitcnt lgkmcnt(5)
    ds_read_b128 v[60:63], v2 offset:17408
    v_cvt_pk_bf16_f32 v94, v48, v49
    v_mfma_f32_16x16x32_bf16 v[12:15], a[80:83], v[64:67], v[12:15]
    v_exp_f32 v50, v50
    v_mfma_f32_16x16x32_bf16 v[12:15], a[88:91], v[68:71], v[12:15]
    v_exp_f32 v51, v51
    v_mfma_f32_16x16x32_bf16 v[16:19], a[84:87], v[64:67], v[16:19]
    ds_read_b128 v[64:67], v2 offset:18432
    buffer_load_dwordx4 a[164:167], v10, s[44:47], s31 offen offset:1024 sc1
    v_mfma_f32_16x16x32_bf16 v[16:19], a[92:95], v[68:71], v[16:19]
    s_waitcnt lgkmcnt(5)
    ds_read_b128 v[68:71], v2 offset:19456
    v_add_f32 v50, 1.0, v50
    v_mfma_f32_16x16x32_bf16 v[12:15], a[96:99], v[72:75], v[12:15]
    v_add_f32 v51, 1.0, v51
    v_mfma_f32_16x16x32_bf16 v[12:15], a[104:107], v[76:79], v[12:15]
    v_rcp_f32 v50, v50
    v_mfma_f32_16x16x32_bf16 v[16:19], a[100:103], v[72:75], v[16:19]
    ds_read_b128 v[72:75], v2 offset:20480
    buffer_load_dwordx4 a[168:171], v10, s[44:47], s31 offen offset:2048 sc1
    v_mfma_f32_16x16x32_bf16 v[16:19], a[108:111], v[76:79], v[16:19]
    s_waitcnt lgkmcnt(5)
    ds_read_b128 v[76:79], v2 offset:21504
    v_mfma_f32_16x16x32_bf16 v[12:15], a[112:115], v[80:83], v[12:15]
    v_rcp_f32 v51, v51
    v_mfma_f32_16x16x32_bf16 v[12:15], a[120:123], v[84:87], v[12:15]
    v_mul_f32 v50, v50, v42
    v_mul_f32 v51, v51, v43
    v_mfma_f32_16x16x32_bf16 v[16:19], a[116:119], v[80:83], v[16:19]
    ds_read_b128 v[80:83], v2 offset:22528
    buffer_load_dwordx4 a[172:175], v10, s[44:47], s31 offen offset:3072 sc1
    v_mfma_f32_16x16x32_bf16 v[16:19], a[124:127], v[84:87], v[16:19]
    s_waitcnt lgkmcnt(5)
    ds_read_b128 v[84:87], v2 offset:23552
    v_cvt_pk_bf16_f32 v95, v50, v51
    v_mfma_f32_16x16x32_bf16 v[12:15], a[128:131], v[56:59], v[12:15]
    s_add_u32 s31, s72, 45056
    v_mfma_f32_16x16x32_bf16 v[12:15], a[136:139], v[60:63], v[12:15]
    v_mfma_f32_16x16x32_bf16 v[16:19], a[132:135], v[56:59], v[16:19]
    ds_read_b128 v[56:59], v2 offset:24576
    buffer_load_dwordx4 a[176:179], v10, s[44:47], s31 offen offset:0 sc1
    v_mfma_f32_16x16x32_bf16 v[16:19], a[140:143], v[60:63], v[16:19]
    s_waitcnt lgkmcnt(5)
    ds_read_b128 v[60:63], v2 offset:25600
    v_mfma_f32_16x16x32_bf16 v[12:15], a[144:147], v[64:67], v[12:15]
    v_permlane16_swap_b32 v92, v94
    v_mfma_f32_16x16x32_bf16 v[12:15], a[152:155], v[68:71], v[12:15]
    v_permlane16_swap_b32 v93, v95
    v_mfma_f32_16x16x32_bf16 v[16:19], a[148:151], v[64:67], v[16:19]
    ds_read_b128 v[64:67], v2 offset:26624
    buffer_load_dwordx4 a[180:183], v10, s[44:47], s31 offen offset:1024 sc1
    v_mfma_f32_16x16x32_bf16 v[16:19], a[156:159], v[68:71], v[16:19]
    s_waitcnt lgkmcnt(5)
    ds_read_b128 v[68:71], v2 offset:27648
    v_mfma_f32_16x16x32_bf16 v[20:23], a[0:3], v[72:75], 0
    v_mfma_f32_16x16x32_bf16 v[20:23], a[8:11], v[76:79], v[20:23]
    v_mfma_f32_16x16x32_bf16 v[24:27], a[4:7], v[72:75], 0
    ds_read_b128 v[72:75], v2 offset:28672
    buffer_load_dwordx4 a[184:187], v10, s[44:47], s31 offen offset:2048 sc1
    v_mfma_f32_16x16x32_bf16 v[24:27], a[12:15], v[76:79], v[24:27]
    s_waitcnt lgkmcnt(5)
    ds_read_b128 v[76:79], v2 offset:29696
    v_mfma_f32_16x16x32_bf16 v[20:23], a[16:19], v[80:83], v[20:23]
    v_mfma_f32_16x16x32_bf16 v[20:23], a[24:27], v[84:87], v[20:23]
    v_mul_f32 v44, s52, v12
    v_mul_f32 v45, s52, v13
    v_mfma_f32_16x16x32_bf16 v[24:27], a[20:23], v[80:83], v[24:27]
    ds_read_b128 v[80:83], v2 offset:30720
    buffer_load_dwordx4 a[188:191], v10, s[44:47], s31 offen offset:3072 sc1
    v_mfma_f32_16x16x32_bf16 v[24:27], a[28:31], v[84:87], v[24:27]
    s_waitcnt lgkmcnt(5)
    ds_read_b128 v[84:87], v2 offset:31744
    v_mul_f32 v46, s52, v14
    v_mfma_f32_16x16x32_bf16 v[20:23], a[32:35], v[56:59], v[20:23]
    s_waitcnt vmcnt(15)
    s_barrier
    v_mul_f32 v47, s52, v15
    v_mfma_f32_16x16x32_bf16 v[20:23], a[40:43], v[60:63], v[20:23]
    s_add_u32 s56, s51, 4423680
    buffer_store_dwordx4 v[92:95], v5, s[44:47], s56 offen sc1
    v_mfma_f32_16x16x32_bf16 v[24:27], a[36:39], v[56:59], v[24:27]
    s_add_u32 s57, s54, 262144
    ds_read_b128 v[56:59], v2 offset:32768
    v_mfma_f32_16x16x32_bf16 v[24:27], a[44:47], v[60:63], v[24:27]
    s_waitcnt lgkmcnt(5)
    ds_read_b128 v[60:63], v2 offset:33792
    v_mfma_f32_16x16x32_bf16 v[20:23], a[48:51], v[64:67], v[20:23]
    s_add_u32 s31, s72, 49152
    buffer_store_dword v11, v9, s[44:47], s57 offen sc1
    v_mfma_f32_16x16x32_bf16 v[20:23], a[56:59], v[68:71], v[20:23]
    v_exp_f32 v44, v44
    v_mfma_f32_16x16x32_bf16 v[24:27], a[52:55], v[64:67], v[24:27]
    ds_read_b128 v[64:67], v2 offset:34816
    buffer_load_dwordx4 a[192:195], v10, s[44:47], s31 offen offset:0 sc1
    v_mfma_f32_16x16x32_bf16 v[24:27], a[60:63], v[68:71], v[24:27]
    s_waitcnt lgkmcnt(5)
    ds_read_b128 v[68:71], v2 offset:35840
    s_add_u32 s30, s59, 0
    v_mfma_f32_16x16x32_bf16 v[20:23], a[64:67], v[72:75], v[20:23]
    buffer_load_dword v8, v7, s[44:47], s30 offen sc1
    v_mfma_f32_16x16x32_bf16 v[20:23], a[72:75], v[76:79], v[20:23]
    v_exp_f32 v45, v45
    v_mfma_f32_16x16x32_bf16 v[24:27], a[68:71], v[72:75], v[24:27]
    ds_read_b128 v[72:75], v2 offset:36864
    buffer_load_dwordx4 a[196:199], v10, s[44:47], s31 offen offset:1024 sc1
    v_mfma_f32_16x16x32_bf16 v[24:27], a[76:79], v[76:79], v[24:27]
    s_waitcnt lgkmcnt(5)
    ds_read_b128 v[76:79], v2 offset:37888
    v_add_f32 v44, 1.0, v44
    v_mfma_f32_16x16x32_bf16 v[20:23], a[80:83], v[80:83], v[20:23]
    v_add_f32 v45, 1.0, v45
    v_mfma_f32_16x16x32_bf16 v[20:23], a[88:91], v[84:87], v[20:23]
    v_rcp_f32 v44, v44
    v_mfma_f32_16x16x32_bf16 v[24:27], a[84:87], v[80:83], v[24:27]
    ds_read_b128 v[80:83], v2 offset:38912
    buffer_load_dwordx4 a[200:203], v10, s[44:47], s31 offen offset:2048 sc1
    v_mfma_f32_16x16x32_bf16 v[24:27], a[92:95], v[84:87], v[24:27]
    s_waitcnt lgkmcnt(5)
    ds_read_b128 v[84:87], v2 offset:39936
    v_mfma_f32_16x16x32_bf16 v[20:23], a[96:99], v[56:59], v[20:23]
    v_rcp_f32 v45, v45
    v_mfma_f32_16x16x32_bf16 v[20:23], a[104:107], v[60:63], v[20:23]
    v_mul_f32 v44, v44, v16
    v_mul_f32 v45, v45, v17
    v_mfma_f32_16x16x32_bf16 v[24:27], a[100:103], v[56:59], v[24:27]
    buffer_load_dwordx4 a[204:207], v10, s[44:47], s31 offen offset:3072 sc1
    v_cvt_pk_bf16_f32 v52, v44, v45
    v_mfma_f32_16x16x32_bf16 v[24:27], a[108:111], v[60:63], v[24:27]
    s_waitcnt lgkmcnt(4)
    v_exp_f32 v46, v46
    v_mfma_f32_16x16x32_bf16 v[20:23], a[112:115], v[64:67], v[20:23]
    s_add_u32 s31, s72, 53248
    v_exp_f32 v47, v47
    v_mfma_f32_16x16x32_bf16 v[20:23], a[120:123], v[68:71], v[20:23]
    v_add_f32 v46, 1.0, v46
    v_add_f32 v47, 1.0, v47
    v_mfma_f32_16x16x32_bf16 v[24:27], a[116:119], v[64:67], v[24:27]
    s_waitcnt vmcnt(19) lgkmcnt(0)
    s_barrier
    ds_read_b128 v[56:59], v3 offset:0
    v_mfma_f32_16x16x32_bf16 v[24:27], a[124:127], v[68:71], v[24:27]
    ds_read_b128 v[60:63], v3 offset:1024
    buffer_load_dwordx4 a[208:211], v10, s[44:47], s31 offen offset:0 sc1
    v_mfma_f32_16x16x32_bf16 v[20:23], a[128:131], v[72:75], v[20:23]
    ds_read_b128 v[64:67], v3 offset:2048
    v_mfma_f32_16x16x32_bf16 v[20:23], a[136:139], v[76:79], v[20:23]
    ds_read_b128 v[68:71], v3 offset:3072
    v_mfma_f32_16x16x32_bf16 v[24:27], a[132:135], v[72:75], v[24:27]
    ds_read_b128 v[72:75], v3 offset:4096
    buffer_load_dwordx4 a[212:215], v10, s[44:47], s31 offen offset:1024 sc1
    v_mfma_f32_16x16x32_bf16 v[24:27], a[140:143], v[76:79], v[24:27]
    ds_read_b128 v[76:79], v3 offset:5120
    v_mfma_f32_16x16x32_bf16 v[20:23], a[144:147], v[80:83], v[20:23]
    v_rcp_f32 v46, v46
    v_mfma_f32_16x16x32_bf16 v[20:23], a[152:155], v[84:87], v[20:23]
    v_rcp_f32 v47, v47
    v_mfma_f32_16x16x32_bf16 v[24:27], a[148:151], v[80:83], v[24:27]
    buffer_load_dwordx4 a[216:219], v10, s[44:47], s31 offen offset:2048 sc1
    v_mul_f32 v46, v46, v18
    v_mfma_f32_16x16x32_bf16 v[24:27], a[156:159], v[84:87], v[24:27]
    s_waitcnt lgkmcnt(4)
    ds_read_b128 v[80:83], v3 offset:6144
    v_mul_f32 v47, v47, v19
    v_mfma_f32_16x16x32_bf16 v[28:31], a[0:3], v[56:59], 0
    ds_read_b128 v[84:87], v3 offset:7168
    v_cvt_pk_bf16_f32 v53, v46, v47
    v_mfma_f32_16x16x32_bf16 v[28:31], a[8:11], v[60:63], v[28:31]
    v_mfma_f32_16x16x32_bf16 v[32:35], a[4:7], v[56:59], 0
    ds_read_b128 v[56:59], v3 offset:8192
    buffer_load_dwordx4 a[220:223], v10, s[44:47], s31 offen offset:3072 sc1
    v_mfma_f32_16x16x32_bf16 v[32:35], a[12:15], v[60:63], v[32:35]
    s_waitcnt lgkmcnt(5)
    ds_read_b128 v[60:63], v3 offset:9216
    v_mul_f32 v48, s52, v20
    v_mfma_f32_16x16x32_bf16 v[28:31], a[16:19], v[64:67], v[28:31]
    s_add_u32 s31, s72, 57344
    v_mul_f32 v49, s52, v21
    v_mfma_f32_16x16x32_bf16 v[28:31], a[24:27], v[68:71], v[28:31]
    v_exp_f32 v48, v48
    v_mfma_f32_16x16x32_bf16 v[32:35], a[20:23], v[64:67], v[32:35]
    ds_read_b128 v[64:67], v3 offset:10240
    buffer_load_dwordx4 a[224:227], v10, s[44:47], s31 offen offset:0 sc1
    v_mfma_f32_16x16x32_bf16 v[32:35], a[28:31], v[68:71], v[32:35]
    s_waitcnt lgkmcnt(5)
    ds_read_b128 v[68:71], v3 offset:11264
    s_add_u32 s30, s59, 131072
    v_mfma_f32_16x16x32_bf16 v[28:31], a[32:35], v[72:75], v[28:31]
    buffer_load_dword v0, v7, s[44:47], s30 offen sc1
    v_mul_f32 v50, s52, v22
    v_mfma_f32_16x16x32_bf16 v[28:31], a[40:43], v[76:79], v[28:31]
    v_exp_f32 v49, v49
    v_mfma_f32_16x16x32_bf16 v[32:35], a[36:39], v[72:75], v[32:35]
    ds_read_b128 v[72:75], v3 offset:12288
    buffer_load_dwordx4 a[228:231], v10, s[44:47], s31 offen offset:1024 sc1
    v_mfma_f32_16x16x32_bf16 v[32:35], a[44:47], v[76:79], v[32:35]
    s_waitcnt lgkmcnt(5)
    ds_read_b128 v[76:79], v3 offset:13312
    v_add_f32 v48, 1.0, v48
    v_mfma_f32_16x16x32_bf16 v[28:31], a[48:51], v[80:83], v[28:31]
    v_add_f32 v49, 1.0, v49
    v_mul_f32 v51, s52, v23
    v_mfma_f32_16x16x32_bf16 v[28:31], a[56:59], v[84:87], v[28:31]
    v_rcp_f32 v48, v48
    v_mfma_f32_16x16x32_bf16 v[32:35], a[52:55], v[80:83], v[32:35]
    ds_read_b128 v[80:83], v3 offset:14336
    buffer_load_dwordx4 a[232:235], v10, s[44:47], s31 offen offset:2048 sc1
    v_mfma_f32_16x16x32_bf16 v[32:35], a[60:63], v[84:87], v[32:35]
    s_waitcnt lgkmcnt(5)
    ds_read_b128 v[84:87], v3 offset:15360
    v_lshrrev_b32 v89, 2, v1
    v_mfma_f32_16x16x32_bf16 v[28:31], a[64:67], v[56:59], v[28:31]
    v_rcp_f32 v49, v49
    v_mfma_f32_16x16x32_bf16 v[28:31], a[72:75], v[60:63], v[28:31]
    v_mul_f32 v48, v48, v24
    v_mul_f32 v49, v49, v25
    v_mfma_f32_16x16x32_bf16 v[32:35], a[68:71], v[56:59], v[32:35]
    ds_read_b128 v[56:59], v3 offset:16384
    buffer_load_dwordx4 a[236:239], v10, s[44:47], s31 offen offset:3072 sc1
    v_mfma_f32_16x16x32_bf16 v[32:35], a[76:79], v[60:63], v[32:35]
    s_waitcnt lgkmcnt(5)
    ds_read_b128 v[60:63], v3 offset:17408
    v_cvt_pk_bf16_f32 v54, v48, v49
    v_mfma_f32_16x16x32_bf16 v[28:31], a[80:83], v[64:67], v[28:31]
    s_add_u32 s31, s72, 61440
    v_exp_f32 v50, v50
    v_mfma_f32_16x16x32_bf16 v[28:31], a[88:91], v[68:71], v[28:31]
    v_exp_f32 v51, v51
    v_mfma_f32_16x16x32_bf16 v[32:35], a[84:87], v[64:67], v[32:35]
    ds_read_b128 v[64:67], v3 offset:18432
    buffer_load_dwordx4 a[240:243], v10, s[44:47], s31 offen offset:0 sc1
    v_mfma_f32_16x16x32_bf16 v[32:35], a[92:95], v[68:71], v[32:35]
    s_waitcnt lgkmcnt(5)
    ds_read_b128 v[68:71], v3 offset:19456
    v_add_f32 v50, 1.0, v50
    v_mfma_f32_16x16x32_bf16 v[28:31], a[96:99], v[72:75], v[28:31]
    v_add_f32 v51, 1.0, v51
    v_and_b32 v88, 3, v1
    v_mfma_f32_16x16x32_bf16 v[28:31], a[104:107], v[76:79], v[28:31]
    s_lshl_b32 s63, s3, 2
    v_rcp_f32 v50, v50
    v_mfma_f32_16x16x32_bf16 v[32:35], a[100:103], v[72:75], v[32:35]
    ds_read_b128 v[72:75], v3 offset:20480
    buffer_load_dwordx4 a[244:247], v10, s[44:47], s31 offen offset:1024 sc1
    v_mfma_f32_16x16x32_bf16 v[32:35], a[108:111], v[76:79], v[32:35]
    s_waitcnt lgkmcnt(5)
    ds_read_b128 v[76:79], v3 offset:21504
    v_add_u32 v88, s63, v88
    v_mfma_f32_16x16x32_bf16 v[28:31], a[112:115], v[80:83], v[28:31]
    v_rcp_f32 v51, v51
    v_mfma_f32_16x16x32_bf16 v[28:31], a[120:123], v[84:87], v[28:31]
    v_mul_f32 v50, v50, v26
    v_mul_f32 v51, v51, v27
    v_mfma_f32_16x16x32_bf16 v[32:35], a[116:119], v[80:83], v[32:35]
    ds_read_b128 v[80:83], v3 offset:22528
    buffer_load_dwordx4 a[248:251], v10, s[44:47], s31 offen offset:2048 sc1
    v_mfma_f32_16x16x32_bf16 v[32:35], a[124:127], v[84:87], v[32:35]
    s_waitcnt lgkmcnt(5)
    ds_read_b128 v[84:87], v3 offset:23552
    v_cvt_pk_bf16_f32 v55, v50, v51
    v_mfma_f32_16x16x32_bf16 v[28:31], a[128:131], v[56:59], v[28:31]
    v_add_u32 v90, 24, v1
    v_lshrrev_b32 v90, 6, v90
    v_mfma_f32_16x16x32_bf16 v[28:31], a[136:139], v[60:63], v[28:31]
    v_lshlrev_b32 v90, 31, v90
    v_lshl_or_b32 v90, v89, 8, v90
    v_mfma_f32_16x16x32_bf16 v[32:35], a[132:135], v[56:59], v[32:35]
    ds_read_b128 v[56:59], v3 offset:24576
    buffer_load_dwordx4 a[252:255], v10, s[44:47], s31 offen offset:3072 sc1
    v_mfma_f32_16x16x32_bf16 v[32:35], a[140:143], v[60:63], v[32:35]
    s_waitcnt lgkmcnt(5)
    ds_read_b128 v[60:63], v3 offset:25600
    v_lshl_add_u32 v90, v88, 4, v90
    v_mfma_f32_16x16x32_bf16 v[28:31], a[144:147], v[64:67], v[28:31]
    s_waitcnt vmcnt(19)
    s_barrier
    s_mul_i32 s61, s76, 20480
    v_mfma_f32_16x16x32_bf16 v[28:31], a[152:155], v[68:71], v[28:31]
    s_mul_i32 s63, s75, 2560
    v_permlane16_swap_b32 v52, v54
    v_mfma_f32_16x16x32_bf16 v[32:35], a[148:151], v[64:67], v[32:35]
    s_add_u32 s61, s61, s63
    ds_read_b128 v[64:67], v3 offset:26624
    s_add_u32 s61, s61, 4194304
    v_mfma_f32_16x16x32_bf16 v[32:35], a[156:159], v[68:71], v[32:35]
    s_waitcnt lgkmcnt(5)
    ds_read_b128 v[68:71], v3 offset:27648
    v_permlane16_swap_b32 v53, v55
    v_mfma_f32_16x16x32_bf16 v[36:39], a[0:3], v[72:75], 0
    s_waitcnt vmcnt(16)
    v_cmp_ne_u32 vcc, v11, v8
    s_nop 0
    s_cbranch_vccnz L_g2p0r
L_g2p0b:
    v_mfma_f32_16x16x32_bf16 v[36:39], a[8:11], v[76:79], v[36:39]
    s_add_u32 s56, s51, 5308416
    buffer_store_dwordx4 v[52:55], v5, s[44:47], s56 offen sc1
    v_mfma_f32_16x16x32_bf16 v[40:43], a[4:7], v[72:75], 0
    s_add_u32 s57, s54, 327680
    ds_read_b128 v[72:75], v3 offset:28672
    v_and_b32 v91, 7, v88
    v_mfma_f32_16x16x32_bf16 v[40:43], a[12:15], v[76:79], v[40:43]
    s_waitcnt lgkmcnt(5)
    ds_read_b128 v[76:79], v3 offset:29696
    v_lshlrev_b32 v91, 4, v91
    v_mfma_f32_16x16x32_bf16 v[36:39], a[16:19], v[80:83], v[36:39]
    s_add_u32 s49, s73, 0
    buffer_store_dword v11, v9, s[44:47], s57 offen sc1
    v_mfma_f32_16x16x32_bf16 v[36:39], a[24:27], v[84:87], v[36:39]
    s_lshr_b32 s62, s3, 1
    v_mul_f32 v44, s52, v28
    v_mul_f32 v45, s52, v29
    v_mfma_f32_16x16x32_bf16 v[40:43], a[20:23], v[80:83], v[40:43]
    s_lshl_b32 s63, s76, 1
    ds_read_b128 v[80:83], v3 offset:30720
    buffer_load_dwordx4 a[0:3], v10, s[44:47], s49 offen offset:0 sc1
    v_mfma_f32_16x16x32_bf16 v[40:43], a[28:31], v[84:87], v[40:43]
    s_waitcnt lgkmcnt(5)
    ds_read_b128 v[84:87], v3 offset:31744
    v_mul_f32 v46, s52, v30
    v_mfma_f32_16x16x32_bf16 v[36:39], a[32:35], v[56:59], v[36:39]
    s_add_u32 s62, s62, s63
    v_exp_f32 v44, v44
    v_mfma_f32_16x16x32_bf16 v[36:39], a[40:43], v[60:63], v[36:39]
    s_lshl_b32 s62, s62, 10
    v_exp_f32 v45, v45
    v_mfma_f32_16x16x32_bf16 v[40:43], a[36:39], v[56:59], v[40:43]
    s_lshl_b32 s63, s97, 7
    ds_read_b128 v[56:59], v3 offset:32768
    buffer_load_dwordx4 a[4:7], v10, s[44:47], s49 offen offset:1024 sc1
    v_mfma_f32_16x16x32_bf16 v[40:43], a[44:47], v[60:63], v[40:43]
    s_waitcnt lgkmcnt(5)
    ds_read_b128 v[60:63], v3 offset:33792
    v_add_f32 v44, 1.0, v44
    v_mfma_f32_16x16x32_bf16 v[36:39], a[48:51], v[64:67], v[36:39]
    s_add_u32 s62, s62, s63
    v_add_f32 v45, 1.0, v45
    v_mul_f32 v47, s52, v31
    v_mfma_f32_16x16x32_bf16 v[36:39], a[56:59], v[68:71], v[36:39]
    s_add_u32 s62, s62, 42991616
    v_rcp_f32 v44, v44
    v_mfma_f32_16x16x32_bf16 v[40:43], a[52:55], v[64:67], v[40:43]
    ds_read_b128 v[64:67], v3 offset:34816
    buffer_load_dwordx4 a[8:11], v10, s[44:47], s49 offen offset:2048 sc1
    v_mfma_f32_16x16x32_bf16 v[40:43], a[60:63], v[68:71], v[40:43]
    s_waitcnt lgkmcnt(5)
    ds_read_b128 v[68:71], v3 offset:35840
    v_add_u32 v2, s71, v10
    v_mfma_f32_16x16x32_bf16 v[36:39], a[64:67], v[72:75], v[36:39]
    s_waitcnt vmcnt(62)
    v_rcp_f32 v45, v45
    v_mfma_f32_16x16x32_bf16 v[36:39], a[72:75], v[76:79], v[36:39]
    v_mul_f32 v44, v44, v32
    v_mul_f32 v45, v45, v33
    v_mfma_f32_16x16x32_bf16 v[40:43], a[68:71], v[72:75], v[40:43]
    ds_read_b128 v[72:75], v3 offset:36864
    buffer_load_dwordx4 a[12:15], v10, s[44:47], s49 offen offset:3072 sc1
    v_mfma_f32_16x16x32_bf16 v[40:43], a[76:79], v[76:79], v[40:43]
    s_waitcnt lgkmcnt(5)
    ds_read_b128 v[76:79], v3 offset:37888
    v_cvt_pk_bf16_f32 v92, v44, v45
    v_mfma_f32_16x16x32_bf16 v[36:39], a[80:83], v[80:83], v[36:39]
    s_add_u32 s49, s73, 4096
    v_exp_f32 v46, v46
    v_mfma_f32_16x16x32_bf16 v[36:39], a[88:91], v[84:87], v[36:39]
    v_exp_f32 v47, v47
    v_mfma_f32_16x16x32_bf16 v[40:43], a[84:87], v[80:83], v[40:43]
    ds_read_b128 v[80:83], v3 offset:38912
    buffer_load_dwordx4 a[16:19], v10, s[44:47], s49 offen offset:0 sc1
    v_mfma_f32_16x16x32_bf16 v[40:43], a[92:95], v[84:87], v[40:43]
    s_waitcnt lgkmcnt(5)
    ds_read_b128 v[84:87], v3 offset:39936
    v_add_f32 v46, 1.0, v46
    v_mfma_f32_16x16x32_bf16 v[36:39], a[96:99], v[56:59], v[36:39]
    v_add_f32 v47, 1.0, v47
    v_mfma_f32_16x16x32_bf16 v[36:39], a[104:107], v[60:63], v[36:39]
    ds_read_b128 a[56:59], v2 offset:0
    v_mfma_f32_16x16x32_bf16 v[40:43], a[100:103], v[56:59], v[40:43]
    buffer_load_dwordx4 a[20:23], v10, s[44:47], s49 offen offset:1024 sc1
    ds_read_b128 a[60:63], v2 offset:1024
    v_mfma_f32_16x16x32_bf16 v[40:43], a[108:111], v[60:63], v[40:43]
    s_waitcnt lgkmcnt(6)
    ds_read_b128 a[64:67], v2 offset:2048
    v_mfma_f32_16x16x32_bf16 v[36:39], a[112:115], v[64:67], v[36:39]
    ds_read_b128 a[68:71], v2 offset:3072
    v_mfma_f32_16x16x32_bf16 v[36:39], a[120:123], v[68:71], v[36:39]
    ds_read_b128 a[72:75], v2 offset:4096
    v_mfma_f32_16x16x32_bf16 v[40:43], a[116:119], v[64:67], v[40:43]
    s_waitcnt vmcnt(40) lgkmcnt(0)
    s_barrier
    buffer_load_dwordx4 a[24:27], v10, s[44:47], s49 offen offset:2048 sc1
    v_mfma_f32_16x16x32_bf16 v[40:43], a[124:127], v[68:71], v[40:43]
    s_waitcnt vmcnt(16)
    ds_read_b128 a[76:79], v2 offset:5120
    v_cmp_ne_u32 vcc, v11, v0
    v_mfma_f32_16x16x32_bf16 v[36:39], a[128:131], v[72:75], v[36:39]
    s_cbranch_vccnz L_g2p1r
L_g2p1b:
    v_rcp_f32 v46, v46
    v_mfma_f32_16x16x32_bf16 v[36:39], a[136:139], v[76:79], v[36:39]
    v_rcp_f32 v47, v47
    v_mfma_f32_16x16x32_bf16 v[40:43], a[132:135], v[72:75], v[40:43]
    buffer_load_dwordx4 a[28:31], v10, s[44:47], s49 offen offset:3072 sc1
    v_mul_f32 v46, v46, v34
    v_mfma_f32_16x16x32_bf16 v[40:43], a[140:143], v[76:79], v[40:43]
    v_mul_f32 v47, v47, v35
    v_cvt_pk_bf16_f32 v93, v46, v47
    v_mfma_f32_16x16x32_bf16 v[36:39], a[144:147], v[80:83], v[36:39]
    s_add_u32 s49, s73, 8192
    v_mfma_f32_16x16x32_bf16 v[36:39], a[152:155], v[84:87], v[36:39]
    v_mfma_f32_16x16x32_bf16 v[40:43], a[148:151], v[80:83], v[40:43]
    buffer_load_dwordx4 a[32:35], v10, s[44:47], s49 offen offset:0 sc1
    v_mfma_f32_16x16x32_bf16 v[40:43], a[156:159], v[84:87], v[40:43]
L_g2:
    s_waitcnt vmcnt(8)
    s_waitcnt vmcnt(7)
    v_mfma_f32_16x16x32_bf16 a[80:83], v[96:99], a[0:3], 0
    s_add_u32 s49, s73, 8192
    v_mfma_f32_16x16x32_bf16 a[80:83], v[116:119], a[4:7], a[80:83]
    s_add_u32 s63, s61, 0
    v_mfma_f32_16x16x32_bf16 a[84:87], v[100:103], a[0:3], 0
    buffer_load_dwordx4 a[36:39], v10, s[44:47], s49 offen offset:1024 sc1
    v_mfma_f32_16x16x32_bf16 a[84:87], v[120:123], a[4:7], a[84:87]
    s_add_u32 s49, s73, 8192
    v_mul_f32 v48, s52, v36
    v_mul_f32 v49, s52, v37
    v_mfma_f32_16x16x32_bf16 a[88:91], v[104:107], a[0:3], 0
    buffer_load_dwordx4 v[68:71], v90, s[44:47], s63 offen sc1
    v_mfma_f32_16x16x32_bf16 a[88:91], v[124:127], a[4:7], a[88:91]
    s_add_u32 s64, s62, 0
    buffer_load_dwordx4 a[40:43], v10, s[44:47], s49 offen offset:2048 sc1
    v_mul_f32 v50, s52, v38
    v_mfma_f32_16x16x32_bf16 a[92:95], v[108:111], a[0:3], 0
    s_add_u32 s49, s73, 8192
    v_exp_f32 v48, v48
    v_mfma_f32_16x16x32_bf16 a[92:95], v[128:131], a[4:7], a[92:95]
    v_exp_f32 v49, v49
    v_mfma_f32_16x16x32_bf16 a[96:99], v[112:115], a[0:3], 0
    buffer_load_dwordx4 a[44:47], v10, s[44:47], s49 offen offset:3072 sc1
    buffer_load_dwordx4 v[60:63], v91, s[44:47], s64 offen sc1
    v_mfma_f32_16x16x32_bf16 a[96:99], v[132:135], a[4:7], a[96:99]
    s_waitcnt vmcnt(11)
    s_waitcnt vmcnt(10)
    v_add_f32 v48, 1.0, v48
    v_mfma_f32_16x16x32_bf16 a[80:83], v[136:139], a[8:11], a[80:83]
    s_add_u32 s49, s73, 12288
    v_add_f32 v49, 1.0, v49
    v_mul_f32 v51, s52, v39
    v_mfma_f32_16x16x32_bf16 a[80:83], v[156:159], a[12:15], a[80:83]
    buffer_load_dwordx4 a[48:51], v10, s[44:47], s49 offen offset:0 sc1
    v_min_u32 v3, 9, v89
    v_mfma_f32_16x16x32_bf16 a[84:87], v[140:143], a[8:11], a[84:87]
    s_add_u32 s49, s73, 12288
    v_rcp_f32 v48, v48
    v_mfma_f32_16x16x32_bf16 a[84:87], v[160:163], a[12:15], a[84:87]
    v_rcp_f32 v49, v49
    v_mfma_f32_16x16x32_bf16 a[88:91], v[144:147], a[8:11], a[88:91]
    buffer_load_dwordx4 a[52:55], v6, s[44:47], s49 offen offset:1024 sc1
    v_mul_f32 v48, v48, v40
    v_mfma_f32_16x16x32_bf16 a[88:91], v[164:167], a[12:15], a[88:91]
    s_add_u32 s49, s73, 1769472
    v_mul_f32 v49, v49, v41
    v_cvt_pk_bf16_f32 v94, v48, v49
    v_mfma_f32_16x16x32_bf16 a[92:95], v[148:151], a[8:11], a[92:95]
    v_exp_f32 v50, v50
    v_mfma_f32_16x16x32_bf16 a[92:95], v[168:171], a[12:15], a[92:95]
    buffer_load_dwordx4 a[120:123], v10, s[44:47], s49 offen offset:0 sc1
    v_mul_u32_u24 v3, 576, v3
    v_mfma_f32_16x16x32_bf16 a[96:99], v[152:155], a[8:11], a[96:99]
    v_exp_f32 v51, v51
    v_mfma_f32_16x16x32_bf16 a[96:99], v[172:175], a[12:15], a[96:99]
    s_waitcnt vmcnt(12) lgkmcnt(0)
    s_waitcnt vmcnt(11)
    v_add_f32 v50, 1.0, v50
    v_add_f32 v51, 1.0, v51
    v_rcp_f32 v50, v50
    v_rcp_f32 v51, v51
    v_mul_f32 v50, v50, v42
    v_mul_f32 v51, v51, v43
    v_cvt_pk_bf16_f32 v95, v50, v51
    v_mfma_f32_16x16x32_bf16 a[80:83], v[176:179], a[16:19], a[80:83]
    s_waitcnt vmcnt(18)
    s_barrier
    buffer_load_dwordx4 a[124:127], v10, s[44:47], s49 offen offset:1024 sc1
    v_mfma_f32_16x16x32_bf16 a[80:83], v[196:199], a[20:23], a[80:83]
    v_permlane16_swap_b32 v92, v94
    v_mfma_f32_16x16x32_bf16 a[84:87], v[180:183], a[16:19], a[84:87]
    v_permlane16_swap_b32 v93, v95
    v_mfma_f32_16x16x32_bf16 a[84:87], v[200:203], a[20:23], a[84:87]
    s_add_u32 s56, s51, 6193152
    buffer_load_dwordx4 a[128:131], v10, s[44:47], s49 offen offset:2048 sc1
    v_lshl_add_u32 v3, v88, 4, v3
    v_mfma_f32_16x16x32_bf16 a[88:91], v[184:187], a[16:19], a[88:91]
    buffer_store_dwordx4 v[92:95], v5, s[44:47], s56 offen sc1
    v_mfma_f32_16x16x32_bf16 a[88:91], v[204:207], a[20:23], a[88:91]
    s_add_u32 s57, s54, 393216
    buffer_store_dword v11, v9, s[44:47], s57 offen sc1
    v_mfma_f32_16x16x32_bf16 a[92:95], v[188:191], a[16:19], a[92:95]
    buffer_load_dwordx4 a[132:135], v10, s[44:47], s49 offen offset:3072 sc1
    v_mul_u32_u24 v4, 1280, v88
    v_mfma_f32_16x16x32_bf16 a[92:95], v[208:211], a[20:23], a[92:95]
    s_add_u32 s49, s73, 1773568
    v_lshl_add_u32 v4, v89, 4, v4
    v_and_b32 v89, 0x80000000, v90
    v_mfma_f32_16x16x32_bf16 a[96:99], v[192:195], a[16:19], a[96:99]
    v_or_b32 v4, v4, v89
    s_mul_i32 s60, s76, 20480
    v_mfma_f32_16x16x32_bf16 a[96:99], v[212:215], a[20:23], a[96:99]
    s_waitcnt vmcnt(15)
    s_waitcnt vmcnt(14)
    buffer_load_dwordx4 a[0:3], v10, s[44:47], s49 offen offset:0 sc1
    v_mfma_f32_16x16x32_bf16 a[80:83], v[216:219], a[24:27], a[80:83]
    s_mul_i32 s66, s75, 160
    s_add_u32 s60, s60, s66
    v_lshrrev_b32 v88, 4, v1
    v_mfma_f32_16x16x32_bf16 a[80:83], v[236:239], a[28:31], a[80:83]
    v_mul_u32_u24 v2, 288, v88
    v_and_b32 v88, 15, v1
    v_mfma_f32_16x16x32_bf16 a[84:87], v[220:223], a[24:27], a[84:87]
    buffer_load_dwordx4 a[4:7], v10, s[44:47], s49 offen offset:1024 sc1
    v_lshl_add_u32 v2, v88, 4, v2
    v_mfma_f32_16x16x32_bf16 a[84:87], v[240:243], a[28:31], a[84:87]
    s_mul_i32 s66, s3, 5760
    v_add_u32 v2, s66, v2
    s_mov_b32 s32, s24
    v_mfma_f32_16x16x32_bf16 a[88:91], v[224:227], a[24:27], a[88:91]
    s_and_b32 s33, s25, 0xffff
    s_mov_b32 s34, 2621440
    s_mov_b32 s35, 0x20000
    v_mfma_f32_16x16x32_bf16 a[88:91], v[244:247], a[28:31], a[88:91]
    buffer_load_dwordx4 a[8:11], v10, s[44:47], s49 offen offset:2048 sc1
    v_mfma_f32_16x16x32_bf16 a[92:95], v[228:231], a[24:27], a[92:95]
    v_mfma_f32_16x16x32_bf16 a[92:95], v[248:251], a[28:31], a[92:95]
    v_mfma_f32_16x16x32_bf16 a[96:99], v[232:235], a[24:27], a[96:99]
    buffer_load_dwordx4 a[12:15], v10, s[44:47], s49 offen offset:3072 sc1
    v_mfma_f32_16x16x32_bf16 a[96:99], v[252:255], a[28:31], a[96:99]
    s_waitcnt vmcnt(17)
    s_waitcnt vmcnt(16)
    v_mfma_f32_16x16x32_bf16 a[80:83], a[160:163], a[32:35], a[80:83]
    s_add_u32 s49, s73, 1777664
    s_buffer_load_dword s6, s[44:47], s59 offset:262144
    s_buffer_load_dword s7, s[44:47], s59 offset:262400
    v_mfma_f32_16x16x32_bf16 a[80:83], a[180:183], a[36:39], a[80:83]
    s_buffer_load_dword s8, s[44:47], s59 offset:262656
    buffer_load_dwordx4 a[16:19], v10, s[44:47], s49 offen offset:0 sc1
    s_buffer_load_dword s9, s[44:47], s59 offset:262912
    v_mfma_f32_16x16x32_bf16 a[84:87], a[164:167], a[32:35], a[84:87]
    s_buffer_load_dword s10, s[44:47], s59 offset:263168
    s_buffer_load_dword s11, s[44:47], s59 offset:263424
    s_buffer_load_dword s12, s[44:47], s59 offset:263680
    v_mfma_f32_16x16x32_bf16 a[84:87], a[184:187], a[36:39], a[84:87]
    v_mfma_f32_16x16x32_bf16 a[88:91], a[168:171], a[32:35], a[88:91]
    buffer_load_dwordx4 a[20:23], v10, s[44:47], s49 offen offset:1024 sc1
    v_mfma_f32_16x16x32_bf16 a[88:91], a[188:191], a[36:39], a[88:91]
    v_mfma_f32_16x16x32_bf16 a[92:95], a[172:175], a[32:35], a[92:95]
    v_mfma_f32_16x16x32_bf16 a[92:95], a[192:195], a[36:39], a[92:95]
    buffer_load_dwordx4 a[24:27], v10, s[44:47], s49 offen offset:2048 sc1
    v_mfma_f32_16x16x32_bf16 a[96:99], a[176:179], a[32:35], a[96:99]
    v_mfma_f32_16x16x32_bf16 a[96:99], a[196:199], a[36:39], a[96:99]
    s_waitcnt vmcnt(17)
    s_waitcnt vmcnt(16)
    v_mfma_f32_16x16x32_bf16 a[80:83], a[200:203], a[40:43], a[80:83]
    buffer_load_dwordx4 a[28:31], v10, s[44:47], s49 offen offset:3072 sc1
    v_mfma_f32_16x16x32_bf16 a[80:83], a[220:223], a[44:47], a[80:83]
    s_add_u32 s49, s73, 1781760
    v_mfma_f32_16x16x32_bf16 a[84:87], a[204:207], a[40:43], a[84:87]
    v_mfma_f32_16x16x32_bf16 a[84:87], a[224:227], a[44:47], a[84:87]
    buffer_load_dwordx4 a[32:35], v10, s[44:47], s49 offen offset:0 sc1
    v_mfma_f32_16x16x32_bf16 a[88:91], a[208:211], a[40:43], a[88:91]
    v_mfma_f32_16x16x32_bf16 a[88:91], a[228:231], a[44:47], a[88:91]
    v_mfma_f32_16x16x32_bf16 a[92:95], a[212:215], a[40:43], a[92:95]
    buffer_load_dwordx4 a[36:39], v6, s[44:47], s49 offen offset:1024 sc1
    v_mfma_f32_16x16x32_bf16 a[92:95], a[232:235], a[44:47], a[92:95]
    v_mfma_f32_16x16x32_bf16 a[96:99], a[216:219], a[40:43], a[96:99]
    v_mfma_f32_16x16x32_bf16 a[96:99], a[236:239], a[44:47], a[96:99]
    s_waitcnt vmcnt(17)
    s_waitcnt vmcnt(16)
    v_mfma_f32_16x16x32_bf16 a[80:83], a[240:243], a[48:51], a[80:83]
    v_mfma_f32_16x16x32_bf16 a[80:83], a[60:63], a[52:55], a[80:83]
    v_mfma_f32_16x16x32_bf16 a[84:87], a[244:247], a[48:51], a[84:87]
    v_mfma_f32_16x16x32_bf16 a[84:87], a[64:67], a[52:55], a[84:87]
    v_mfma_f32_16x16x32_bf16 a[88:91], a[248:251], a[48:51], a[88:91]
    v_mfma_f32_16x16x32_bf16 a[88:91], a[68:71], a[52:55], a[88:91]
    v_mfma_f32_16x16x32_bf16 a[92:95], a[252:255], a[48:51], a[92:95]
    s_add_u32 s57, s54, 458752
    v_mfma_f32_16x16x32_bf16 a[92:95], a[72:75], a[52:55], a[92:95]
    s_waitcnt vmcnt(12)
    s_barrier
    v_mfma_f32_16x16x32_bf16 a[96:99], a[56:59], a[48:51], a[96:99]
    buffer_store_dword v11, v9, s[44:47], s57 offen sc1
    v_mfma_f32_16x16x32_bf16 a[96:99], a[76:79], a[52:55], a[96:99]
    s_waitcnt vmcnt(16)
    s_waitcnt vmcnt(15)
    v_mfma_f32_16x16x32_bf16 a[100:103], v[96:99], a[120:123], 0
    s_waitcnt lgkmcnt(0)
    v_mfma_f32_16x16x32_bf16 a[100:103], v[116:119], a[124:127], a[100:103]
    s_mov_b32 s13, s12
    s_xor_b64 s[6:7], s[6:7], s[4:5]
    s_xor_b64 s[8:9], s[8:9], s[4:5]
    v_mfma_f32_16x16x32_bf16 a[104:107], v[100:103], a[120:123], 0
    s_xor_b64 s[10:11], s[10:11], s[4:5]
    s_xor_b64 s[12:13], s[12:13], s[4:5]
    s_or_b64 s[6:7], s[6:7], s[8:9]
    v_mfma_f32_16x16x32_bf16 a[104:107], v[120:123], a[124:127], a[104:107]
    s_or_b64 s[10:11], s[10:11], s[12:13]
    ds_write_b128 v2, a[80:83] offset:0
    v_mfma_f32_16x16x32_bf16 a[108:111], v[104:107], a[120:123], 0
    s_or_b64 s[6:7], s[6:7], s[10:11]
    s_cbranch_scc1 L_g2p2r
L_g2p2b:
    s_add_u32 s49, s73, 3538944
    v_mfma_f32_16x16x32_bf16 a[108:111], v[124:127], a[124:127], a[108:111]
    s_add_u32 s63, s61, 655360
    buffer_load_dwordx4 a[40:43], v10, s[44:47], s49 offen offset:0 sc1
    buffer_load_dwordx4 v[72:75], v90, s[44:47], s63 offen sc1
    v_mfma_f32_16x16x32_bf16 a[112:115], v[108:111], a[120:123], 0
    s_add_u32 s64, s62, 65536
    v_mfma_f32_16x16x32_bf16 a[112:115], v[128:131], a[124:127], a[112:115]
    buffer_load_dwordx4 a[44:47], v10, s[44:47], s49 offen offset:1024 sc1
    v_mfma_f32_16x16x32_bf16 a[116:119], v[112:115], a[120:123], 0
    ds_write_b128 v2, a[84:87] offset:1152
    v_mfma_f32_16x16x32_bf16 a[116:119], v[132:135], a[124:127], a[116:119]
    s_waitcnt vmcnt(17)
    s_waitcnt vmcnt(14)
    buffer_load_dwordx4 v[64:67], v91, s[44:47], s64 offen sc1
    v_mfma_f32_16x16x32_bf16 a[100:103], v[136:139], a[128:131], a[100:103]
    buffer_load_dwordx4 a[48:51], v10, s[44:47], s49 offen offset:2048 sc1
    v_mfma_f32_16x16x32_bf16 a[100:103], v[156:159], a[132:135], a[100:103]
    ds_write_b128 v2, a[88:91] offset:2304
    v_mfma_f32_16x16x32_bf16 a[104:107], v[140:143], a[128:131], a[104:107]
    v_mfma_f32_16x16x32_bf16 a[104:107], v[160:163], a[132:135], a[104:107]
    s_waitcnt vmcnt(24)
    buffer_load_dwordx4 a[52:55], v10, s[44:47], s49 offen offset:3072 sc1
    v_xor_b32 v76, v11, v60
    v_mfma_f32_16x16x32_bf16 a[108:111], v[144:147], a[128:131], a[108:111]
    s_add_u32 s49, s73, 3543040
    v_bitop3_b32 v76, v63, v11, v76 bitop3:0xbe
    v_cmp_ne_u32 vcc, 0, v76
    v_mfma_f32_16x16x32_bf16 a[108:111], v[164:167], a[132:135], a[108:111]
    s_cbranch_vccnz L_g2s0r
L_g2s0b:
    ds_write_b128 v2, a[92:95] offset:3456
    v_mfma_f32_16x16x32_bf16 a[112:115], v[148:151], a[128:131], a[112:115]
    buffer_load_dwordx4 a[120:123], v10, s[44:47], s49 offen offset:0 sc1
    v_lshlrev_b32 v76, 16, v68
    v_mfma_f32_16x16x32_bf16 a[112:115], v[168:171], a[132:135], a[112:115]
    v_and_b32 v77, s26, v68
    v_lshlrev_b32 v78, 16, v69
    v_mfma_f32_16x16x32_bf16 a[116:119], v[152:155], a[128:131], a[116:119]
    v_and_b32 v79, s26, v69
    v_lshlrev_b32 v80, 16, v70
    v_mfma_f32_16x16x32_bf16 a[116:119], v[172:175], a[132:135], a[116:119]
    s_waitcnt vmcnt(17)
    s_waitcnt vmcnt(16)
    buffer_load_dwordx4 a[124:127], v10, s[44:47], s49 offen offset:1024 sc1
    v_mfma_f32_16x16x32_bf16 a[100:103], v[176:179], a[0:3], a[100:103]
    ds_write_b128 v2, a[96:99] offset:4608
    v_mfma_f32_16x16x32_bf16 a[100:103], v[196:199], a[4:7], a[100:103]
    v_and_b32 v81, s26, v70
    v_lshlrev_b32 v82, 16, v71
    v_mfma_f32_16x16x32_bf16 a[104:107], v[180:183], a[0:3], a[104:107]
    buffer_load_dwordx4 a[128:131], v10, s[44:47], s49 offen offset:2048 sc1
    v_and_b32 v83, s26, v71
    v_mfma_f32_16x16x32_bf16 a[104:107], v[200:203], a[4:7], a[104:107]
    v_fma_f32 v76, v76, v62, v61
    v_fma_f32 v77, v77, v62, v61
    v_mfma_f32_16x16x32_bf16 a[108:111], v[184:187], a[0:3], a[108:111]
    v_fma_f32 v78, v78, v62, v61
    v_fma_f32 v79, v79, v62, v61
    v_mfma_f32_16x16x32_bf16 a[108:111], v[204:207], a[4:7], a[108:111]
    buffer_load_dwordx4 a[132:135], v10, s[44:47], s49 offen offset:3072 sc1
    v_fma_f32 v80, v80, v62, v61
    v_mfma_f32_16x16x32_bf16 a[112:115], v[188:191], a[0:3], a[112:115]
    s_add_u32 s49, s73, 3547136
    v_fma_f32 v81, v81, v62, v61
    v_fma_f32 v82, v82, v62, v61
    v_mfma_f32_16x16x32_bf16 a[112:115], v[208:211], a[4:7], a[112:115]
    s_waitcnt lgkmcnt(0)
    s_barrier
    v_fma_f32 v83, v83, v62, v61
    v_mfma_f32_16x16x32_bf16 a[116:119], v[192:195], a[0:3], a[116:119]
    buffer_load_dwordx4 a[0:3], v10, s[44:47], s49 offen offset:0 sc1
    ds_read_b128 v[12:15], v3 offset:0
    v_mfma_f32_16x16x32_bf16 a[116:119], v[212:215], a[4:7], a[116:119]
    s_waitcnt vmcnt(19)
    s_waitcnt vmcnt(18)
    ds_read_b128 v[16:19], v3 offset:288
    v_mfma_f32_16x16x32_bf16 a[100:103], v[216:219], a[8:11], a[100:103]
    ds_read_b128 v[20:23], v3 offset:5760
    v_mfma_f32_16x16x32_bf16 a[100:103], v[236:239], a[12:15], a[100:103]
    buffer_load_dwordx4 a[4:7], v10, s[44:47], s49 offen offset:1024 sc1
    ds_read_b128 v[24:27], v3 offset:6048
    v_mfma_f32_16x16x32_bf16 a[104:107], v[220:223], a[8:11], a[104:107]
    ds_read_b128 v[28:31], v3 offset:11520
    v_mfma_f32_16x16x32_bf16 a[104:107], v[240:243], a[12:15], a[104:107]
    ds_read_b128 v[32:35], v3 offset:11808
    v_mfma_f32_16x16x32_bf16 a[108:111], v[224:227], a[8:11], a[108:111]
    ds_read_b128 v[36:39], v3 offset:17280
    v_mfma_f32_16x16x32_bf16 a[108:111], v[244:247], a[12:15], a[108:111]
    ds_read_b128 v[40:43], v3 offset:17568
    v_mfma_f32_16x16x32_bf16 a[112:115], v[228:231], a[8:11], a[112:115]
    v_mfma_f32_16x16x32_bf16 a[112:115], v[248:251], a[12:15], a[112:115]
    v_mfma_f32_16x16x32_bf16 a[116:119], v[232:235], a[8:11], a[116:119]
    v_mfma_f32_16x16x32_bf16 a[116:119], v[252:255], a[12:15], a[116:119]
    s_waitcnt vmcnt(18)
    s_waitcnt vmcnt(17)
    v_mfma_f32_16x16x32_bf16 a[100:103], a[160:163], a[16:19], a[100:103]
    s_add_u32 s65, s60, 0
    buffer_load_dwordx4 a[8:11], v10, s[44:47], s49 offen offset:2048 sc1
    v_mfma_f32_16x16x32_bf16 a[100:103], a[180:183], a[20:23], a[100:103]
    s_waitcnt lgkmcnt(6)
    v_add_f32 v76, v76, v12
    v_add_f32 v77, v77, v13
    v_mfma_f32_16x16x32_bf16 a[104:107], a[164:167], a[16:19], a[104:107]
    v_add_f32 v78, v78, v14
    v_add_f32 v79, v79, v15
    v_mfma_f32_16x16x32_bf16 a[104:107], a[184:187], a[20:23], a[104:107]
    buffer_load_dwordx4 a[12:15], v10, s[44:47], s49 offen offset:3072 sc1
    v_add_f32 v80, v80, v16
    v_mfma_f32_16x16x32_bf16 a[108:111], a[168:171], a[16:19], a[108:111]
    v_add_f32 v81, v81, v17
    v_add_f32 v82, v82, v18
    v_mfma_f32_16x16x32_bf16 a[108:111], a[188:191], a[20:23], a[108:111]
    v_add_f32 v83, v83, v19
    s_waitcnt lgkmcnt(4)
    v_mfma_f32_16x16x32_bf16 a[112:115], a[172:175], a[16:19], a[112:115]
    v_add_f32 v76, v76, v20
    v_add_f32 v77, v77, v21
    v_mfma_f32_16x16x32_bf16 a[112:115], a[192:195], a[20:23], a[112:115]
    s_add_u32 s49, s73, 3551232
    v_add_f32 v78, v78, v22
    v_add_f32 v79, v79, v23
    v_mfma_f32_16x16x32_bf16 a[116:119], a[176:179], a[16:19], a[116:119]
    v_add_f32 v80, v80, v24
    v_add_f32 v81, v81, v25
    v_mfma_f32_16x16x32_bf16 a[116:119], a[196:199], a[20:23], a[116:119]
    s_waitcnt vmcnt(18)
    s_waitcnt vmcnt(17)
    buffer_load_dwordx4 a[16:19], v10, s[44:47], s49 offen offset:0 sc1
    v_mfma_f32_16x16x32_bf16 a[100:103], a[200:203], a[24:27], a[100:103]
    v_add_f32 v82, v82, v26
    v_add_f32 v83, v83, v27
    v_mfma_f32_16x16x32_bf16 a[100:103], a[220:223], a[28:31], a[100:103]
    s_waitcnt lgkmcnt(2)
    v_add_f32 v76, v76, v28
    v_add_f32 v77, v77, v29
    v_mfma_f32_16x16x32_bf16 a[104:107], a[204:207], a[24:27], a[104:107]
    buffer_load_dwordx4 a[20:23], v6, s[44:47], s49 offen offset:1024 sc1
    v_add_f32 v78, v78, v30
    v_mfma_f32_16x16x32_bf16 a[104:107], a[224:227], a[28:31], a[104:107]
    v_add_f32 v79, v79, v31
    v_add_f32 v80, v80, v32
    v_mfma_f32_16x16x32_bf16 a[108:111], a[208:211], a[24:27], a[108:111]
    v_add_f32 v81, v81, v33
    v_add_f32 v82, v82, v34
    v_mfma_f32_16x16x32_bf16 a[108:111], a[228:231], a[28:31], a[108:111]
    v_add_f32 v83, v83, v35
    s_waitcnt lgkmcnt(0)
    v_mfma_f32_16x16x32_bf16 a[112:115], a[212:215], a[24:27], a[112:115]
    v_add_f32 v76, v76, v36
    v_add_f32 v77, v77, v37
    v_mfma_f32_16x16x32_bf16 a[112:115], a[232:235], a[28:31], a[112:115]
    v_add_f32 v78, v78, v38
    v_add_f32 v79, v79, v39
    v_mfma_f32_16x16x32_bf16 a[116:119], a[216:219], a[24:27], a[116:119]
    v_add_f32 v80, v80, v40
    v_add_f32 v81, v81, v41
    v_mfma_f32_16x16x32_bf16 a[116:119], a[236:239], a[28:31], a[116:119]
    s_waitcnt vmcnt(18)
    s_waitcnt vmcnt(17)
    v_add_f32 v82, v82, v42
    v_mfma_f32_16x16x32_bf16 a[100:103], a[240:243], a[32:35], a[100:103]
    v_add_f32 v83, v83, v43
    v_cvt_pk_bf16_f32 v12, v76, v77
    v_mfma_f32_16x16x32_bf16 a[100:103], a[60:63], a[36:39], a[100:103]
    s_buffer_load_dword s6, s[44:47], s59 offset:393216
    s_buffer_load_dword s7, s[44:47], s59 offset:393472
    s_buffer_load_dword s8, s[44:47], s59 offset:393728
    v_mfma_f32_16x16x32_bf16 a[104:107], a[244:247], a[32:35], a[104:107]
    s_buffer_load_dword s9, s[44:47], s59 offset:393984
    s_buffer_load_dword s10, s[44:47], s59 offset:394240
    s_buffer_load_dword s11, s[44:47], s59 offset:394496
    v_mfma_f32_16x16x32_bf16 a[104:107], a[64:67], a[36:39], a[104:107]
    s_buffer_load_dword s12, s[44:47], s59 offset:394752
    v_cvt_pk_bf16_f32 v13, v78, v79
    v_cvt_pk_bf16_f32 v14, v80, v81
    v_mfma_f32_16x16x32_bf16 a[108:111], a[248:251], a[32:35], a[108:111]
    v_cvt_pk_bf16_f32 v15, v82, v83
    v_mfma_f32_16x16x32_bf16 a[108:111], a[68:71], a[36:39], a[108:111]
    buffer_store_dwordx4 v[12:15], v4, s[32:35], s65 offen nt
    v_mfma_f32_16x16x32_bf16 a[112:115], a[252:255], a[32:35], a[112:115]
    v_mfma_f32_16x16x32_bf16 a[112:115], a[72:75], a[36:39], a[112:115]
    v_mfma_f32_16x16x32_bf16 a[116:119], a[56:59], a[32:35], a[116:119]
    v_mfma_f32_16x16x32_bf16 a[116:119], a[76:79], a[36:39], a[116:119]
    s_waitcnt vmcnt(16)
    s_waitcnt vmcnt(14)
    v_mfma_f32_16x16x32_bf16 a[80:83], v[96:99], a[40:43], 0
    s_add_u32 s63, s61, 1310720
    v_mfma_f32_16x16x32_bf16 a[80:83], v[116:119], a[44:47], a[80:83]
    v_mfma_f32_16x16x32_bf16 a[84:87], v[100:103], a[40:43], 0
    v_mfma_f32_16x16x32_bf16 a[84:87], v[120:123], a[44:47], a[84:87]
    ds_write_b128 v2, a[100:103] offset:23040
    v_mfma_f32_16x16x32_bf16 a[88:91], v[104:107], a[40:43], 0
    buffer_load_dwordx4 v[68:71], v90, s[44:47], s63 offen sc1
    v_mfma_f32_16x16x32_bf16 a[88:91], v[124:127], a[44:47], a[88:91]
    s_add_u32 s64, s62, 131072
    v_mfma_f32_16x16x32_bf16 a[92:95], v[108:111], a[40:43], 0
    v_mfma_f32_16x16x32_bf16 a[92:95], v[128:131], a[44:47], a[92:95]
    ds_write_b128 v2, a[104:107] offset:24192
    v_mfma_f32_16x16x32_bf16 a[96:99], v[112:115], a[40:43], 0
    buffer_load_dwordx4 v[60:63], v91, s[44:47], s64 offen sc1
    v_mfma_f32_16x16x32_bf16 a[96:99], v[132:135], a[44:47], a[96:99]
    s_waitcnt vmcnt(14)
    s_waitcnt vmcnt(13)
    v_mfma_f32_16x16x32_bf16 a[80:83], v[136:139], a[48:51], a[80:83]
    v_mfma_f32_16x16x32_bf16 a[80:83], v[156:159], a[52:55], a[80:83]
    ds_write_b128 v2, a[108:111] offset:25344
    v_mfma_f32_16x16x32_bf16 a[84:87], v[140:143], a[48:51], a[84:87]
    v_mfma_f32_16x16x32_bf16 a[84:87], v[160:163], a[52:55], a[84:87]
    s_waitcnt vmcnt(15)
    v_xor_b32 v76, v11, v64
    v_bitop3_b32 v76, v67, v11, v76 bitop3:0xbe
    v_mfma_f32_16x16x32_bf16 a[88:91], v[144:147], a[48:51], a[88:91]
    v_cmp_ne_u32 vcc, 0, v76
    s_nop 0
    s_cbranch_vccnz L_g2s1r
L_g2s1b:
    v_mfma_f32_16x16x32_bf16 a[88:91], v[164:167], a[52:55], a[88:91]
    ds_write_b128 v2, a[112:115] offset:26496
    v_mfma_f32_16x16x32_bf16 a[92:95], v[148:151], a[48:51], a[92:95]
    v_lshlrev_b32 v76, 16, v72
    v_and_b32 v77, s26, v72
    v_mfma_f32_16x16x32_bf16 a[92:95], v[168:171], a[52:55], a[92:95]
    v_lshlrev_b32 v78, 16, v73
    v_and_b32 v79, s26, v73
    v_mfma_f32_16x16x32_bf16 a[96:99], v[152:155], a[48:51], a[96:99]
    v_lshlrev_b32 v80, 16, v74
    v_and_b32 v81, s26, v74
    v_mfma_f32_16x16x32_bf16 a[96:99], v[172:175], a[52:55], a[96:99]
    s_waitcnt vmcnt(12)
    s_waitcnt vmcnt(11)
    s_waitcnt lgkmcnt(0)
    v_mfma_f32_16x16x32_bf16 a[80:83], v[176:179], a[120:123], a[80:83]
    s_mov_b32 s13, s12
    ds_write_b128 v2, a[116:119] offset:27648
    v_mfma_f32_16x16x32_bf16 a[80:83], v[196:199], a[124:127], a[80:83]
    s_xor_b64 s[6:7], s[6:7], s[4:5]
    s_xor_b64 s[8:9], s[8:9], s[4:5]
    s_xor_b64 s[10:11], s[10:11], s[4:5]
    v_mfma_f32_16x16x32_bf16 a[84:87], v[180:183], a[120:123], a[84:87]
    s_xor_b64 s[12:13], s[12:13], s[4:5]
    s_or_b64 s[6:7], s[6:7], s[8:9]
    s_or_b64 s[10:11], s[10:11], s[12:13]
    v_mfma_f32_16x16x32_bf16 a[84:87], v[200:203], a[124:127], a[84:87]
    s_or_b64 s[6:7], s[6:7], s[10:11]
    s_cbranch_scc1 L_g2p3r
L_g2p3b:
    s_add_u32 s49, s73, 5308416
    v_mfma_f32_16x16x32_bf16 a[88:91], v[184:187], a[120:123], a[88:91]
    buffer_load_dwordx4 a[24:27], v10, s[44:47], s49 offen offset:0 sc1
    buffer_load_dwordx4 a[28:31], v10, s[44:47], s49 offen offset:1024 sc1
    v_mfma_f32_16x16x32_bf16 a[88:91], v[204:207], a[124:127], a[88:91]
    v_lshlrev_b32 v82, 16, v75
    v_and_b32 v83, s26, v75
    v_mfma_f32_16x16x32_bf16 a[92:95], v[188:191], a[120:123], a[92:95]
    v_fma_f32 v76, v76, v66, v65
    v_fma_f32 v77, v77, v66, v65
    v_mfma_f32_16x16x32_bf16 a[92:95], v[208:211], a[124:127], a[92:95]
    s_waitcnt lgkmcnt(0)
    buffer_load_dwordx4 a[32:35], v10, s[44:47], s49 offen offset:2048 sc1
    s_barrier
    v_mfma_f32_16x16x32_bf16 a[96:99], v[192:195], a[120:123], a[96:99]
    ds_read_b128 v[12:15], v3 offset:23040
    v_fma_f32 v78, v78, v66, v65
    v_mfma_f32_16x16x32_bf16 a[96:99], v[212:215], a[124:127], a[96:99]
    s_waitcnt vmcnt(13)
    s_waitcnt vmcnt(12)
    ds_read_b128 v[16:19], v3 offset:23328
    v_mfma_f32_16x16x32_bf16 a[80:83], v[216:219], a[128:131], a[80:83]
    buffer_load_dwordx4 a[36:39], v10, s[44:47], s49 offen offset:3072 sc1
    ds_read_b128 v[20:23], v3 offset:28800
    v_mfma_f32_16x16x32_bf16 a[80:83], v[236:239], a[132:135], a[80:83]
    s_add_u32 s49, s73, 5312512
    ds_read_b128 v[24:27], v3 offset:29088
    v_fma_f32 v79, v79, v66, v65
    v_mfma_f32_16x16x32_bf16 a[84:87], v[220:223], a[128:131], a[84:87]
    ds_read_b128 v[28:31], v3 offset:34560
    v_fma_f32 v80, v80, v66, v65
    v_mfma_f32_16x16x32_bf16 a[84:87], v[240:243], a[132:135], a[84:87]
    buffer_load_dwordx4 a[40:43], v10, s[44:47], s49 offen offset:0 sc1
    ds_read_b128 v[32:35], v3 offset:34848
    v_mfma_f32_16x16x32_bf16 a[88:91], v[224:227], a[128:131], a[88:91]
    ds_read_b128 v[36:39], v3 offset:40320
    v_fma_f32 v81, v81, v66, v65
    v_mfma_f32_16x16x32_bf16 a[88:91], v[244:247], a[132:135], a[88:91]
    ds_read_b128 v[40:43], v3 offset:40608
    v_fma_f32 v82, v82, v66, v65
    v_mfma_f32_16x16x32_bf16 a[92:95], v[228:231], a[128:131], a[92:95]
    buffer_load_dwordx4 a[44:47], v10, s[44:47], s49 offen offset:1024 sc1
    v_fma_f32 v83, v83, v66, v65
    v_mfma_f32_16x16x32_bf16 a[92:95], v[248:251], a[132:135], a[92:95]
    v_mfma_f32_16x16x32_bf16 a[96:99], v[232:235], a[128:131], a[96:99]
    v_mfma_f32_16x16x32_bf16 a[96:99], v[252:255], a[132:135], a[96:99]
    s_waitcnt vmcnt(14)
    s_waitcnt vmcnt(13)
    buffer_load_dwordx4 a[48:51], v10, s[44:47], s49 offen offset:2048 sc1
    v_mfma_f32_16x16x32_bf16 a[80:83], a[160:163], a[0:3], a[80:83]
    s_add_u32 s65, s60, 655360
    v_mfma_f32_16x16x32_bf16 a[80:83], a[180:183], a[4:7], a[80:83]
    s_waitcnt lgkmcnt(6)
    v_add_f32 v76, v76, v12
    v_add_f32 v77, v77, v13
    v_mfma_f32_16x16x32_bf16 a[84:87], a[164:167], a[0:3], a[84:87]
    buffer_load_dwordx4 a[52:55], v10, s[44:47], s49 offen offset:3072 sc1
    v_add_f32 v78, v78, v14
    v_mfma_f32_16x16x32_bf16 a[84:87], a[184:187], a[4:7], a[84:87]
    s_add_u32 s49, s73, 5316608
    v_add_f32 v79, v79, v15
    v_add_f32 v80, v80, v16
    v_mfma_f32_16x16x32_bf16 a[88:91], a[168:171], a[0:3], a[88:91]
    v_add_f32 v81, v81, v17
    v_add_f32 v82, v82, v18
    v_mfma_f32_16x16x32_bf16 a[88:91], a[188:191], a[4:7], a[88:91]
    buffer_load_dwordx4 a[120:123], v10, s[44:47], s49 offen offset:0 sc1
    v_add_f32 v83, v83, v19
    v_mfma_f32_16x16x32_bf16 a[92:95], a[172:175], a[0:3], a[92:95]
    s_waitcnt lgkmcnt(4)
    v_add_f32 v76, v76, v20
    v_add_f32 v77, v77, v21
    v_mfma_f32_16x16x32_bf16 a[92:95], a[192:195], a[4:7], a[92:95]
    v_add_f32 v78, v78, v22
    v_add_f32 v79, v79, v23
    v_mfma_f32_16x16x32_bf16 a[96:99], a[176:179], a[0:3], a[96:99]
    buffer_load_dwordx4 a[124:127], v10, s[44:47], s49 offen offset:1024 sc1
    v_add_f32 v80, v80, v24
    v_mfma_f32_16x16x32_bf16 a[96:99], a[196:199], a[4:7], a[96:99]
    s_waitcnt vmcnt(16)
    s_waitcnt vmcnt(15)
    v_add_f32 v81, v81, v25
    v_mfma_f32_16x16x32_bf16 a[80:83], a[200:203], a[8:11], a[80:83]
    v_add_f32 v82, v82, v26
    v_add_f32 v83, v83, v27
    v_mfma_f32_16x16x32_bf16 a[80:83], a[220:223], a[12:15], a[80:83]
    s_waitcnt lgkmcnt(2)
    buffer_load_dwordx4 a[128:131], v10, s[44:47], s49 offen offset:2048 sc1
    v_add_f32 v76, v76, v28
    v_mfma_f32_16x16x32_bf16 a[84:87], a[204:207], a[8:11], a[84:87]
    v_add_f32 v77, v77, v29
    v_add_f32 v78, v78, v30
    v_mfma_f32_16x16x32_bf16 a[84:87], a[224:227], a[12:15], a[84:87]
    v_add_f32 v79, v79, v31
    v_add_f32 v80, v80, v32
    v_mfma_f32_16x16x32_bf16 a[88:91], a[208:211], a[8:11], a[88:91]
    buffer_load_dwordx4 a[132:135], v10, s[44:47], s49 offen offset:3072 sc1
    v_add_f32 v81, v81, v33
    v_mfma_f32_16x16x32_bf16 a[88:91], a[228:231], a[12:15], a[88:91]
    s_add_u32 s49, s73, 5320704
    v_add_f32 v82, v82, v34
    v_add_f32 v83, v83, v35
    v_mfma_f32_16x16x32_bf16 a[92:95], a[212:215], a[8:11], a[92:95]
    s_waitcnt lgkmcnt(0)
    v_add_f32 v76, v76, v36
    v_add_f32 v77, v77, v37
    v_mfma_f32_16x16x32_bf16 a[92:95], a[232:235], a[12:15], a[92:95]
    buffer_load_dwordx4 a[0:3], v10, s[44:47], s49 offen offset:0 sc1
    v_add_f32 v78, v78, v38
    v_mfma_f32_16x16x32_bf16 a[96:99], a[216:219], a[8:11], a[96:99]
    v_add_f32 v79, v79, v39
    v_add_f32 v80, v80, v40
    v_mfma_f32_16x16x32_bf16 a[96:99], a[236:239], a[12:15], a[96:99]
    s_waitcnt vmcnt(17)
    s_waitcnt vmcnt(16)
    v_add_f32 v81, v81, v41
    v_mfma_f32_16x16x32_bf16 a[80:83], a[240:243], a[16:19], a[80:83]
    buffer_load_dwordx4 a[4:7], v6, s[44:47], s49 offen offset:1024 sc1
    v_add_f32 v82, v82, v42
    v_mfma_f32_16x16x32_bf16 a[80:83], a[60:63], a[20:23], a[80:83]
    v_add_f32 v83, v83, v43
    v_cvt_pk_bf16_f32 v12, v76, v77
    v_mfma_f32_16x16x32_bf16 a[84:87], a[244:247], a[16:19], a[84:87]
    v_cvt_pk_bf16_f32 v13, v78, v79
    v_cvt_pk_bf16_f32 v14, v80, v81
    v_mfma_f32_16x16x32_bf16 a[84:87], a[64:67], a[20:23], a[84:87]
    v_cvt_pk_bf16_f32 v15, v82, v83
    v_mfma_f32_16x16x32_bf16 a[88:91], a[248:251], a[16:19], a[88:91]
    buffer_store_dwordx4 v[12:15], v4, s[32:35], s65 offen nt
    v_mfma_f32_16x16x32_bf16 a[88:91], a[68:71], a[20:23], a[88:91]
    v_mfma_f32_16x16x32_bf16 a[92:95], a[252:255], a[16:19], a[92:95]
    v_mfma_f32_16x16x32_bf16 a[92:95], a[72:75], a[20:23], a[92:95]
    v_mfma_f32_16x16x32_bf16 a[96:99], a[56:59], a[16:19], a[96:99]
    v_mfma_f32_16x16x32_bf16 a[96:99], a[76:79], a[20:23], a[96:99]
    s_waitcnt vmcnt(14)
    s_waitcnt vmcnt(13)
    v_mfma_f32_16x16x32_bf16 a[100:103], v[96:99], a[24:27], 0
    s_add_u32 s63, s61, 1966080
    v_mfma_f32_16x16x32_bf16 a[100:103], v[116:119], a[28:31], a[100:103]
    v_mfma_f32_16x16x32_bf16 a[104:107], v[100:103], a[24:27], 0
    v_mfma_f32_16x16x32_bf16 a[104:107], v[120:123], a[28:31], a[104:107]
    ds_write_b128 v2, a[80:83] offset:0
    v_mfma_f32_16x16x32_bf16 a[108:111], v[104:107], a[24:27], 0
    buffer_load_dwordx4 v[72:75], v90, s[44:47], s63 offen sc1
    v_mfma_f32_16x16x32_bf16 a[108:111], v[124:127], a[28:31], a[108:111]
    s_add_u32 s64, s62, 196608
    v_mfma_f32_16x16x32_bf16 a[112:115], v[108:111], a[24:27], 0
    v_mfma_f32_16x16x32_bf16 a[112:115], v[128:131], a[28:31], a[112:115]
    ds_write_b128 v2, a[84:87] offset:1152
    v_mfma_f32_16x16x32_bf16 a[116:119], v[112:115], a[24:27], 0
    buffer_load_dwordx4 v[64:67], v91, s[44:47], s64 offen sc1
    v_mfma_f32_16x16x32_bf16 a[116:119], v[132:135], a[28:31], a[116:119]
    s_waitcnt vmcnt(14)
    s_waitcnt vmcnt(13)
    v_mfma_f32_16x16x32_bf16 a[100:103], v[136:139], a[32:35], a[100:103]
    v_mfma_f32_16x16x32_bf16 a[100:103], v[156:159], a[36:39], a[100:103]
    ds_write_b128 v2, a[88:91] offset:2304
    v_mfma_f32_16x16x32_bf16 a[104:107], v[140:143], a[32:35], a[104:107]
    v_mfma_f32_16x16x32_bf16 a[104:107], v[160:163], a[36:39], a[104:107]
    s_waitcnt vmcnt(17)
    v_xor_b32 v76, v11, v60
    v_bitop3_b32 v76, v63, v11, v76 bitop3:0xbe
    v_mfma_f32_16x16x32_bf16 a[108:111], v[144:147], a[32:35], a[108:111]
    v_cmp_ne_u32 vcc, 0, v76
    s_nop 0
    s_cbranch_vccnz L_g2s2r
L_g2s2b:
    v_mfma_f32_16x16x32_bf16 a[108:111], v[164:167], a[36:39], a[108:111]
    ds_write_b128 v2, a[92:95] offset:3456
    v_mfma_f32_16x16x32_bf16 a[112:115], v[148:151], a[32:35], a[112:115]
    v_lshlrev_b32 v76, 16, v68
    v_and_b32 v77, s26, v68
    v_mfma_f32_16x16x32_bf16 a[112:115], v[168:171], a[36:39], a[112:115]
    v_lshlrev_b32 v78, 16, v69
    v_and_b32 v79, s26, v69
    v_mfma_f32_16x16x32_bf16 a[116:119], v[152:155], a[32:35], a[116:119]
    v_lshlrev_b32 v80, 16, v70
    v_and_b32 v81, s26, v70
    v_mfma_f32_16x16x32_bf16 a[116:119], v[172:175], a[36:39], a[116:119]
    s_waitcnt vmcnt(12)
    s_waitcnt vmcnt(11)
    v_lshlrev_b32 v82, 16, v71
    v_mfma_f32_16x16x32_bf16 a[100:103], v[176:179], a[40:43], a[100:103]
    ds_write_b128 v2, a[96:99] offset:4608
    v_mfma_f32_16x16x32_bf16 a[100:103], v[196:199], a[44:47], a[100:103]
    v_and_b32 v83, s26, v71
    v_fma_f32 v76, v76, v62, v61
    v_mfma_f32_16x16x32_bf16 a[104:107], v[180:183], a[40:43], a[104:107]
    v_fma_f32 v77, v77, v62, v61
    v_fma_f32 v78, v78, v62, v61
    v_mfma_f32_16x16x32_bf16 a[104:107], v[200:203], a[44:47], a[104:107]
    v_fma_f32 v79, v79, v62, v61
    v_fma_f32 v80, v80, v62, v61
    v_mfma_f32_16x16x32_bf16 a[108:111], v[184:187], a[40:43], a[108:111]
    v_fma_f32 v81, v81, v62, v61
    v_fma_f32 v82, v82, v62, v61
    v_mfma_f32_16x16x32_bf16 a[108:111], v[204:207], a[44:47], a[108:111]
    v_fma_f32 v83, v83, v62, v61
    v_mfma_f32_16x16x32_bf16 a[112:115], v[188:191], a[40:43], a[112:115]
    v_mfma_f32_16x16x32_bf16 a[112:115], v[208:211], a[44:47], a[112:115]
    s_waitcnt lgkmcnt(0)
    s_barrier
    v_mfma_f32_16x16x32_bf16 a[116:119], v[192:195], a[40:43], a[116:119]
    ds_read_b128 v[12:15], v3 offset:0
    v_mfma_f32_16x16x32_bf16 a[116:119], v[212:215], a[44:47], a[116:119]
    s_waitcnt vmcnt(10)
    s_waitcnt vmcnt(9)
    ds_read_b128 v[16:19], v3 offset:288
    v_mfma_f32_16x16x32_bf16 a[100:103], v[216:219], a[48:51], a[100:103]
    ds_read_b128 v[20:23], v3 offset:5760
    v_mfma_f32_16x16x32_bf16 a[100:103], v[236:239], a[52:55], a[100:103]
    ds_read_b128 v[24:27], v3 offset:6048
    v_mfma_f32_16x16x32_bf16 a[104:107], v[220:223], a[48:51], a[104:107]
    ds_read_b128 v[28:31], v3 offset:11520
    v_mfma_f32_16x16x32_bf16 a[104:107], v[240:243], a[52:55], a[104:107]
    ds_read_b128 v[32:35], v3 offset:11808
    v_mfma_f32_16x16x32_bf16 a[108:111], v[224:227], a[48:51], a[108:111]
    ds_read_b128 v[36:39], v3 offset:17280
    v_mfma_f32_16x16x32_bf16 a[108:111], v[244:247], a[52:55], a[108:111]
    ds_read_b128 v[40:43], v3 offset:17568
    v_mfma_f32_16x16x32_bf16 a[112:115], v[228:231], a[48:51], a[112:115]
    s_add_u32 s65, s60, 1310720
    v_mfma_f32_16x16x32_bf16 a[112:115], v[248:251], a[52:55], a[112:115]
    s_waitcnt lgkmcnt(6)
    v_add_f32 v76, v76, v12
    v_add_f32 v77, v77, v13
    v_mfma_f32_16x16x32_bf16 a[116:119], v[232:235], a[48:51], a[116:119]
    v_add_f32 v78, v78, v14
    v_add_f32 v79, v79, v15
    v_mfma_f32_16x16x32_bf16 a[116:119], v[252:255], a[52:55], a[116:119]
    s_waitcnt vmcnt(8)
    s_waitcnt vmcnt(7)
    v_add_f32 v80, v80, v16
    v_mfma_f32_16x16x32_bf16 a[100:103], a[160:163], a[120:123], a[100:103]
    v_add_f32 v81, v81, v17
    v_add_f32 v82, v82, v18
    v_mfma_f32_16x16x32_bf16 a[100:103], a[180:183], a[124:127], a[100:103]
    v_add_f32 v83, v83, v19
    s_waitcnt lgkmcnt(4)
    v_mfma_f32_16x16x32_bf16 a[104:107], a[164:167], a[120:123], a[104:107]
    v_add_f32 v76, v76, v20
    v_add_f32 v77, v77, v21
    v_mfma_f32_16x16x32_bf16 a[104:107], a[184:187], a[124:127], a[104:107]
    v_add_f32 v78, v78, v22
    v_add_f32 v79, v79, v23
    v_mfma_f32_16x16x32_bf16 a[108:111], a[168:171], a[120:123], a[108:111]
    v_add_f32 v80, v80, v24
    v_add_f32 v81, v81, v25
    v_mfma_f32_16x16x32_bf16 a[108:111], a[188:191], a[124:127], a[108:111]
    v_add_f32 v82, v82, v26
    v_add_f32 v83, v83, v27
    v_mfma_f32_16x16x32_bf16 a[112:115], a[172:175], a[120:123], a[112:115]
    s_waitcnt lgkmcnt(2)
    v_add_f32 v76, v76, v28
    v_add_f32 v77, v77, v29
    v_mfma_f32_16x16x32_bf16 a[112:115], a[192:195], a[124:127], a[112:115]
    v_add_f32 v78, v78, v30
    v_add_f32 v79, v79, v31
    v_mfma_f32_16x16x32_bf16 a[116:119], a[176:179], a[120:123], a[116:119]
    v_add_f32 v80, v80, v32
    v_add_f32 v81, v81, v33
    v_mfma_f32_16x16x32_bf16 a[116:119], a[196:199], a[124:127], a[116:119]
    s_waitcnt vmcnt(6)
    s_waitcnt vmcnt(5)
    s_waitcnt vmcnt(4)
    s_waitcnt vmcnt(3)
    v_mfma_f32_16x16x32_bf16 a[100:103], a[200:203], a[128:131], a[100:103]
    s_waitcnt vmcnt(0)
    v_add_f32 v82, v82, v34
    v_add_f32 v83, v83, v35
    v_mfma_f32_16x16x32_bf16 a[100:103], a[220:223], a[132:135], a[100:103]
    s_waitcnt lgkmcnt(0)
    v_add_f32 v76, v76, v36
    v_add_f32 v77, v77, v37
    v_mfma_f32_16x16x32_bf16 a[100:103], a[240:243], a[0:3], a[100:103]
    v_add_f32 v78, v78, v38
    v_add_f32 v79, v79, v39
    v_mfma_f32_16x16x32_bf16 a[100:103], a[60:63], a[4:7], a[100:103]
    v_add_f32 v80, v80, v40
    v_add_f32 v81, v81, v41
    v_mfma_f32_16x16x32_bf16 a[104:107], a[204:207], a[128:131], a[104:107]
    v_add_f32 v82, v82, v42
    v_add_f32 v83, v83, v43
    v_mfma_f32_16x16x32_bf16 a[104:107], a[224:227], a[132:135], a[104:107]
    v_cvt_pk_bf16_f32 v12, v76, v77
    v_cvt_pk_bf16_f32 v13, v78, v79
    v_mfma_f32_16x16x32_bf16 a[104:107], a[244:247], a[0:3], a[104:107]
    ds_write_b128 v2, a[100:103] offset:23040
    v_mfma_f32_16x16x32_bf16 a[104:107], a[64:67], a[4:7], a[104:107]
    v_cvt_pk_bf16_f32 v14, v80, v81
    v_cvt_pk_bf16_f32 v15, v82, v83
    v_mfma_f32_16x16x32_bf16 a[108:111], a[208:211], a[128:131], a[108:111]
    buffer_store_dwordx4 v[12:15], v4, s[32:35], s65 offen nt
    v_mfma_f32_16x16x32_bf16 a[108:111], a[228:231], a[132:135], a[108:111]
    v_xor_b32 v44, v11, v64
    v_bitop3_b32 v44, v67, v11, v44 bitop3:0xbe
    v_mfma_f32_16x16x32_bf16 a[108:111], a[248:251], a[0:3], a[108:111]
    ds_write_b128 v2, a[104:107] offset:24192
    v_mfma_f32_16x16x32_bf16 a[108:111], a[68:71], a[4:7], a[108:111]
    v_cmp_ne_u32 vcc, 0, v44
    s_nop 0
    s_cbranch_vccnz L_g2s3r
L_g2s3b:
    v_mfma_f32_16x16x32_bf16 a[112:115], a[212:215], a[128:131], a[112:115]
    v_lshlrev_b32 v44, 16, v72
    v_and_b32 v45, s26, v72
    v_mfma_f32_16x16x32_bf16 a[112:115], a[232:235], a[132:135], a[112:115]
    v_lshlrev_b32 v46, 16, v73
    v_and_b32 v47, s26, v73
    v_mfma_f32_16x16x32_bf16 a[112:115], a[252:255], a[0:3], a[112:115]
    ds_write_b128 v2, a[108:111] offset:25344
    v_mfma_f32_16x16x32_bf16 a[112:115], a[72:75], a[4:7], a[112:115]
    v_lshlrev_b32 v48, 16, v74
    v_and_b32 v49, s26, v74
    v_mfma_f32_16x16x32_bf16 a[116:119], a[216:219], a[128:131], a[116:119]
    v_lshlrev_b32 v50, 16, v75
    v_and_b32 v51, s26, v75
    v_mfma_f32_16x16x32_bf16 a[116:119], a[236:239], a[132:135], a[116:119]
    v_fma_f32 v44, v44, v66, v65
    v_fma_f32 v45, v45, v66, v65
    v_mfma_f32_16x16x32_bf16 a[116:119], a[56:59], a[0:3], a[116:119]
    ds_write_b128 v2, a[112:115] offset:26496
    v_mfma_f32_16x16x32_bf16 a[116:119], a[76:79], a[4:7], a[116:119]
    s_nop 7
    ds_write_b128 v2, a[116:119] offset:27648
    v_fma_f32 v46, v46, v66, v65
    v_fma_f32 v47, v47, v66, v65
    v_fma_f32 v48, v48, v66, v65
    v_fma_f32 v49, v49, v66, v65
    v_fma_f32 v50, v50, v66, v65
    v_fma_f32 v51, v51, v66, v65
    s_waitcnt lgkmcnt(0)
    s_barrier
    ds_read_b128 v[12:15], v3 offset:23040
    ds_read_b128 v[16:19], v3 offset:23328
    ds_read_b128 v[20:23], v3 offset:28800
    ds_read_b128 v[24:27], v3 offset:29088
    ds_read_b128 v[28:31], v3 offset:34560
    ds_read_b128 v[32:35], v3 offset:34848
    ds_read_b128 v[36:39], v3 offset:40320
    ds_read_b128 v[40:43], v3 offset:40608
    s_add_u32 s65, s60, 1966080
    s_waitcnt lgkmcnt(6)
    v_pk_add_f32 v[44:45], v[44:45], v[12:13]
    v_pk_add_f32 v[46:47], v[46:47], v[14:15]
    v_pk_add_f32 v[48:49], v[48:49], v[16:17]
    v_pk_add_f32 v[50:51], v[50:51], v[18:19]
    s_waitcnt lgkmcnt(4)
    v_pk_add_f32 v[44:45], v[44:45], v[20:21]
    v_pk_add_f32 v[46:47], v[46:47], v[22:23]
    v_pk_add_f32 v[48:49], v[48:49], v[24:25]
    v_pk_add_f32 v[50:51], v[50:51], v[26:27]
    s_waitcnt lgkmcnt(2)
    v_pk_add_f32 v[44:45], v[44:45], v[28:29]
    v_pk_add_f32 v[46:47], v[46:47], v[30:31]
    v_pk_add_f32 v[48:49], v[48:49], v[32:33]
    v_pk_add_f32 v[50:51], v[50:51], v[34:35]
    s_waitcnt lgkmcnt(0)
    v_pk_add_f32 v[44:45], v[44:45], v[36:37]
    v_pk_add_f32 v[46:47], v[46:47], v[38:39]
    v_pk_add_f32 v[48:49], v[48:49], v[40:41]
    v_pk_add_f32 v[50:51], v[50:51], v[42:43]
    v_cvt_pk_bf16_f32 v12, v44, v45
    v_cvt_pk_bf16_f32 v13, v46, v47
    v_cvt_pk_bf16_f32 v14, v48, v49
    v_cvt_pk_bf16_f32 v15, v50, v51
    buffer_store_dwordx4 v[12:15], v4, s[32:35], s65 offen
L_end:
    s_endpgm
L_nc:
    s_and_b32 s53, s53, 0xffff
    s_mov_b32 s54, L_code_end-L_pc
    s_mov_b32 s55, 0x20000
    s_sub_u32 s30, s96, 20
    s_and_b32 s30, s30, 15
    s_lshl_b32 s30, s30, 7
    v_mul_u32_u24 v9, 1536, v0
    buffer_load_dword v253, v9, s[52:55], s30 offen
    s_waitcnt lgkmcnt(0)
    s_add_u32 s30, s28, 41943040
    s_addc_u32 s31, s29, 0
    s_load_dword s100, s[30:31], 0
    s_cmp_ge_u32 s96, 27
    s_cbranch_scc1 L_nf
    s_mov_b32 s44, s28
    s_and_b32 s45, s29, 0xffff
    s_mov_b32 s46, 268435456
    s_mov_b32 s47, 0x20000
    s_mov_b32 s26, 0xffff0000
    s_lshr_b32 s31, s97, 1
    s_add_u32 s31, s31, 2
    s_and_b32 s31, s31, 3
    s_add_u32 s30, s96, 3
    s_sub_u32 s30, s30, s31
    s_mul_i32 s30, s30, 21846
    s_lshr_b32 s30, s30, 16
    s_add_u32 s30, s30, s96
    s_lshl2_add_u32 s31, s96, s31
    s_sub_u32 s31, s31, 80
    s_min_u32 s31, s31, 26
    s_cmp_lt_u32 s96, 20
    s_cselect_b32 s31, s30, s31
    s_lshr_b32 s30, s97, 1
    s_mul_i32 s30, s30, 27
    s_add_u32 s30, s30, s31
    s_lshr_b32 s78, s30, 2
    s_and_b32 s77, s30, 3
    s_and_b32 s30, s97, 1
    s_lshl_b32 s30, s30, 2
    s_add_u32 s77, s77, s30
    v_lshrrev_b32 v30, 3, v1
    v_mul_u32_u24 v248, 3456, v30
    v_and_b32 v30, 2, v30
    v_and_b32 v31, 7, v1
    v_xor_b32 v30, v30, v31
    v_xor_b32 v31, 4, v30
    v_lshl_add_u32 v249, v31, 4, v248
    v_lshl_add_u32 v248, v30, 4, v248
    s_and_b32 s30, s3, 1
    s_mul_i32 s70, s30, 276480
    s_lshl_b32 s30, s78, 7
    s_add_u32 s70, s70, s30
    s_mul_i32 s71, s3, 10240
    s_cmp_ge_u32 s3, 2
    s_cselect_b32 s40, s20, s18
    s_cselect_b32 s41, s21, s19
    s_and_b32 s41, s41, 0xffff
    s_mov_b32 s42, 2211840
    s_mov_b32 s43, 0x20000
    v_lshrrev_b32 v30, 4, v1
    v_bfe_u32 v31, v1, 2, 2
    v_lshl_add_u32 v250, v30, 3, v31
    v_lshlrev_b32 v250, 7, v250
    v_bfe_u32 v30, v1, 3, 2
    v_xor_b32 v30, s3, v30
    v_lshl_add_u32 v250, v30, 5, v250
    v_and_b32 v30, 3, v1
    v_lshl_add_u32 v250, v30, 3, v250
    s_lshr_b32 s76, s97, 1
    s_lshl_b32 s76, s76, 3
    s_lshr_b32 s30, s96, 2
    s_add_u32 s76, s76, s30
    s_and_b32 s75, s97, 1
    s_lshl_b32 s75, s75, 2
    s_and_b32 s30, s96, 3
    s_add_u32 s75, s75, s30
    s_mul_i32 s74, s3, 14
    s_cmp_eq_u32 s3, 3
    s_cselect_b32 s74, 41, s74
    s_mul_i32 s72, s75, 276480
    s_mul_i32 s30, s74, 5120
    s_add_u32 s72, s72, s30
    s_add_u32 s72, s72, 20971520
    s_mul_i32 s73, s76, 55296
    s_lshl_b32 s30, s74, 10
    s_add_u32 s73, s73, s30
    s_add_u32 s73, s73, 12582912
    s_waitcnt lgkmcnt(0)
    s_mul_i32 s100, s100, 0x41c64e6d
    s_add_u32 s100, s100, 12345
    s_and_b32 s99, s100, 0x1fff
    s_or_b32 s99, s99, 0x4000
    s_lshl_b32 s98, s99, 16
    v_mov_b32 v11, s100
    s_mov_b32 s4, s100
    s_mov_b32 s5, s100
    s_sub_u32 s79, s2, 160
    s_min_u32 s79, s79, 53
    s_bitcmp1_b32 s77, 2
    s_cbranch_scc1 L_fpa
    s_add_u32 m0, s71, 40960
    s_add_u32 s31, s70, 0
    buffer_load_dwordx4 v248, s[40:43], s31 offen offset:0 lds
    s_add_u32 s31, s70, 26624
    buffer_load_dwordx4 v249, s[40:43], s31 offen offset:1024 lds
    s_add_u32 s31, s70, 53248
    buffer_load_dwordx4 v248, s[40:43], s31 offen offset:2048 lds
    s_add_u32 s31, s70, 79872
    buffer_load_dwordx4 v249, s[40:43], s31 offen offset:3072 lds
    s_add_u32 m0, s71, 45056
    s_add_u32 s31, s70, 110592
    buffer_load_dwordx4 v248, s[40:43], s31 offen offset:0 lds
    s_add_u32 s31, s70, 137216
    buffer_load_dwordx4 v249, s[40:43], s31 offen offset:1024 lds
    s_add_u32 s31, s70, 163840
    buffer_load_dwordx4 v248, s[40:43], s31 offen offset:2048 lds
    s_add_u32 s31, s70, 190464
    buffer_load_dwordx4 v249, s[40:43], s31 offen offset:3072 lds
    s_add_u32 m0, s71, 49152
    s_add_u32 s31, s70, 221184
    buffer_load_dwordx4 v248, s[40:43], s31 offen offset:0 lds
    s_add_u32 s31, s70, 247808
    buffer_load_dwordx4 v249, s[40:43], s31 offen offset:1024 lds
    s_add_u32 m0, s71, 122880
    s_add_u32 s31, s70, 1105920
    buffer_load_dwordx4 v248, s[40:43], s31 offen offset:0 lds
    s_add_u32 s31, s70, 1132544
    buffer_load_dwordx4 v249, s[40:43], s31 offen offset:1024 lds
    s_add_u32 s31, s70, 1159168
    buffer_load_dwordx4 v248, s[40:43], s31 offen offset:2048 lds
    s_add_u32 s31, s70, 1185792
    buffer_load_dwordx4 v249, s[40:43], s31 offen offset:3072 lds
    s_add_u32 m0, s71, 126976
    s_add_u32 s31, s70, 1216512
    buffer_load_dwordx4 v248, s[40:43], s31 offen offset:0 lds
    s_add_u32 s31, s70, 1243136
    buffer_load_dwordx4 v249, s[40:43], s31 offen offset:1024 lds
    s_add_u32 s31, s70, 1269760
    buffer_load_dwordx4 v248, s[40:43], s31 offen offset:2048 lds
    s_add_u32 s31, s70, 1296384
    buffer_load_dwordx4 v249, s[40:43], s31 offen offset:3072 lds
    s_add_u32 m0, s71, 131072
    s_add_u32 s31, s70, 1327104
    buffer_load_dwordx4 v248, s[40:43], s31 offen offset:0 lds
    s_add_u32 s31, s70, 1353728
    buffer_load_dwordx4 v249, s[40:43], s31 offen offset:1024 lds
L_fqa:
    s_mov_b32 s32, s22
    s_and_b32 s33, s23, 0xffff
    s_mov_b32 s34, 2211840
    s_mov_b32 s35, 0x20000
    s_mul_i32 s48, s79, 40960
    s_add_u32 s48, s48, s71
    v_lshrrev_b32 v3, 4, v1
    s_and_b32 s50, s3, 1
    s_lshl_b32 s50, s50, 2
    v_or_b32 v4, s50, v3
    v_lshlrev_b32 v4, 5, v4
    v_and_b32 v2, 0xff, v10
    v_xor_b32 v2, v2, v4
    v_mul_u32_u24 v4, 1280, v3
    v_add_u32 v2, v2, v4
    s_add_u32 m0, s71, 0
    s_add_u32 s50, s48, 0
    buffer_load_dwordx4 v2, s[32:35], s50 offen nt lds
    s_add_u32 m0, s71, 1024
    s_add_u32 s50, s48, 256
    buffer_load_dwordx4 v2, s[32:35], s50 offen nt lds
    s_add_u32 m0, s71, 2048
    s_add_u32 s50, s48, 512
    buffer_load_dwordx4 v2, s[32:35], s50 offen nt lds
    s_add_u32 m0, s71, 3072
    s_add_u32 s50, s48, 768
    buffer_load_dwordx4 v2, s[32:35], s50 offen nt lds
    s_add_u32 m0, s71, 4096
    s_add_u32 s50, s48, 1024
    buffer_load_dwordx4 v2, s[32:35], s50 offen nt lds
    s_add_u32 m0, s71, 5120
    s_add_u32 s50, s48, 5120
    buffer_load_dwordx4 v2, s[32:35], s50 offen nt lds
    s_add_u32 m0, s71, 6144
    s_add_u32 s50, s48, 5376
    buffer_load_dwordx4 v2, s[32:35], s50 offen nt lds
    s_add_u32 m0, s71, 7168
    s_add_u32 s50, s48, 5632
    buffer_load_dwordx4 v2, s[32:35], s50 offen nt lds
    s_add_u32 m0, s71, 8192
    s_add_u32 s50, s48, 5888
    buffer_load_dwordx4 v2, s[32:35], s50 offen nt lds
    s_add_u32 m0, s71, 9216
    s_add_u32 s50, s48, 6144
    buffer_load_dwordx4 v2, s[32:35], s50 offen nt lds
    s_waitcnt vmcnt(10)
    s_barrier
    s_bitcmp1_b32 s77, 2
    s_cbranch_scc1 L_fpb
    v_add_u32 v60, 40960, v250
    ds_read_b64_tr_b16 a[0:1], v60 offset:0
    ds_read_b64_tr_b16 a[2:3], v60 offset:512
    ds_read_b64_tr_b16 a[4:5], v60 offset:20480
    ds_read_b64_tr_b16 a[6:7], v60 offset:20992
    ds_read_b64_tr_b16 a[8:9], v60 offset:4096
    ds_read_b64_tr_b16 a[10:11], v60 offset:4608
    ds_read_b64_tr_b16 a[12:13], v60 offset:24576
    ds_read_b64_tr_b16 a[14:15], v60 offset:25088
    ds_read_b64_tr_b16 a[16:17], v60 offset:8192
    ds_read_b64_tr_b16 a[18:19], v60 offset:8704
    ds_read_b64_tr_b16 a[20:21], v60 offset:28672
    ds_read_b64_tr_b16 a[22:23], v60 offset:29184
    ds_read_b64_tr_b16 a[24:25], v60 offset:12288
    ds_read_b64_tr_b16 a[26:27], v60 offset:12800
    ds_read_b64_tr_b16 a[28:29], v60 offset:32768
    ds_read_b64_tr_b16 a[30:31], v60 offset:33280
    ds_read_b64_tr_b16 a[32:33], v60 offset:16384
    ds_read_b64_tr_b16 a[34:35], v60 offset:16896
    ds_read_b64_tr_b16 a[36:37], v60 offset:36864
    ds_read_b64_tr_b16 a[38:39], v60 offset:37376
    s_add_u32 m0, s71, 81920
    s_add_u32 s31, s70, 552960
    buffer_load_dwordx4 v248, s[40:43], s31 offen offset:0 lds
    s_add_u32 s31, s70, 579584
    buffer_load_dwordx4 v249, s[40:43], s31 offen offset:1024 lds
    s_add_u32 s31, s70, 606208
    buffer_load_dwordx4 v248, s[40:43], s31 offen offset:2048 lds
    s_add_u32 s31, s70, 632832
    buffer_load_dwordx4 v249, s[40:43], s31 offen offset:3072 lds
    s_add_u32 m0, s71, 86016
    s_add_u32 s31, s70, 663552
    buffer_load_dwordx4 v248, s[40:43], s31 offen offset:0 lds
    s_add_u32 s31, s70, 690176
    buffer_load_dwordx4 v249, s[40:43], s31 offen offset:1024 lds
    s_add_u32 s31, s70, 716800
    buffer_load_dwordx4 v248, s[40:43], s31 offen offset:2048 lds
    s_add_u32 s31, s70, 743424
    buffer_load_dwordx4 v249, s[40:43], s31 offen offset:3072 lds
    s_add_u32 m0, s71, 90112
    s_add_u32 s31, s70, 774144
    buffer_load_dwordx4 v248, s[40:43], s31 offen offset:0 lds
    s_add_u32 s31, s70, 800768
    buffer_load_dwordx4 v249, s[40:43], s31 offen offset:1024 lds
    v_add_u32 v61, 122880, v250
    ds_read_b64_tr_b16 a[80:81], v61 offset:0
    ds_read_b64_tr_b16 a[82:83], v61 offset:512
    ds_read_b64_tr_b16 a[84:85], v61 offset:20480
    ds_read_b64_tr_b16 a[86:87], v61 offset:20992
    ds_read_b64_tr_b16 a[88:89], v61 offset:4096
    ds_read_b64_tr_b16 a[90:91], v61 offset:4608
    ds_read_b64_tr_b16 a[92:93], v61 offset:24576
    ds_read_b64_tr_b16 a[94:95], v61 offset:25088
    ds_read_b64_tr_b16 a[96:97], v61 offset:8192
    ds_read_b64_tr_b16 a[98:99], v61 offset:8704
    ds_read_b64_tr_b16 a[100:101], v61 offset:28672
    ds_read_b64_tr_b16 a[102:103], v61 offset:29184
    ds_read_b64_tr_b16 a[104:105], v61 offset:12288
    ds_read_b64_tr_b16 a[106:107], v61 offset:12800
    ds_read_b64_tr_b16 a[108:109], v61 offset:32768
    ds_read_b64_tr_b16 a[110:111], v61 offset:33280
    ds_read_b64_tr_b16 a[112:113], v61 offset:16384
    ds_read_b64_tr_b16 a[114:115], v61 offset:16896
    ds_read_b64_tr_b16 a[116:117], v61 offset:36864
    ds_read_b64_tr_b16 a[118:119], v61 offset:37376
L_fqb:
    s_waitcnt lgkmcnt(0)
    v_lshrrev_b32 v3, 4, v1
    v_mul_u32_u24 v3, 10240, v3
    v_bfe_u32 v4, v1, 2, 2
    v_lshl_add_u32 v3, v4, 8, v3
    v_bfe_u32 v4, v1, 2, 3
    v_lshl_add_u32 v3, v4, 5, v3
    v_and_b32 v4, 3, v1
    v_lshl_add_u32 v3, v4, 3, v3
    s_mul_i32 s49, s3, 10
    s_add_u32 s50, s49, 0
    s_and_b32 s51, s50, 7
    s_lshl_b32 s51, s51, 5
    s_lshr_b32 s50, s50, 3
    s_lshl_b32 s50, s50, 10
    v_xor_b32 v64, s51, v3
    v_add_u32 v64, s50, v64
    s_add_u32 s50, s49, 1
    s_and_b32 s51, s50, 7
    s_lshl_b32 s51, s51, 5
    s_lshr_b32 s50, s50, 3
    s_lshl_b32 s50, s50, 10
    v_xor_b32 v65, s51, v3
    v_add_u32 v65, s50, v65
    s_add_u32 s50, s49, 2
    s_and_b32 s51, s50, 7
    s_lshl_b32 s51, s51, 5
    s_lshr_b32 s50, s50, 3
    s_lshl_b32 s50, s50, 10
    v_xor_b32 v66, s51, v3
    v_add_u32 v66, s50, v66
    s_add_u32 s50, s49, 3
    s_and_b32 s51, s50, 7
    s_lshl_b32 s51, s51, 5
    s_lshr_b32 s50, s50, 3
    s_lshl_b32 s50, s50, 10
    v_xor_b32 v67, s51, v3
    v_add_u32 v67, s50, v67
    s_add_u32 s50, s49, 4
    s_and_b32 s51, s50, 7
    s_lshl_b32 s51, s51, 5
    s_lshr_b32 s50, s50, 3
    s_lshl_b32 s50, s50, 10
    v_xor_b32 v68, s51, v3
    v_add_u32 v68, s50, v68
    s_add_u32 s50, s49, 5
    s_and_b32 s51, s50, 7
    s_lshl_b32 s51, s51, 5
    s_lshr_b32 s50, s50, 3
    s_lshl_b32 s50, s50, 10
    v_xor_b32 v69, s51, v3
    v_add_u32 v69, s50, v69
    s_add_u32 s50, s49, 6
    s_and_b32 s51, s50, 7
    s_lshl_b32 s51, s51, 5
    s_lshr_b32 s50, s50, 3
    s_lshl_b32 s50, s50, 10
    v_xor_b32 v70, s51, v3
    v_add_u32 v70, s50, v70
    s_add_u32 s50, s49, 7
    s_and_b32 s51, s50, 7
    s_lshl_b32 s51, s51, 5
    s_lshr_b32 s50, s50, 3
    s_lshl_b32 s50, s50, 10
    v_xor_b32 v71, s51, v3
    v_add_u32 v71, s50, v71
    s_add_u32 s50, s49, 8
    s_and_b32 s51, s50, 7
    s_lshl_b32 s51, s51, 5
    s_lshr_b32 s50, s50, 3
    s_lshl_b32 s50, s50, 10
    v_xor_b32 v72, s51, v3
    v_add_u32 v72, s50, v72
    s_add_u32 s50, s49, 9
    s_and_b32 s51, s50, 7
    s_lshl_b32 s51, s51, 5
    s_lshr_b32 s50, s50, 3
    s_lshl_b32 s50, s50, 10
    v_xor_b32 v73, s51, v3
    v_add_u32 v73, s50, v73
    s_mul_i32 s50, s3, 552960
    s_mul_i32 s51, s79, 5120
    s_add_u32 s50, s50, s51
    s_add_u32 s50, s50, 20971520
    s_waitcnt vmcnt(10)
    s_barrier
    ds_read_b64_tr_b16 v[12:13], v64
    ds_read_b64_tr_b16 v[14:15], v64 offset:5120
    ds_read_b64_tr_b16 v[16:17], v65
    ds_read_b64_tr_b16 v[18:19], v65 offset:5120
    ds_read_b64_tr_b16 v[20:21], v66
    ds_read_b64_tr_b16 v[22:23], v66 offset:5120
    ds_read_b64_tr_b16 v[24:25], v67
    ds_read_b64_tr_b16 v[26:27], v67 offset:5120
    ds_read_b64_tr_b16 v[28:29], v68
    ds_read_b64_tr_b16 v[30:31], v68 offset:5120
    ds_read_b64_tr_b16 v[32:33], v69
    ds_read_b64_tr_b16 v[34:35], v69 offset:5120
    ds_read_b64_tr_b16 v[36:37], v70
    ds_read_b64_tr_b16 v[38:39], v70 offset:5120
    ds_read_b64_tr_b16 v[40:41], v71
    ds_read_b64_tr_b16 v[42:43], v71 offset:5120
    ds_read_b64_tr_b16 v[44:45], v72
    ds_read_b64_tr_b16 v[46:47], v72 offset:5120
    ds_read_b64_tr_b16 v[48:49], v73
    ds_read_b64_tr_b16 v[50:51], v73 offset:5120
    s_waitcnt lgkmcnt(14)
    buffer_store_dwordx4 v[12:15], v10, s[44:47], s50 offen offset:0 sc1
    s_waitcnt lgkmcnt(14)
    buffer_store_dwordx4 v[16:19], v10, s[44:47], s50 offen offset:1024 sc1
    s_waitcnt lgkmcnt(14)
    buffer_store_dwordx4 v[20:23], v10, s[44:47], s50 offen offset:2048 sc1
    s_waitcnt lgkmcnt(12)
    buffer_store_dwordx4 v[24:27], v10, s[44:47], s50 offen offset:3072 sc1
    s_add_u32 s50, s50, 4096
    s_waitcnt lgkmcnt(10)
    buffer_store_dwordx4 v[28:31], v10, s[44:47], s50 offen offset:0 sc1
    s_add_u32 s50, s50, 272384
    s_waitcnt lgkmcnt(8)
    buffer_store_dwordx4 v[32:35], v10, s[44:47], s50 offen offset:0 sc1
    s_waitcnt lgkmcnt(6)
    buffer_store_dwordx4 v[36:39], v10, s[44:47], s50 offen offset:1024 sc1
    s_waitcnt lgkmcnt(4)
    buffer_store_dwordx4 v[40:43], v10, s[44:47], s50 offen offset:2048 sc1
    s_waitcnt lgkmcnt(2)
    buffer_store_dwordx4 v[44:47], v10, s[44:47], s50 offen offset:3072 sc1
    s_add_u32 s50, s50, 4096
    s_waitcnt lgkmcnt(0)
    buffer_store_dwordx4 v[48:51], v10, s[44:47], s50 offen offset:0 sc1
    s_lshl_b32 s53, s77, 12
    s_lshr_b32 s48, s3, 1
    s_lshl_b32 s48, s48, 11
    s_add_u32 s53, s53, s48
    s_add_u32 s53, s53, 42991616
    s_lshl_b32 s48, s97, 7
    s_add_u32 s53, s53, s48
    v_min_u32 v7, 1, v1
    v_lshlrev_b32 v7, 10, v7
    s_mul_i32 s51, s77, 110592
    s_lshl_b32 s48, s78, 11
    s_add_u32 s51, s51, s48
    s_lshl_b32 s48, s3, 9
    s_add_u32 s51, s51, s48
    s_add_u32 s51, s51, 12582912
    s_mul_i32 s50, s77, 40960
    s_add_u32 s50, s50, s71
    s_lshr_b32 s48, s3, 1
    s_mul_i32 s48, s48, 0
    s_add_u32 s50, s50, s48
    s_add_u32 s50, s50, 4194304
    s_mov_b32 s52, 0xbfb8aa3b
    s_lshl_b32 s54, s77, 5
    s_add_u32 s54, s54, s78
    s_lshl_b32 s54, s54, 8
    s_add_u32 s54, s54, 42205184
    v_bfe_u32 v6, v1, 4, 1
    v_mul_u32_u24 v5, 55296, v6
    v_lshrrev_b32 v6, 5, v1
    v_lshl_add_u32 v5, v6, 8, v5
    v_and_b32 v6, 15, v1
    v_lshl_add_u32 v5, v6, 4, v5
    v_lshrrev_b32 v6, 6, v0
    v_min_u32 v6, 1, v6
    v_lshrrev_b32 v9, 2, v10
    v_lshl_or_b32 v9, v6, 31, v9
    v_add_u32 v2, 122880, v10
    v_add_u32 v3, 40960, v10
    v_add_u32 v4, 81920, v10
    s_lshr_b32 s48, s3, 1
    s_lshl_b32 s48, s48, 31
    v_or_b32 v6, s48, v10
    s_lshl_b32 s57, s79, 8
    s_add_u32 s57, s57, 41947136
    s_bitcmp1_b32 s77, 2
    s_cbranch_scc1 L_fpc
    s_add_u32 m0, s71, 40960
    s_add_u32 s31, s70, 1658880
    buffer_load_dwordx4 v248, s[40:43], s31 offen offset:0 lds
    s_add_u32 s31, s70, 1685504
    buffer_load_dwordx4 v249, s[40:43], s31 offen offset:1024 lds
    s_add_u32 s31, s70, 1712128
    buffer_load_dwordx4 v248, s[40:43], s31 offen offset:2048 lds
    s_add_u32 s31, s70, 1738752
    buffer_load_dwordx4 v249, s[40:43], s31 offen offset:3072 lds
    s_add_u32 m0, s71, 45056
    s_add_u32 s31, s70, 1769472
    buffer_load_dwordx4 v248, s[40:43], s31 offen offset:0 lds
    s_add_u32 s31, s70, 1796096
    buffer_load_dwordx4 v249, s[40:43], s31 offen offset:1024 lds
    s_add_u32 s31, s70, 1822720
    buffer_load_dwordx4 v248, s[40:43], s31 offen offset:2048 lds
    s_add_u32 s31, s70, 1849344
    buffer_load_dwordx4 v249, s[40:43], s31 offen offset:3072 lds
    s_add_u32 m0, s71, 49152
    s_add_u32 s31, s70, 1880064
    buffer_load_dwordx4 v248, s[40:43], s31 offen offset:0 lds
    s_add_u32 s31, s70, 1906688
    buffer_load_dwordx4 v249, s[40:43], s31 offen offset:1024 lds
L_fqc:
    s_waitcnt vmcnt(10)
    s_barrier
    buffer_store_dword v11, v9, s[44:47], s57 offen sc1
    s_bitcmp1_b32 s77, 2
    s_cbranch_scc1 L_fpd
    v_add_u32 v60, 81920, v250
    ds_read_b64_tr_b16 a[40:41], v60 offset:0
    ds_read_b64_tr_b16 a[42:43], v60 offset:512
    ds_read_b64_tr_b16 a[44:45], v60 offset:20480
    ds_read_b64_tr_b16 a[46:47], v60 offset:20992
    ds_read_b64_tr_b16 a[48:49], v60 offset:4096
    ds_read_b64_tr_b16 a[50:51], v60 offset:4608
    ds_read_b64_tr_b16 a[52:53], v60 offset:24576
    ds_read_b64_tr_b16 a[54:55], v60 offset:25088
    ds_read_b64_tr_b16 a[56:57], v60 offset:8192
    ds_read_b64_tr_b16 a[58:59], v60 offset:8704
    ds_read_b64_tr_b16 a[60:61], v60 offset:28672
    ds_read_b64_tr_b16 a[62:63], v60 offset:29184
    ds_read_b64_tr_b16 a[64:65], v60 offset:12288
    ds_read_b64_tr_b16 a[66:67], v60 offset:12800
    ds_read_b64_tr_b16 a[68:69], v60 offset:32768
    ds_read_b64_tr_b16 a[70:71], v60 offset:33280
    ds_read_b64_tr_b16 a[72:73], v60 offset:16384
    ds_read_b64_tr_b16 a[74:75], v60 offset:16896
    ds_read_b64_tr_b16 a[76:77], v60 offset:36864
    ds_read_b64_tr_b16 a[78:79], v60 offset:37376
L_fqd:
    s_waitcnt vmcnt(1)
    s_barrier
    s_bitcmp1_b32 s77, 2
    s_cbranch_scc1 L_fpe
    v_add_u32 v60, 40960, v250
    ds_read_b64_tr_b16 a[120:121], v60 offset:0
    ds_read_b64_tr_b16 a[122:123], v60 offset:512
    ds_read_b64_tr_b16 a[124:125], v60 offset:20480
    ds_read_b64_tr_b16 a[126:127], v60 offset:20992
    ds_read_b64_tr_b16 a[128:129], v60 offset:4096
    ds_read_b64_tr_b16 a[130:131], v60 offset:4608
    ds_read_b64_tr_b16 a[132:133], v60 offset:24576
    ds_read_b64_tr_b16 a[134:135], v60 offset:25088
    ds_read_b64_tr_b16 a[136:137], v60 offset:8192
    ds_read_b64_tr_b16 a[138:139], v60 offset:8704
    ds_read_b64_tr_b16 a[140:141], v60 offset:28672
    ds_read_b64_tr_b16 a[142:143], v60 offset:29184
    ds_read_b64_tr_b16 a[144:145], v60 offset:12288
    ds_read_b64_tr_b16 a[146:147], v60 offset:12800
    ds_read_b64_tr_b16 a[148:149], v60 offset:32768
    ds_read_b64_tr_b16 a[150:151], v60 offset:33280
    ds_read_b64_tr_b16 a[152:153], v60 offset:16384
    ds_read_b64_tr_b16 a[154:155], v60 offset:16896
    ds_read_b64_tr_b16 a[156:157], v60 offset:36864
    ds_read_b64_tr_b16 a[158:159], v60 offset:37376
L_fqe:
    s_buffer_load_dword s6, s[44:47], s53 offset:0
    s_buffer_load_dword s7, s[44:47], s53 offset:1024
    s_waitcnt lgkmcnt(0)
    s_cmp_lg_u64 s[6:7], s[4:5]
    s_cbranch_scc1 L_g1l0fr
L_g1l0fb:
    s_add_u32 m0, s71, 122880
    s_add_u32 s55, s50, 0
    buffer_load_dwordx4 v10, s[44:47], s55 offen offset:0 sc1 lds
    buffer_load_dwordx4 v10, s[44:47], s55 offen offset:1024 sc1 lds
    buffer_load_dwordx4 v10, s[44:47], s55 offen offset:2048 sc1 lds
    buffer_load_dwordx4 v10, s[44:47], s55 offen offset:3072 sc1 lds
    s_add_u32 m0, s71, 126976
    s_add_u32 s55, s50, 4096
    buffer_load_dwordx4 v10, s[44:47], s55 offen offset:0 sc1 lds
    buffer_load_dwordx4 v10, s[44:47], s55 offen offset:1024 sc1 lds
    buffer_load_dwordx4 v10, s[44:47], s55 offen offset:2048 sc1 lds
    buffer_load_dwordx4 v10, s[44:47], s55 offen offset:3072 sc1 lds
    s_add_u32 m0, s71, 131072
    s_add_u32 s55, s50, 8192
    buffer_load_dwordx4 v10, s[44:47], s55 offen offset:0 sc1 lds
    buffer_load_dwordx4 v10, s[44:47], s55 offen offset:1024 sc1 lds
    s_waitcnt vmcnt(4)
L_fw2b:
    s_buffer_load_dword s8, s[44:47], s53 offset:32768
    s_buffer_load_dword s9, s[44:47], s53 offset:33792
    s_waitcnt vmcnt(0) lgkmcnt(0)
    s_barrier
    s_branch L_g1
L_nf:
    s_sub_u32 s79, s2, 216
    s_mov_b32 s52, s4
    s_and_b32 s53, s5, 0xffff
    s_mov_b32 s54, 2621440
    s_mov_b32 s55, 0x20000
    v_lshrrev_b32 v16, 4, v1
    v_and_b32 v17, 15, v1
    v_lshlrev_b32 v18, 1, v16
    v_xor_b32 v17, v17, v18
    v_mul_u32_u24 v16, 1280, v16
    v_xor_b32 v18, 8, v17
    v_lshl_add_u32 v17, v17, 4, v16
    v_lshl_add_u32 v18, v18, 4, v16
    s_mul_i32 s60, s79, 10240
    s_mul_i32 s61, s3, 409600
    s_add_u32 s60, s60, s61
    s_mul_i32 s61, s3, 8704
    s_lshl_b32 s62, s3, 11
    s_add_u32 m0, s61, 0
    s_add_u32 s30, s60, 0
    buffer_load_dwordx4 v10, s[52:55], s30 offen nt lds
    s_add_u32 m0, s61, 1088
    s_add_u32 s30, s60, 1280
    buffer_load_dwordx4 v10, s[52:55], s30 offen nt lds
    s_add_u32 m0, s61, 2176
    s_add_u32 s30, s60, 2560
    buffer_load_dwordx4 v10, s[52:55], s30 offen nt lds
    s_add_u32 m0, s61, 3264
    s_add_u32 s30, s60, 3840
    buffer_load_dwordx4 v10, s[52:55], s30 offen nt lds
    s_add_u32 m0, s61, 4352
    s_add_u32 s30, s60, 5120
    buffer_load_dwordx4 v10, s[52:55], s30 offen nt lds
    s_add_u32 m0, s61, 5440
    s_add_u32 s30, s60, 6400
    buffer_load_dwordx4 v10, s[52:55], s30 offen nt lds
    s_add_u32 m0, s61, 6528
    s_add_u32 s30, s60, 7680
    buffer_load_dwordx4 v10, s[52:55], s30 offen nt lds
    s_add_u32 m0, s61, 7616
    s_add_u32 s30, s60, 8960
    buffer_load_dwordx4 v10, s[52:55], s30 offen nt lds
    s_add_u32 m0, s62, 69632
    s_add_u32 s30, s60, 1024
    buffer_load_dwordx4 v17, s[52:55], s30 offen nt lds
    s_add_u32 m0, s62, 70656
    s_add_u32 s30, s60, 6144
    buffer_load_dwordx4 v18, s[52:55], s30 offen nt lds
    s_mov_b32 s44, s28
    s_and_b32 s45, s29, 0xffff
    s_mov_b32 s46, 268435456
    s_mov_b32 s47, 0x20000
    s_mov_b32 s26, 0xffff0000
    s_lshr_b32 s31, s97, 1
    s_add_u32 s31, s31, 2
    s_and_b32 s31, s31, 3
    s_add_u32 s30, s96, 3
    s_sub_u32 s30, s30, s31
    s_mul_i32 s30, s30, 21846
    s_lshr_b32 s30, s30, 16
    s_add_u32 s30, s30, s96
    s_lshl2_add_u32 s31, s96, s31
    s_sub_u32 s31, s31, 80
    s_min_u32 s31, s31, 26
    s_cmp_lt_u32 s96, 20
    s_cselect_b32 s31, s30, s31
    s_lshr_b32 s30, s97, 1
    s_mul_i32 s30, s30, 27
    s_add_u32 s30, s30, s31
    s_lshr_b32 s78, s30, 2
    s_and_b32 s77, s30, 3
    s_and_b32 s30, s97, 1
    s_lshl_b32 s30, s30, 2
    s_add_u32 s77, s77, s30
    v_lshrrev_b32 v30, 3, v1
    v_mul_u32_u24 v248, 3456, v30
    v_and_b32 v30, 2, v30
    v_and_b32 v31, 7, v1
    v_xor_b32 v30, v30, v31
    v_xor_b32 v31, 4, v30
    v_lshl_add_u32 v249, v31, 4, v248
    v_lshl_add_u32 v248, v30, 4, v248
    s_and_b32 s30, s3, 1
    s_mul_i32 s70, s30, 276480
    s_lshl_b32 s30, s78, 7
    s_add_u32 s70, s70, s30
    s_mul_i32 s71, s3, 10240
    s_cmp_ge_u32 s3, 2
    s_cselect_b32 s40, s20, s18
    s_cselect_b32 s41, s21, s19
    s_and_b32 s41, s41, 0xffff
    s_mov_b32 s42, 2211840
    s_mov_b32 s43, 0x20000
    v_lshrrev_b32 v30, 4, v1
    v_bfe_u32 v31, v1, 2, 2
    v_lshl_add_u32 v250, v30, 3, v31
    v_lshlrev_b32 v250, 7, v250
    v_bfe_u32 v30, v1, 3, 2
    v_xor_b32 v30, s3, v30
    v_lshl_add_u32 v250, v30, 5, v250
    v_and_b32 v30, 3, v1
    v_lshl_add_u32 v250, v30, 3, v250
    s_lshr_b32 s76, s97, 1
    s_lshl_b32 s76, s76, 3
    s_lshr_b32 s30, s96, 2
    s_add_u32 s76, s76, s30
    s_and_b32 s75, s97, 1
    s_lshl_b32 s75, s75, 2
    s_and_b32 s30, s96, 3
    s_add_u32 s75, s75, s30
    s_mul_i32 s74, s3, 14
    s_cmp_eq_u32 s3, 3
    s_cselect_b32 s74, 41, s74
    s_mul_i32 s72, s75, 276480
    s_mul_i32 s30, s74, 5120
    s_add_u32 s72, s72, s30
    s_add_u32 s72, s72, 20971520
    s_mul_i32 s73, s76, 55296
    s_lshl_b32 s30, s74, 10
    s_add_u32 s73, s73, s30
    s_add_u32 s73, s73, 12582912
    s_waitcnt lgkmcnt(0)
    s_mul_i32 s100, s100, 0x41c64e6d
    s_add_u32 s100, s100, 12345
    s_and_b32 s99, s100, 0x1fff
    s_or_b32 s99, s99, 0x4000
    s_lshl_b32 s98, s99, 16
    v_mov_b32 v11, s100
    s_mov_b32 s4, s100
    s_mov_b32 s5, s100
    v_and_b32 v14, 7, v0
    v_lshrrev_b32 v15, 3, v0
    v_lshlrev_b32 v3, 4, v14
    v_lshl_add_u32 v2, v15, 8, v3
    v_lshl_add_u32 v3, v15, 7, v3
    v_and_b32 v16, 8, v1
    v_cmp_eq_u32 vcc, 0, v16
    v_bfrev_b32 v7, 1
    s_nop 0
    v_cndmask_b32 v4, v7, v3, vcc
    v_cmp_gt_u32 vcc, 8, v1
    v_mul_u32_u24 v9, 1088, v14
    v_lshl_add_u32 v9, v15, 4, v9
    v_cndmask_b32 v8, v7, v10, vcc
    v_mov_b32 v136, v11
    v_mov_b32 v137, v11
    v_mov_b32 v138, v11
    v_mov_b32 v139, v11
    v_lshrrev_b32 v16, 1, v15
    v_lshlrev_b32 v19, 1, v14
    v_xor_b32 v16, v16, v19
    v_lshlrev_b32 v16, 4, v16
    v_lshl_add_u32 v12, v14, 8, v16
    v_and_b32 v16, 1, v15
    v_lshl_add_u32 v12, v16, 3, v12
    v_add_u32 v12, 69632, v12
    v_mul_u32_u24 v6, 80, v14
    v_add_u32 v6, 86016, v6
    v_bfe_u32 v5, v1, 4, 1
    v_lshl_add_u32 v5, v5, 5, v6
    v_lshrrev_b32 v16, 5, v1
    v_lshl_add_u32 v5, v16, 2, v5
    s_lshl_b32 s30, s3, 3
    v_add_u32 v5, s30, v5
    s_mul_i32 s56, s79, 20480
    s_add_u32 s56, s56, 33554432
    s_lshr_b32 s57, s79, 1
    s_mul_i32 s57, s57, 20480
    s_and_b32 s30, s79, 1
    s_lshl_b32 s30, s30, 7
    s_add_u32 s57, s57, s30
    s_add_u32 s57, s57, 4194304
    s_lshl_b32 s58, s79, 10
    s_add_u32 s58, s58, 42950656
    s_add_u32 m0, s61, 34816
    s_add_u32 s30, s60, 1638400
    buffer_load_dwordx4 v10, s[52:55], s30 offen nt lds
    s_add_u32 m0, s61, 35904
    s_add_u32 s30, s60, 1639680
    buffer_load_dwordx4 v10, s[52:55], s30 offen nt lds
    s_add_u32 m0, s61, 36992
    s_add_u32 s30, s60, 1640960
    buffer_load_dwordx4 v10, s[52:55], s30 offen nt lds
    s_add_u32 m0, s61, 38080
    s_add_u32 s30, s60, 1642240
    buffer_load_dwordx4 v10, s[52:55], s30 offen nt lds
    s_add_u32 m0, s61, 39168
    s_add_u32 s30, s60, 1643520
    buffer_load_dwordx4 v10, s[52:55], s30 offen nt lds
    s_add_u32 m0, s61, 40256
    s_add_u32 s30, s60, 1644800
    buffer_load_dwordx4 v10, s[52:55], s30 offen nt lds
    s_add_u32 m0, s61, 41344
    s_add_u32 s30, s60, 1646080
    buffer_load_dwordx4 v10, s[52:55], s30 offen nt lds
    s_add_u32 m0, s61, 42432
    s_add_u32 s30, s60, 1647360
    buffer_load_dwordx4 v10, s[52:55], s30 offen nt lds
    s_add_u32 m0, s62, 77824
    s_add_u32 s30, s60, 1639424
    buffer_load_dwordx4 v17, s[52:55], s30 offen nt lds
    s_add_u32 m0, s62, 78848
    s_add_u32 s30, s60, 1644544
    buffer_load_dwordx4 v18, s[52:55], s30 offen nt lds
    s_waitcnt vmcnt(10)
    s_barrier
    v_lshlrev_b32 v120, 7, v0
    v_min_u32 v120, 20352, v120
    buffer_load_dword v121, v120, s[44:47], s56 offen sc1
    s_cmp_lt_u32 s79, 8
    s_cselect_b32 s68, 4, 3
    s_add_u32 s30, s68, 1
    s_mul_i32 s69, s30, 819200
    s_add_u32 s69, s69, s56
    v_min_u32 v160, 3, v1
    s_lshl_b32 s30, s3, 2
    v_add_u32 v160, s30, v160
    v_mul_u32_u24 v160, 1280, v160
    s_lshr_b32 s30, s79, 2
    s_lshl_b32 s30, s30, 7
    v_add_u32 v160, s30, v160
    buffer_load_dword v161, v160, s[44:47], s69 offen sc1
    ds_read_b128 v[20:23], v9
    ds_read_b128 v[24:27], v9 offset:512
    ds_read_b64 v[28:29], v12
    s_mov_b32 s59, 3
    s_waitcnt lgkmcnt(0)
L_rp0:
    v_add_u32 v9, 8704, v9
    v_add_u32 v12, 2048, v12
    s_waitcnt lgkmcnt(1)
    v_lshlrev_b32 v32, 16, v20
    v_and_b32 v33, s26, v20
    v_lshlrev_b32 v34, 16, v21
    v_and_b32 v35, s26, v21
    v_lshlrev_b32 v36, 16, v22
    v_and_b32 v37, s26, v22
    v_lshlrev_b32 v38, 16, v23
    v_and_b32 v39, s26, v23
    v_lshlrev_b32 v40, 16, v24
    v_and_b32 v41, s26, v24
    v_lshlrev_b32 v42, 16, v25
    v_and_b32 v43, s26, v25
    v_lshlrev_b32 v44, 16, v26
    v_and_b32 v45, s26, v26
    v_lshlrev_b32 v46, 16, v27
    v_and_b32 v47, s26, v27
    v_lshlrev_b32 v48, 16, v28
    v_and_b32 v49, s26, v28
    v_lshlrev_b32 v50, 16, v29
    v_and_b32 v51, s26, v29
    ds_read_b128 v[20:23], v9
    ds_read_b128 v[24:27], v9 offset:512
    ds_read_b64 v[28:29], v12
.p2align 3
    v_pk_add_f32 v[92:93], v[32:33], v[34:35]
    v_pk_mul_f32 v[94:95], v[32:33], v[32:33]
    v_pk_fma_f32 v[94:95], v[34:35], v[34:35], v[94:95]
    v_pk_add_f32 v[92:93], v[92:93], v[36:37]
    v_pk_fma_f32 v[94:95], v[36:37], v[36:37], v[94:95]
    v_pk_add_f32 v[92:93], v[92:93], v[38:39]
    v_pk_fma_f32 v[94:95], v[38:39], v[38:39], v[94:95]
    v_pk_add_f32 v[92:93], v[92:93], v[40:41]
    v_pk_fma_f32 v[94:95], v[40:41], v[40:41], v[94:95]
    v_pk_add_f32 v[92:93], v[92:93], v[42:43]
    v_pk_fma_f32 v[94:95], v[42:43], v[42:43], v[94:95]
    v_pk_add_f32 v[92:93], v[92:93], v[44:45]
    v_pk_fma_f32 v[94:95], v[44:45], v[44:45], v[94:95]
    v_pk_add_f32 v[92:93], v[92:93], v[46:47]
    v_pk_fma_f32 v[94:95], v[46:47], v[46:47], v[94:95]
    v_pk_add_f32 v[92:93], v[92:93], v[48:49]
    v_pk_fma_f32 v[94:95], v[48:49], v[48:49], v[94:95]
    v_pk_add_f32 v[92:93], v[92:93], v[50:51]
    v_pk_fma_f32 v[94:95], v[50:51], v[50:51], v[94:95]
    v_add_f32 v92, v92, v93
    v_add_f32 v93, v94, v95
    s_nop 1
    v_permlane16_swap_b32 v92, v93
    v_add_f32 v92, v92, v93
    s_nop 1
    v_add_f32_dpp v92, v92, v92 row_ror:8 row_mask:0xf bank_mask:0xf
    ds_write_b32 v5, v92
    v_add_u32 v5, 640, v5
    s_sub_u32 s59, s59, 1
    s_cbranch_scc0 L_rp0
    s_waitcnt lgkmcnt(0)
    s_waitcnt vmcnt(2)
    s_barrier
    s_cmp_lg_u32 s3, 0
    s_cbranch_scc1 L_rpw
    v_not_b32 v112, v11
    v_not_b32 v113, v11
    v_not_b32 v114, v11
    v_not_b32 v115, v11
    s_add_u32 s30, s58, 40960
    buffer_store_dwordx4 v[112:115], v10, s[44:47], s30 offen sc1
    s_add_u32 s30, s58, 81920
    buffer_store_dwordx4 v[112:115], v10, s[44:47], s30 offen sc1
    s_add_u32 s30, s58, 122880
    buffer_store_dwordx4 v[112:115], v10, s[44:47], s30 offen sc1
    s_add_u32 s30, s58, 163840
    buffer_store_dwordx4 v[112:115], v10, s[44:47], s30 offen sc1
    s_add_u32 s30, s58, 204800
    buffer_store_dwordx4 v[112:115], v10, s[44:47], s30 offen sc1
    s_add_u32 s30, s58, 245760
    buffer_store_dwordx4 v[112:115], v10, s[44:47], s30 offen sc1
    s_add_u32 s30, s58, 286720
    buffer_store_dwordx4 v[112:115], v10, s[44:47], s30 offen sc1
L_rpw:
    ds_read_b128 v[20:23], v9
    ds_read_b128 v[24:27], v9 offset:512
    ds_read_b64 v[28:29], v12
    s_mov_b32 s59, 2
    s_waitcnt lgkmcnt(0)
L_rp1:
    v_add_u32 v9, 8704, v9
    v_add_u32 v12, 2048, v12
    s_waitcnt lgkmcnt(1)
    v_lshlrev_b32 v32, 16, v20
    v_and_b32 v33, s26, v20
    v_lshlrev_b32 v34, 16, v21
    v_and_b32 v35, s26, v21
    v_lshlrev_b32 v36, 16, v22
    v_and_b32 v37, s26, v22
    v_lshlrev_b32 v38, 16, v23
    v_and_b32 v39, s26, v23
    v_lshlrev_b32 v40, 16, v24
    v_and_b32 v41, s26, v24
    v_lshlrev_b32 v42, 16, v25
    v_and_b32 v43, s26, v25
    v_lshlrev_b32 v44, 16, v26
    v_and_b32 v45, s26, v26
    v_lshlrev_b32 v46, 16, v27
    v_and_b32 v47, s26, v27
    v_lshlrev_b32 v48, 16, v28
    v_and_b32 v49, s26, v28
    v_lshlrev_b32 v50, 16, v29
    v_and_b32 v51, s26, v29
    ds_read_b128 v[20:23], v9
    ds_read_b128 v[24:27], v9 offset:512
    ds_read_b64 v[28:29], v12
.p2align 3
    v_pk_add_f32 v[92:93], v[32:33], v[34:35]
    v_pk_mul_f32 v[94:95], v[32:33], v[32:33]
    v_pk_fma_f32 v[94:95], v[34:35], v[34:35], v[94:95]
    v_pk_add_f32 v[92:93], v[92:93], v[36:37]
    v_pk_fma_f32 v[94:95], v[36:37], v[36:37], v[94:95]
    v_pk_add_f32 v[92:93], v[92:93], v[38:39]
    v_pk_fma_f32 v[94:95], v[38:39], v[38:39], v[94:95]
    v_pk_add_f32 v[92:93], v[92:93], v[40:41]
    v_pk_fma_f32 v[94:95], v[40:41], v[40:41], v[94:95]
    v_pk_add_f32 v[92:93], v[92:93], v[42:43]
    v_pk_fma_f32 v[94:95], v[42:43], v[42:43], v[94:95]
    v_pk_add_f32 v[92:93], v[92:93], v[44:45]
    v_pk_fma_f32 v[94:95], v[44:45], v[44:45], v[94:95]
    v_pk_add_f32 v[92:93], v[92:93], v[46:47]
    v_pk_fma_f32 v[94:95], v[46:47], v[46:47], v[94:95]
    v_pk_add_f32 v[92:93], v[92:93], v[48:49]
    v_pk_fma_f32 v[94:95], v[48:49], v[48:49], v[94:95]
    v_pk_add_f32 v[92:93], v[92:93], v[50:51]
    v_pk_fma_f32 v[94:95], v[50:51], v[50:51], v[94:95]
    v_add_f32 v92, v92, v93
    v_add_f32 v93, v94, v95
    s_nop 1
    v_permlane16_swap_b32 v92, v93
    v_add_f32 v92, v92, v93
    s_nop 1
    v_add_f32_dpp v92, v92, v92 row_ror:8 row_mask:0xf bank_mask:0xf
    ds_write_b32 v5, v92
    v_add_u32 v5, 640, v5
    s_sub_u32 s59, s59, 1
    s_cbranch_scc0 L_rp1
    s_waitcnt lgkmcnt(0)
    s_barrier
    v_lshrrev_b32 v16, 3, v1
    v_mul_u32_u24 v16, 640, v16
    v_add_u32 v16, v16, v6
    ds_read_b128 v[96:99], v16 offset:0
    ds_read_b128 v[100:103], v16 offset:16
    ds_read_b128 v[104:107], v16 offset:32
    ds_read_b128 v[108:111], v16 offset:48
    v_subrev_u32 v9, 60928, v9
    v_subrev_u32 v12, 14336, v12
    ds_read_b128 v[20:23], v9
    ds_read_b128 v[24:27], v9 offset:512
    ds_read_b64 v[28:29], v12
    v_add_u32 v5, 1664, v5
    v_add_u32 v6, 6144, v6
    v_lshlrev_b32 v16, 3, v1
    v_add_u32 v16, 91136, v16
    v_lshlrev_b32 v13, 3, v14
    v_add_u32 v13, 91136, v13
    s_waitcnt lgkmcnt(3)
    v_pk_add_f32 v[96:97], v[96:97], v[98:99]
    v_pk_add_f32 v[100:101], v[100:101], v[102:103]
    v_pk_add_f32 v[104:105], v[104:105], v[106:107]
    v_pk_add_f32 v[108:109], v[108:109], v[110:111]
    v_pk_add_f32 v[96:97], v[96:97], v[100:101]
    v_pk_add_f32 v[104:105], v[104:105], v[108:109]
    v_add_f32 v92, v96, v97
    v_add_f32 v93, v104, v105
    v_mul_f32 v92, 0x3acccccd, v92
    v_mul_f32 v93, 0x3acccccd, v93
    v_fma_f32 v93, -v92, v92, v93
    v_max_f32 v93, 0, v93
    v_cvt_pk_bf16_f32 v93, 0, v93
    v_add_f32 v93, 0x3727c5ac, v93
    v_cvt_pk_bf16_f32 v93, 0, v93
    v_sqrt_f32 v93, v93
    v_cvt_pk_bf16_f32 v92, 0, v92
    v_cvt_pk_bf16_f32 v93, 0, v93
    v_rcp_f32 v93, v93
    s_nop 0
    v_mul_f32 v92, v92, v93
    ds_write_b64 v16, v[92:93]
    ds_read_b64 v[30:31], v13
    s_cmp_lt_u32 s79, 16
    s_cselect_b32 s59, 6, 5
    s_mov_b32 s65, 0
    s_sub_u32 s67, s59, s68
    s_sub_u32 s59, s68, 1
    s_add_u32 s30, s56, 8192
    s_add_u32 s31, s56, 16384
    buffer_load_dwordx4 v[72:75], v2, s[44:47], s56 offen offset:0 sc1
    buffer_load_dwordx4 v[76:79], v2, s[44:47], s56 offen offset:128 sc1
    buffer_load_dwordx4 v[80:83], v2, s[44:47], s30 offen offset:0 sc1
    buffer_load_dwordx4 v[84:87], v2, s[44:47], s30 offen offset:128 sc1
    buffer_load_dwordx4 v[88:91], v3, s[44:47], s31 offen offset:0 sc1
    s_waitcnt lgkmcnt(0)
    v_lshlrev_b32 v32, 16, v20
    v_and_b32 v33, s26, v20
    v_lshlrev_b32 v34, 16, v21
    v_and_b32 v35, s26, v21
    v_lshlrev_b32 v36, 16, v22
    v_and_b32 v37, s26, v22
    v_lshlrev_b32 v38, 16, v23
    v_and_b32 v39, s26, v23
    v_lshlrev_b32 v40, 16, v24
    v_and_b32 v41, s26, v24
    v_lshlrev_b32 v42, 16, v25
    v_and_b32 v43, s26, v25
    v_lshlrev_b32 v44, 16, v26
    v_and_b32 v45, s26, v26
    v_lshlrev_b32 v46, 16, v27
    v_and_b32 v47, s26, v27
    v_lshlrev_b32 v48, 16, v28
    v_and_b32 v49, s26, v28
    v_lshlrev_b32 v50, 16, v29
    v_and_b32 v51, s26, v29
.p2align 3
    v_pk_fma_f32 v[52:53], v[32:33], v[30:31], v[30:31] op_sel:[0,1,0] op_sel_hi:[1,1,0] neg_lo:[0,0,1] neg_hi:[0,0,1]
    v_pk_fma_f32 v[54:55], v[34:35], v[30:31], v[30:31] op_sel:[0,1,0] op_sel_hi:[1,1,0] neg_lo:[0,0,1] neg_hi:[0,0,1]
    v_pk_fma_f32 v[56:57], v[36:37], v[30:31], v[30:31] op_sel:[0,1,0] op_sel_hi:[1,1,0] neg_lo:[0,0,1] neg_hi:[0,0,1]
    v_pk_fma_f32 v[58:59], v[38:39], v[30:31], v[30:31] op_sel:[0,1,0] op_sel_hi:[1,1,0] neg_lo:[0,0,1] neg_hi:[0,0,1]
    v_pk_fma_f32 v[60:61], v[40:41], v[30:31], v[30:31] op_sel:[0,1,0] op_sel_hi:[1,1,0] neg_lo:[0,0,1] neg_hi:[0,0,1]
    v_pk_fma_f32 v[62:63], v[42:43], v[30:31], v[30:31] op_sel:[0,1,0] op_sel_hi:[1,1,0] neg_lo:[0,0,1] neg_hi:[0,0,1]
    v_pk_fma_f32 v[64:65], v[44:45], v[30:31], v[30:31] op_sel:[0,1,0] op_sel_hi:[1,1,0] neg_lo:[0,0,1] neg_hi:[0,0,1]
    v_pk_fma_f32 v[66:67], v[46:47], v[30:31], v[30:31] op_sel:[0,1,0] op_sel_hi:[1,1,0] neg_lo:[0,0,1] neg_hi:[0,0,1]
    v_pk_fma_f32 v[68:69], v[48:49], v[30:31], v[30:31] op_sel:[0,1,0] op_sel_hi:[1,1,0] neg_lo:[0,0,1] neg_hi:[0,0,1]
    v_pk_fma_f32 v[70:71], v[50:51], v[30:31], v[30:31] op_sel:[0,1,0] op_sel_hi:[1,1,0] neg_lo:[0,0,1] neg_hi:[0,0,1]
    v_add_u32 v9, 8704, v9
    v_add_u32 v12, 2048, v12
    v_add_u32 v13, 64, v13
L_rre:
    s_mov_b32 s66, 1
    s_add_u32 s62, s56, 819200
    s_add_u32 s60, s62, 8192
    s_add_u32 s61, s62, 16384
    s_waitcnt vmcnt(0)
    v_xor_b32 v72, s99, v72
    v_xor_b32 v73, s99, v73
    v_xor_b32 v74, s99, v74
    v_xor_b32 v75, s99, v75
    v_xor_b32 v76, s99, v76
    v_xor_b32 v77, s99, v77
    v_xor_b32 v78, s99, v78
    v_xor_b32 v79, s99, v79
    v_xor_b32 v80, s99, v80
    v_xor_b32 v81, s99, v81
    v_xor_b32 v82, s99, v82
    v_xor_b32 v83, s99, v83
    v_xor_b32 v84, s99, v84
    v_xor_b32 v85, s99, v85
    v_xor_b32 v86, s99, v86
    v_xor_b32 v87, s99, v87
    v_xor_b32 v88, s99, v88
    v_xor_b32 v89, s99, v89
    v_xor_b32 v90, s99, v90
    v_xor_b32 v91, s99, v91
    v_or3_b32 v16, v72, v73, v74
    v_or3_b32 v17, v75, v76, v77
    v_or3_b32 v16, v78, v79, v16
    v_or3_b32 v17, v80, v81, v17
    v_or3_b32 v16, v82, v83, v16
    v_or3_b32 v17, v84, v85, v17
    v_or3_b32 v16, v86, v87, v16
    v_or3_b32 v17, v88, v89, v17
    v_or3_b32 v16, v90, v91, v16
    v_or_b32 v16, v16, v17
    v_cmp_ne_u16 vcc, 0, v16
    s_nop 0
    s_cbranch_vccnz L_ryr
L_ryb:
    buffer_load_dwordx4 v[140:143], v2, s[44:47], s62 offen offset:0 sc1
    buffer_load_dwordx4 v[144:147], v2, s[44:47], s62 offen offset:128 sc1
    buffer_load_dwordx4 v[148:151], v2, s[44:47], s60 offen offset:0 sc1
    buffer_load_dwordx4 v[152:155], v2, s[44:47], s60 offen offset:128 sc1
    s_branch L_ry0b
L_rtop0:
    v_xor_b32 v72, s99, v72
    v_xor_b32 v73, s99, v73
    v_xor_b32 v74, s99, v74
    v_xor_b32 v75, s99, v75
    v_xor_b32 v76, s99, v76
    v_xor_b32 v77, s99, v77
    v_xor_b32 v78, s99, v78
    v_xor_b32 v79, s99, v79
    buffer_load_dwordx4 v[148:151], v2, s[44:47], s60 offen offset:0 sc1
    v_xor_b32 v80, s99, v80
    v_xor_b32 v81, s99, v81
    v_xor_b32 v82, s99, v82
    v_xor_b32 v83, s99, v83
    v_xor_b32 v84, s99, v84
    v_xor_b32 v85, s99, v85
    v_xor_b32 v86, s99, v86
    v_xor_b32 v87, s99, v87
    v_xor_b32 v88, s99, v88
    v_xor_b32 v89, s99, v89
    v_xor_b32 v90, s99, v90
    v_xor_b32 v91, s99, v91
    v_or3_b32 v16, v72, v73, v74
    v_or3_b32 v17, v75, v76, v77
    v_or3_b32 v16, v78, v79, v16
    v_or3_b32 v17, v80, v81, v17
    buffer_load_dwordx4 v[152:155], v2, s[44:47], s60 offen offset:128 sc1
    v_or3_b32 v16, v82, v83, v16
    v_or3_b32 v17, v84, v85, v17
    v_or3_b32 v16, v86, v87, v16
    v_or3_b32 v17, v88, v89, v17
    v_or3_b32 v16, v90, v91, v16
    v_or_b32 v16, v16, v17
    v_cmp_ne_u16 vcc, 0, v16
    s_nop 0
    s_cbranch_vccnz L_ry0r
L_ry0b:
.p2align 3
    v_pk_fma_f32 v[32:33], v[52:53], v[72:73], v[32:33]
    v_pk_fma_f32 v[34:35], v[54:55], v[74:75], v[34:35]
    v_pk_fma_f32 v[36:37], v[56:57], v[76:77], v[36:37]
    v_pk_fma_f32 v[38:39], v[58:59], v[78:79], v[38:39]
    v_pk_fma_f32 v[40:41], v[60:61], v[80:81], v[40:41]
    v_pk_fma_f32 v[42:43], v[62:63], v[82:83], v[42:43]
    v_pk_fma_f32 v[44:45], v[64:65], v[84:85], v[44:45]
    v_pk_fma_f32 v[46:47], v[66:67], v[86:87], v[46:47]
    v_pk_fma_f32 v[48:49], v[68:69], v[88:89], v[48:49]
    v_pk_fma_f32 v[50:51], v[70:71], v[90:91], v[50:51]
    buffer_load_dwordx4 v[156:159], v3, s[44:47], s61 offen offset:0 sc1
.p2align 3
    v_pk_add_f32 v[92:93], v[32:33], v[34:35]
    v_pk_mul_f32 v[94:95], v[32:33], v[32:33]
    v_pk_fma_f32 v[94:95], v[34:35], v[34:35], v[94:95]
    v_pk_add_f32 v[92:93], v[92:93], v[36:37]
    v_pk_fma_f32 v[94:95], v[36:37], v[36:37], v[94:95]
    v_pk_add_f32 v[92:93], v[92:93], v[38:39]
    v_pk_fma_f32 v[94:95], v[38:39], v[38:39], v[94:95]
    v_pk_add_f32 v[92:93], v[92:93], v[40:41]
    v_pk_fma_f32 v[94:95], v[40:41], v[40:41], v[94:95]
    v_pk_add_f32 v[92:93], v[92:93], v[42:43]
    v_pk_fma_f32 v[94:95], v[42:43], v[42:43], v[94:95]
    v_pk_add_f32 v[92:93], v[92:93], v[44:45]
    v_pk_fma_f32 v[94:95], v[44:45], v[44:45], v[94:95]
    v_pk_add_f32 v[92:93], v[92:93], v[46:47]
    v_pk_fma_f32 v[94:95], v[46:47], v[46:47], v[94:95]
    v_pk_add_f32 v[92:93], v[92:93], v[48:49]
    v_pk_fma_f32 v[94:95], v[48:49], v[48:49], v[94:95]
    v_pk_add_f32 v[92:93], v[92:93], v[50:51]
    v_pk_fma_f32 v[94:95], v[50:51], v[50:51], v[94:95]
    v_add_f32 v92, v92, v93
    v_add_f32 v93, v94, v95
    s_nop 1
    v_permlane16_swap_b32 v92, v93
    v_add_f32 v92, v92, v93
    s_nop 1
    v_add_f32_dpp v92, v92, v92 row_ror:8 row_mask:0xf bank_mask:0xf
    ds_write_b32 v5, v92
    s_add_u32 s63, s57, 8192
    s_add_u32 s64, s57, 16384
    v_xor_b32 v5, 1024, v5
    s_add_u32 s56, s56, 819200
    s_add_u32 s62, s56, 819200
    s_cmp_lt_u32 s59, 2
    s_cselect_b32 s62, 2147483648, s62
    s_add_u32 s60, s62, 8192
    s_add_u32 s61, s62, 16384
    s_waitcnt vmcnt(5) lgkmcnt(0)
    s_barrier
    ds_read_b128 v[96:99], v6 offset:0
    ds_read_b128 v[100:103], v6 offset:16
    ds_read_b128 v[104:107], v6 offset:32
    ds_read_b128 v[108:111], v6 offset:48
    ds_read_b128 v[20:23], v9
    ds_read_b128 v[24:27], v9 offset:512
    ds_read_b64 v[28:29], v12
    ds_read_b64 v[30:31], v13
    s_cmp_lg_u32 s66, 0
    s_cbranch_scc1 L_rnf0_
    buffer_store_dwordx4 v[136:139], v10, s[44:47], s58 offen sc1
L_rnf0_:
    v_xor_b32 v6, 1024, v6
    s_waitcnt lgkmcnt(4)
    v_pk_add_f32 v[96:97], v[96:97], v[98:99]
    v_pk_add_f32 v[100:101], v[100:101], v[102:103]
    v_pk_add_f32 v[104:105], v[104:105], v[106:107]
    v_pk_add_f32 v[108:109], v[108:109], v[110:111]
    v_pk_add_f32 v[96:97], v[96:97], v[100:101]
    v_pk_add_f32 v[104:105], v[104:105], v[108:109]
    v_add_f32 v92, v96, v97
    v_add_f32 v93, v104, v105
    v_mul_f32 v92, 0x3acccccd, v92
    v_mul_f32 v93, 0x3acccccd, v93
    v_fma_f32 v93, -v92, v92, v93
    v_max_f32 v93, 0, v93
    v_cvt_pk_bf16_f32 v93, 0, v93
    v_add_f32 v93, 0x3727c5ac, v93
    v_cvt_pk_bf16_f32 v93, 0, v93
    v_sqrt_f32 v93, v93
    v_cvt_pk_bf16_f32 v137, 0, v92
    v_cvt_pk_bf16_f32 v138, 0, v93
    v_rcp_f32 v93, v138
    s_nop 0
    v_mul_f32 v92, v137, v93
.p2align 3
    v_pk_fma_f32 v[52:53], v[32:33], v[92:93], v[92:93] op_sel:[0,1,0] op_sel_hi:[1,1,0] neg_lo:[0,0,1] neg_hi:[0,0,1]
    v_pk_fma_f32 v[54:55], v[34:35], v[92:93], v[92:93] op_sel:[0,1,0] op_sel_hi:[1,1,0] neg_lo:[0,0,1] neg_hi:[0,0,1]
    v_pk_fma_f32 v[56:57], v[36:37], v[92:93], v[92:93] op_sel:[0,1,0] op_sel_hi:[1,1,0] neg_lo:[0,0,1] neg_hi:[0,0,1]
    v_pk_fma_f32 v[58:59], v[38:39], v[92:93], v[92:93] op_sel:[0,1,0] op_sel_hi:[1,1,0] neg_lo:[0,0,1] neg_hi:[0,0,1]
    v_cvt_pk_bf16_f32 v112, v52, v53
    v_cvt_pk_bf16_f32 v113, v54, v55
    v_cvt_pk_bf16_f32 v114, v56, v57
    v_cvt_pk_bf16_f32 v115, v58, v59
    buffer_store_dwordx4 v[112:115], v2, s[44:47], s57 offen sc1
    v_pk_fma_f32 v[60:61], v[40:41], v[92:93], v[92:93] op_sel:[0,1,0] op_sel_hi:[1,1,0] neg_lo:[0,0,1] neg_hi:[0,0,1]
    v_pk_fma_f32 v[62:63], v[42:43], v[92:93], v[92:93] op_sel:[0,1,0] op_sel_hi:[1,1,0] neg_lo:[0,0,1] neg_hi:[0,0,1]
    v_pk_fma_f32 v[64:65], v[44:45], v[92:93], v[92:93] op_sel:[0,1,0] op_sel_hi:[1,1,0] neg_lo:[0,0,1] neg_hi:[0,0,1]
    v_pk_fma_f32 v[66:67], v[46:47], v[92:93], v[92:93] op_sel:[0,1,0] op_sel_hi:[1,1,0] neg_lo:[0,0,1] neg_hi:[0,0,1]
    v_pk_fma_f32 v[68:69], v[48:49], v[92:93], v[92:93] op_sel:[0,1,0] op_sel_hi:[1,1,0] neg_lo:[0,0,1] neg_hi:[0,0,1]
    v_pk_fma_f32 v[70:71], v[50:51], v[92:93], v[92:93] op_sel:[0,1,0] op_sel_hi:[1,1,0] neg_lo:[0,0,1] neg_hi:[0,0,1]
    v_cvt_pk_bf16_f32 v120, v68, v69
    v_cvt_pk_bf16_f32 v121, v70, v71
    v_cvt_pk_bf16_f32 v116, v60, v61
    v_cvt_pk_bf16_f32 v117, v62, v63
    v_cvt_pk_bf16_f32 v118, v64, v65
    v_cvt_pk_bf16_f32 v119, v66, v67
    buffer_store_dwordx4 v[116:119], v2, s[44:47], s63 offen sc1
    v_mov_b32_dpp v122, v120 row_shl:8 row_mask:0xf bank_mask:0xf bound_ctrl:0
    v_mov_b32_dpp v123, v121 row_shl:8 row_mask:0xf bank_mask:0xf bound_ctrl:0
    s_add_u32 s57, s57, 409600
    s_add_u32 s58, s58, 40960
    s_mov_b32 s66, s3
    buffer_store_dwordx4 v[120:123], v4, s[44:47], s64 offen sc1
    s_waitcnt lgkmcnt(0)
    v_lshlrev_b32 v32, 16, v20
    v_and_b32 v33, s26, v20
    v_lshlrev_b32 v34, 16, v21
    v_and_b32 v35, s26, v21
    v_lshlrev_b32 v36, 16, v22
    v_and_b32 v37, s26, v22
    v_lshlrev_b32 v38, 16, v23
    v_and_b32 v39, s26, v23
    v_lshlrev_b32 v40, 16, v24
    v_and_b32 v41, s26, v24
    v_lshlrev_b32 v42, 16, v25
    v_and_b32 v43, s26, v25
    buffer_load_dwordx4 v[72:75], v2, s[44:47], s62 offen offset:0 sc1
    v_lshlrev_b32 v44, 16, v26
    v_and_b32 v45, s26, v26
    v_lshlrev_b32 v46, 16, v27
    v_and_b32 v47, s26, v27
    v_lshlrev_b32 v48, 16, v28
    v_and_b32 v49, s26, v28
    v_lshlrev_b32 v50, 16, v29
    v_and_b32 v51, s26, v29
.p2align 3
    v_pk_fma_f32 v[52:53], v[32:33], v[30:31], v[30:31] op_sel:[0,1,0] op_sel_hi:[1,1,0] neg_lo:[0,0,1] neg_hi:[0,0,1]
    v_pk_fma_f32 v[54:55], v[34:35], v[30:31], v[30:31] op_sel:[0,1,0] op_sel_hi:[1,1,0] neg_lo:[0,0,1] neg_hi:[0,0,1]
    v_pk_fma_f32 v[56:57], v[36:37], v[30:31], v[30:31] op_sel:[0,1,0] op_sel_hi:[1,1,0] neg_lo:[0,0,1] neg_hi:[0,0,1]
    v_pk_fma_f32 v[58:59], v[38:39], v[30:31], v[30:31] op_sel:[0,1,0] op_sel_hi:[1,1,0] neg_lo:[0,0,1] neg_hi:[0,0,1]
    v_pk_fma_f32 v[60:61], v[40:41], v[30:31], v[30:31] op_sel:[0,1,0] op_sel_hi:[1,1,0] neg_lo:[0,0,1] neg_hi:[0,0,1]
    v_pk_fma_f32 v[62:63], v[42:43], v[30:31], v[30:31] op_sel:[0,1,0] op_sel_hi:[1,1,0] neg_lo:[0,0,1] neg_hi:[0,0,1]
    v_pk_fma_f32 v[64:65], v[44:45], v[30:31], v[30:31] op_sel:[0,1,0] op_sel_hi:[1,1,0] neg_lo:[0,0,1] neg_hi:[0,0,1]
    v_pk_fma_f32 v[66:67], v[46:47], v[30:31], v[30:31] op_sel:[0,1,0] op_sel_hi:[1,1,0] neg_lo:[0,0,1] neg_hi:[0,0,1]
    buffer_load_dwordx4 v[76:79], v2, s[44:47], s62 offen offset:128 sc1
    v_pk_fma_f32 v[68:69], v[48:49], v[30:31], v[30:31] op_sel:[0,1,0] op_sel_hi:[1,1,0] neg_lo:[0,0,1] neg_hi:[0,0,1]
    v_pk_fma_f32 v[70:71], v[50:51], v[30:31], v[30:31] op_sel:[0,1,0] op_sel_hi:[1,1,0] neg_lo:[0,0,1] neg_hi:[0,0,1]
    v_add_u32 v9, 8704, v9
    v_add_u32 v12, 2048, v12
    v_add_u32 v13, 64, v13
    s_sub_u32 s59, s59, 1
    s_waitcnt vmcnt(5)
    s_cbranch_scc1 L_rdone
L_rtop1:
    v_xor_b32 v140, s99, v140
    v_xor_b32 v141, s99, v141
    v_xor_b32 v142, s99, v142
    v_xor_b32 v143, s99, v143
    v_xor_b32 v144, s99, v144
    v_xor_b32 v145, s99, v145
    v_xor_b32 v146, s99, v146
    v_xor_b32 v147, s99, v147
    buffer_load_dwordx4 v[80:83], v2, s[44:47], s60 offen offset:0 sc1
    v_xor_b32 v148, s99, v148
    v_xor_b32 v149, s99, v149
    v_xor_b32 v150, s99, v150
    v_xor_b32 v151, s99, v151
    v_xor_b32 v152, s99, v152
    v_xor_b32 v153, s99, v153
    v_xor_b32 v154, s99, v154
    v_xor_b32 v155, s99, v155
    v_xor_b32 v156, s99, v156
    v_xor_b32 v157, s99, v157
    v_xor_b32 v158, s99, v158
    v_xor_b32 v159, s99, v159
    v_or3_b32 v16, v140, v141, v142
    v_or3_b32 v17, v143, v144, v145
    v_or3_b32 v16, v146, v147, v16
    v_or3_b32 v17, v148, v149, v17
    buffer_load_dwordx4 v[84:87], v2, s[44:47], s60 offen offset:128 sc1
    v_or3_b32 v16, v150, v151, v16
    v_or3_b32 v17, v152, v153, v17
    v_or3_b32 v16, v154, v155, v16
    v_or3_b32 v17, v156, v157, v17
    v_or3_b32 v16, v158, v159, v16
    v_or_b32 v16, v16, v17
    v_cmp_ne_u16 vcc, 0, v16
    s_nop 0
    s_cbranch_vccnz L_ry1r
L_ry1b:
.p2align 3
    v_pk_fma_f32 v[32:33], v[52:53], v[140:141], v[32:33]
    v_pk_fma_f32 v[34:35], v[54:55], v[142:143], v[34:35]
    v_pk_fma_f32 v[36:37], v[56:57], v[144:145], v[36:37]
    v_pk_fma_f32 v[38:39], v[58:59], v[146:147], v[38:39]
    v_pk_fma_f32 v[40:41], v[60:61], v[148:149], v[40:41]
    v_pk_fma_f32 v[42:43], v[62:63], v[150:151], v[42:43]
    v_pk_fma_f32 v[44:45], v[64:65], v[152:153], v[44:45]
    v_pk_fma_f32 v[46:47], v[66:67], v[154:155], v[46:47]
    v_pk_fma_f32 v[48:49], v[68:69], v[156:157], v[48:49]
    v_pk_fma_f32 v[50:51], v[70:71], v[158:159], v[50:51]
    buffer_load_dwordx4 v[88:91], v3, s[44:47], s61 offen offset:0 sc1
.p2align 3
    v_pk_add_f32 v[92:93], v[32:33], v[34:35]
    v_pk_mul_f32 v[94:95], v[32:33], v[32:33]
    v_pk_fma_f32 v[94:95], v[34:35], v[34:35], v[94:95]
    v_pk_add_f32 v[92:93], v[92:93], v[36:37]
    v_pk_fma_f32 v[94:95], v[36:37], v[36:37], v[94:95]
    v_pk_add_f32 v[92:93], v[92:93], v[38:39]
    v_pk_fma_f32 v[94:95], v[38:39], v[38:39], v[94:95]
    v_pk_add_f32 v[92:93], v[92:93], v[40:41]
    v_pk_fma_f32 v[94:95], v[40:41], v[40:41], v[94:95]
    v_pk_add_f32 v[92:93], v[92:93], v[42:43]
    v_pk_fma_f32 v[94:95], v[42:43], v[42:43], v[94:95]
    v_pk_add_f32 v[92:93], v[92:93], v[44:45]
    v_pk_fma_f32 v[94:95], v[44:45], v[44:45], v[94:95]
    v_pk_add_f32 v[92:93], v[92:93], v[46:47]
    v_pk_fma_f32 v[94:95], v[46:47], v[46:47], v[94:95]
    v_pk_add_f32 v[92:93], v[92:93], v[48:49]
    v_pk_fma_f32 v[94:95], v[48:49], v[48:49], v[94:95]
    v_pk_add_f32 v[92:93], v[92:93], v[50:51]
    v_pk_fma_f32 v[94:95], v[50:51], v[50:51], v[94:95]
    v_add_f32 v92, v92, v93
    v_add_f32 v93, v94, v95
    s_nop 1
    v_permlane16_swap_b32 v92, v93
    v_add_f32 v92, v92, v93
    s_nop 1
    v_add_f32_dpp v92, v92, v92 row_ror:8 row_mask:0xf bank_mask:0xf
    ds_write_b32 v5, v92
    s_add_u32 s63, s57, 8192
    s_add_u32 s64, s57, 16384
    v_xor_b32 v5, 1024, v5
    s_add_u32 s56, s56, 819200
    s_add_u32 s62, s56, 819200
    s_cmp_lt_u32 s59, 2
    s_cselect_b32 s62, 2147483648, s62
    s_add_u32 s60, s62, 8192
    s_add_u32 s61, s62, 16384
    s_waitcnt vmcnt(5) lgkmcnt(0)
    s_barrier
    ds_read_b128 v[96:99], v6 offset:0
    ds_read_b128 v[100:103], v6 offset:16
    ds_read_b128 v[104:107], v6 offset:32
    ds_read_b128 v[108:111], v6 offset:48
    ds_read_b128 v[20:23], v9
    ds_read_b128 v[24:27], v9 offset:512
    ds_read_b64 v[28:29], v12
    ds_read_b64 v[30:31], v13
    s_cmp_lg_u32 s66, 0
    s_cbranch_scc1 L_rnf1_
    buffer_store_dwordx4 v[136:139], v10, s[44:47], s58 offen sc1
L_rnf1_:
    v_xor_b32 v6, 1024, v6
    s_waitcnt lgkmcnt(4)
    v_pk_add_f32 v[96:97], v[96:97], v[98:99]
    v_pk_add_f32 v[100:101], v[100:101], v[102:103]
    v_pk_add_f32 v[104:105], v[104:105], v[106:107]
    v_pk_add_f32 v[108:109], v[108:109], v[110:111]
    v_pk_add_f32 v[96:97], v[96:97], v[100:101]
    v_pk_add_f32 v[104:105], v[104:105], v[108:109]
    v_add_f32 v92, v96, v97
    v_add_f32 v93, v104, v105
    v_mul_f32 v92, 0x3acccccd, v92
    v_mul_f32 v93, 0x3acccccd, v93
    v_fma_f32 v93, -v92, v92, v93
    v_max_f32 v93, 0, v93
    v_cvt_pk_bf16_f32 v93, 0, v93
    v_add_f32 v93, 0x3727c5ac, v93
    v_cvt_pk_bf16_f32 v93, 0, v93
    v_sqrt_f32 v93, v93
    v_cvt_pk_bf16_f32 v137, 0, v92
    v_cvt_pk_bf16_f32 v138, 0, v93
    v_rcp_f32 v93, v138
    s_nop 0
    v_mul_f32 v92, v137, v93
.p2align 3
    v_pk_fma_f32 v[52:53], v[32:33], v[92:93], v[92:93] op_sel:[0,1,0] op_sel_hi:[1,1,0] neg_lo:[0,0,1] neg_hi:[0,0,1]
    v_pk_fma_f32 v[54:55], v[34:35], v[92:93], v[92:93] op_sel:[0,1,0] op_sel_hi:[1,1,0] neg_lo:[0,0,1] neg_hi:[0,0,1]
    v_pk_fma_f32 v[56:57], v[36:37], v[92:93], v[92:93] op_sel:[0,1,0] op_sel_hi:[1,1,0] neg_lo:[0,0,1] neg_hi:[0,0,1]
    v_pk_fma_f32 v[58:59], v[38:39], v[92:93], v[92:93] op_sel:[0,1,0] op_sel_hi:[1,1,0] neg_lo:[0,0,1] neg_hi:[0,0,1]
    v_cvt_pk_bf16_f32 v112, v52, v53
    v_cvt_pk_bf16_f32 v113, v54, v55
    v_cvt_pk_bf16_f32 v114, v56, v57
    v_cvt_pk_bf16_f32 v115, v58, v59
    buffer_store_dwordx4 v[112:115], v2, s[44:47], s57 offen sc1
    v_pk_fma_f32 v[60:61], v[40:41], v[92:93], v[92:93] op_sel:[0,1,0] op_sel_hi:[1,1,0] neg_lo:[0,0,1] neg_hi:[0,0,1]
    v_pk_fma_f32 v[62:63], v[42:43], v[92:93], v[92:93] op_sel:[0,1,0] op_sel_hi:[1,1,0] neg_lo:[0,0,1] neg_hi:[0,0,1]
    v_pk_fma_f32 v[64:65], v[44:45], v[92:93], v[92:93] op_sel:[0,1,0] op_sel_hi:[1,1,0] neg_lo:[0,0,1] neg_hi:[0,0,1]
    v_pk_fma_f32 v[66:67], v[46:47], v[92:93], v[92:93] op_sel:[0,1,0] op_sel_hi:[1,1,0] neg_lo:[0,0,1] neg_hi:[0,0,1]
    v_pk_fma_f32 v[68:69], v[48:49], v[92:93], v[92:93] op_sel:[0,1,0] op_sel_hi:[1,1,0] neg_lo:[0,0,1] neg_hi:[0,0,1]
    v_pk_fma_f32 v[70:71], v[50:51], v[92:93], v[92:93] op_sel:[0,1,0] op_sel_hi:[1,1,0] neg_lo:[0,0,1] neg_hi:[0,0,1]
    v_cvt_pk_bf16_f32 v120, v68, v69
    v_cvt_pk_bf16_f32 v121, v70, v71
    v_cvt_pk_bf16_f32 v116, v60, v61
    v_cvt_pk_bf16_f32 v117, v62, v63
    v_cvt_pk_bf16_f32 v118, v64, v65
    v_cvt_pk_bf16_f32 v119, v66, v67
    buffer_store_dwordx4 v[116:119], v2, s[44:47], s63 offen sc1
    v_mov_b32_dpp v122, v120 row_shl:8 row_mask:0xf bank_mask:0xf bound_ctrl:0
    v_mov_b32_dpp v123, v121 row_shl:8 row_mask:0xf bank_mask:0xf bound_ctrl:0
    s_add_u32 s57, s57, 409600
    s_add_u32 s58, s58, 40960
    s_mov_b32 s66, s3
    buffer_store_dwordx4 v[120:123], v4, s[44:47], s64 offen sc1
    s_waitcnt lgkmcnt(0)
    v_lshlrev_b32 v32, 16, v20
    v_and_b32 v33, s26, v20
    v_lshlrev_b32 v34, 16, v21
    v_and_b32 v35, s26, v21
    v_lshlrev_b32 v36, 16, v22
    v_and_b32 v37, s26, v22
    v_lshlrev_b32 v38, 16, v23
    v_and_b32 v39, s26, v23
    v_lshlrev_b32 v40, 16, v24
    v_and_b32 v41, s26, v24
    v_lshlrev_b32 v42, 16, v25
    v_and_b32 v43, s26, v25
    buffer_load_dwordx4 v[140:143], v2, s[44:47], s62 offen offset:0 sc1
    v_lshlrev_b32 v44, 16, v26
    v_and_b32 v45, s26, v26
    v_lshlrev_b32 v46, 16, v27
    v_and_b32 v47, s26, v27
    v_lshlrev_b32 v48, 16, v28
    v_and_b32 v49, s26, v28
    v_lshlrev_b32 v50, 16, v29
    v_and_b32 v51, s26, v29
.p2align 3
    v_pk_fma_f32 v[52:53], v[32:33], v[30:31], v[30:31] op_sel:[0,1,0] op_sel_hi:[1,1,0] neg_lo:[0,0,1] neg_hi:[0,0,1]
    v_pk_fma_f32 v[54:55], v[34:35], v[30:31], v[30:31] op_sel:[0,1,0] op_sel_hi:[1,1,0] neg_lo:[0,0,1] neg_hi:[0,0,1]
    v_pk_fma_f32 v[56:57], v[36:37], v[30:31], v[30:31] op_sel:[0,1,0] op_sel_hi:[1,1,0] neg_lo:[0,0,1] neg_hi:[0,0,1]
    v_pk_fma_f32 v[58:59], v[38:39], v[30:31], v[30:31] op_sel:[0,1,0] op_sel_hi:[1,1,0] neg_lo:[0,0,1] neg_hi:[0,0,1]
    v_pk_fma_f32 v[60:61], v[40:41], v[30:31], v[30:31] op_sel:[0,1,0] op_sel_hi:[1,1,0] neg_lo:[0,0,1] neg_hi:[0,0,1]
    v_pk_fma_f32 v[62:63], v[42:43], v[30:31], v[30:31] op_sel:[0,1,0] op_sel_hi:[1,1,0] neg_lo:[0,0,1] neg_hi:[0,0,1]
    v_pk_fma_f32 v[64:65], v[44:45], v[30:31], v[30:31] op_sel:[0,1,0] op_sel_hi:[1,1,0] neg_lo:[0,0,1] neg_hi:[0,0,1]
    v_pk_fma_f32 v[66:67], v[46:47], v[30:31], v[30:31] op_sel:[0,1,0] op_sel_hi:[1,1,0] neg_lo:[0,0,1] neg_hi:[0,0,1]
    buffer_load_dwordx4 v[144:147], v2, s[44:47], s62 offen offset:128 sc1
    v_pk_fma_f32 v[68:69], v[48:49], v[30:31], v[30:31] op_sel:[0,1,0] op_sel_hi:[1,1,0] neg_lo:[0,0,1] neg_hi:[0,0,1]
    v_pk_fma_f32 v[70:71], v[50:51], v[30:31], v[30:31] op_sel:[0,1,0] op_sel_hi:[1,1,0] neg_lo:[0,0,1] neg_hi:[0,0,1]
    v_add_u32 v9, 8704, v9
    v_add_u32 v12, 2048, v12
    v_add_u32 v13, 64, v13
    s_sub_u32 s59, s59, 1
    s_waitcnt vmcnt(5)
    s_cbranch_scc0 L_rtop0
L_rdone:
    buffer_load_dword v161, v160, s[44:47], s69 offen sc1
    s_waitcnt vmcnt(0)
    s_barrier
    s_cmp_lg_u32 s66, 0
    s_cbranch_scc1 L_rnf2
    buffer_store_dwordx4 v[136:139], v10, s[44:47], s58 offen sc1
L_rnf2:
    s_cmp_eq_u32 s67, 0
    s_cbranch_scc1 L_rfin
    s_mov_b32 s59, s67
    s_mov_b32 s67, 0
    v_xor_b32 v161, s99, v161
    v_cmp_ne_u16 vcc, 0, v161
    s_nop 0
    s_cbranch_vccnz L_rh2r
L_rh2b:
    s_barrier
    s_add_u32 s30, s56, 8192
    s_add_u32 s31, s56, 16384
    buffer_load_dwordx4 v[72:75], v2, s[44:47], s56 offen offset:0 sc1
    buffer_load_dwordx4 v[76:79], v2, s[44:47], s56 offen offset:128 sc1
    buffer_load_dwordx4 v[80:83], v2, s[44:47], s30 offen offset:0 sc1
    buffer_load_dwordx4 v[84:87], v2, s[44:47], s30 offen offset:128 sc1
    buffer_load_dwordx4 v[88:91], v3, s[44:47], s31 offen offset:0 sc1
    s_branch L_rre
L_rfin:
    s_waitcnt vmcnt(0)
    v_min_u32 v89, 13, v1
    v_add_u32 v89, s74, v89
    v_min_u32 v89, 53, v89
    v_lshlrev_b32 v89, 8, v89
    s_mov_b32 s30, 41947136
    buffer_load_dword v88, v89, s[44:47], s30 offen sc1
    s_lshr_b32 s48, s3, 1
    s_lshl_b32 s48, s48, 31
    v_or_b32 v6, s48, v10
    s_waitcnt vmcnt(0)
    v_cmp_ne_u32 vcc, v11, v88
    s_nop 0
    s_cbranch_vccnz L_msw2r
L_msw2b:
    s_add_u32 s31, s72, 0
    buffer_load_dwordx4 v[96:99], v10, s[44:47], s31 offen offset:0 sc1
    buffer_load_dwordx4 v[100:103], v10, s[44:47], s31 offen offset:1024 sc1
    buffer_load_dwordx4 v[104:107], v10, s[44:47], s31 offen offset:2048 sc1
    buffer_load_dwordx4 v[108:111], v10, s[44:47], s31 offen offset:3072 sc1
    s_add_u32 s31, s72, 4096
    buffer_load_dwordx4 v[112:115], v10, s[44:47], s31 offen offset:0 sc1
    buffer_load_dwordx4 v[116:119], v10, s[44:47], s31 offen offset:1024 sc1
    buffer_load_dwordx4 v[120:123], v10, s[44:47], s31 offen offset:2048 sc1
    buffer_load_dwordx4 v[124:127], v10, s[44:47], s31 offen offset:3072 sc1
    s_add_u32 s31, s72, 8192
    buffer_load_dwordx4 v[128:131], v10, s[44:47], s31 offen offset:0 sc1
    buffer_load_dwordx4 v[132:135], v10, s[44:47], s31 offen offset:1024 sc1
    buffer_load_dwordx4 v[136:139], v10, s[44:47], s31 offen offset:2048 sc1
    buffer_load_dwordx4 v[140:143], v10, s[44:47], s31 offen offset:3072 sc1
    s_add_u32 s31, s72, 12288
    buffer_load_dwordx4 v[144:147], v10, s[44:47], s31 offen offset:0 sc1
    buffer_load_dwordx4 v[148:151], v10, s[44:47], s31 offen offset:1024 sc1
    buffer_load_dwordx4 v[152:155], v10, s[44:47], s31 offen offset:2048 sc1
    buffer_load_dwordx4 v[156:159], v10, s[44:47], s31 offen offset:3072 sc1
    s_add_u32 s31, s72, 16384
    buffer_load_dwordx4 v[160:163], v10, s[44:47], s31 offen offset:0 sc1
    buffer_load_dwordx4 v[164:167], v10, s[44:47], s31 offen offset:1024 sc1
    buffer_load_dwordx4 v[168:171], v10, s[44:47], s31 offen offset:2048 sc1
    buffer_load_dwordx4 v[172:175], v10, s[44:47], s31 offen offset:3072 sc1
    s_add_u32 s31, s72, 20480
    buffer_load_dwordx4 v[176:179], v10, s[44:47], s31 offen offset:0 sc1
    buffer_load_dwordx4 v[180:183], v10, s[44:47], s31 offen offset:1024 sc1
    buffer_load_dwordx4 v[184:187], v10, s[44:47], s31 offen offset:2048 sc1
    buffer_load_dwordx4 v[188:191], v10, s[44:47], s31 offen offset:3072 sc1
    s_add_u32 s31, s72, 24576
    buffer_load_dwordx4 v[192:195], v10, s[44:47], s31 offen offset:0 sc1
    buffer_load_dwordx4 v[196:199], v10, s[44:47], s31 offen offset:1024 sc1
    buffer_load_dwordx4 v[200:203], v10, s[44:47], s31 offen offset:2048 sc1
    buffer_load_dwordx4 v[204:207], v10, s[44:47], s31 offen offset:3072 sc1
    s_add_u32 s31, s72, 28672
    buffer_load_dwordx4 v[208:211], v10, s[44:47], s31 offen offset:0 sc1
    buffer_load_dwordx4 v[212:215], v10, s[44:47], s31 offen offset:1024 sc1
    buffer_load_dwordx4 v[216:219], v10, s[44:47], s31 offen offset:2048 sc1
    buffer_load_dwordx4 v[220:223], v10, s[44:47], s31 offen offset:3072 sc1
    s_waitcnt vmcnt(16)
    s_add_u32 s31, s72, 32768
    buffer_load_dwordx4 v[224:227], v10, s[44:47], s31 offen offset:0 sc1
    buffer_load_dwordx4 v[228:231], v10, s[44:47], s31 offen offset:1024 sc1
    buffer_load_dwordx4 v[232:235], v10, s[44:47], s31 offen offset:2048 sc1
    buffer_load_dwordx4 v[236:239], v10, s[44:47], s31 offen offset:3072 sc1
    s_add_u32 s31, s72, 36864
    buffer_load_dwordx4 v[240:243], v10, s[44:47], s31 offen offset:0 sc1
    buffer_load_dwordx4 v[244:247], v10, s[44:47], s31 offen offset:1024 sc1
    buffer_load_dwordx4 v[248:251], v10, s[44:47], s31 offen offset:2048 sc1
    buffer_load_dwordx4 v[252:255], v10, s[44:47], s31 offen offset:3072 sc1
    s_add_u32 s31, s72, 40960
    buffer_load_dwordx4 a[160:163], v10, s[44:47], s31 offen offset:0 sc1
    buffer_load_dwordx4 a[164:167], v10, s[44:47], s31 offen offset:1024 sc1
    buffer_load_dwordx4 a[168:171], v10, s[44:47], s31 offen offset:2048 sc1
    buffer_load_dwordx4 a[172:175], v10, s[44:47], s31 offen offset:3072 sc1
    s_add_u32 s31, s72, 45056
    buffer_load_dwordx4 a[176:179], v10, s[44:47], s31 offen offset:0 sc1
    buffer_load_dwordx4 a[180:183], v10, s[44:47], s31 offen offset:1024 sc1
    buffer_load_dwordx4 a[184:187], v10, s[44:47], s31 offen offset:2048 sc1
    buffer_load_dwordx4 a[188:191], v10, s[44:47], s31 offen offset:3072 sc1
    s_add_u32 s31, s72, 49152
    buffer_load_dwordx4 a[192:195], v10, s[44:47], s31 offen offset:0 sc1
    buffer_load_dwordx4 a[196:199], v10, s[44:47], s31 offen offset:1024 sc1
    buffer_load_dwordx4 a[200:203], v10, s[44:47], s31 offen offset:2048 sc1
    buffer_load_dwordx4 a[204:207], v10, s[44:47], s31 offen offset:3072 sc1
    s_add_u32 s31, s72, 53248
    buffer_load_dwordx4 a[208:211], v10, s[44:47], s31 offen offset:0 sc1
    buffer_load_dwordx4 a[212:215], v10, s[44:47], s31 offen offset:1024 sc1
    buffer_load_dwordx4 a[216:219], v10, s[44:47], s31 offen offset:2048 sc1
    buffer_load_dwordx4 a[220:223], v10, s[44:47], s31 offen offset:3072 sc1
    s_add_u32 s31, s72, 57344
    buffer_load_dwordx4 a[224:227], v10, s[44:47], s31 offen offset:0 sc1
    buffer_load_dwordx4 a[228:231], v10, s[44:47], s31 offen offset:1024 sc1
    buffer_load_dwordx4 a[232:235], v10, s[44:47], s31 offen offset:2048 sc1
    buffer_load_dwordx4 a[236:239], v10, s[44:47], s31 offen offset:3072 sc1
    s_add_u32 s31, s72, 61440
    buffer_load_dwordx4 a[240:243], v10, s[44:47], s31 offen offset:0 sc1
    buffer_load_dwordx4 a[244:247], v10, s[44:47], s31 offen offset:1024 sc1
    buffer_load_dwordx4 a[248:251], v10, s[44:47], s31 offen offset:2048 sc1
    buffer_load_dwordx4 a[252:255], v10, s[44:47], s31 offen offset:3072 sc1
    s_add_u32 s31, s72, 65536
    buffer_load_dwordx4 a[56:59], v10, s[44:47], s31 offen offset:0 sc1
    buffer_load_dwordx4 a[60:63], v6, s[44:47], s31 offen offset:1024 sc1
    buffer_load_dwordx4 a[64:67], v6, s[44:47], s31 offen offset:2048 sc1
    buffer_load_dwordx4 a[68:71], v6, s[44:47], s31 offen offset:3072 sc1
    s_add_u32 s31, s72, 69632
    buffer_load_dwordx4 a[72:75], v6, s[44:47], s31 offen offset:0 sc1
    buffer_load_dwordx4 a[76:79], v6, s[44:47], s31 offen offset:1024 sc1
    v_bfrev_b32 v9, 1
    v_bfrev_b32 v5, 1
    s_mov_b32 s51, 0
    s_mov_b32 s54, 0
    s_mov_b32 s56, 0
    s_mov_b32 s57, 0
    s_lshr_b32 s59, s76, 1
    s_lshl_b32 s59, s59, 5
    s_lshr_b32 s30, s74, 1
    s_add_u32 s59, s59, s30
    s_lshl_b32 s59, s59, 1
    s_and_b32 s30, s97, 1
    s_add_u32 s59, s59, s30
    s_lshl_b32 s59, s59, 7
    s_add_u32 s59, s59, 42205184
    v_min_u32 v7, 6, v1
    v_lshlrev_b32 v7, 8, v7
    s_cmp_lg_u32 s3, 0
    s_cbranch_scc1 L_msh
    s_mul_i32 s30, s79, 2731
    s_lshr_b32 s30, s30, 12
    s_lshl_b32 s30, s30, 8
    v_mov_b32 v88, s30
    s_add_u32 s30, s59, 131072
    buffer_load_dword v8, v88, s[44:47], s30 offen sc1
    s_waitcnt vmcnt(0)
    v_cmp_ne_u32 vcc, v11, v8
    s_nop 0
    s_cbranch_vccnz L_mshr
L_mshb:
L_msh:
    s_barrier
    s_buffer_load_dword s6, s[44:47], s59 offset:0
    s_buffer_load_dword s7, s[44:47], s59 offset:256
    s_buffer_load_dword s8, s[44:47], s59 offset:512
    s_buffer_load_dword s9, s[44:47], s59 offset:768
    s_buffer_load_dword s10, s[44:47], s59 offset:1024
    s_buffer_load_dword s11, s[44:47], s59 offset:1280
    s_buffer_load_dword s12, s[44:47], s59 offset:1536
    s_waitcnt lgkmcnt(0)
    s_mov_b32 s13, s12
    s_xor_b64 s[6:7], s[6:7], s[4:5]
    s_xor_b64 s[8:9], s[8:9], s[4:5]
    s_xor_b64 s[10:11], s[10:11], s[4:5]
    s_xor_b64 s[12:13], s[12:13], s[4:5]
    s_or_b64 s[6:7], s[6:7], s[8:9]
    s_or_b64 s[10:11], s[10:11], s[12:13]
    s_or_b64 s[6:7], s[6:7], s[10:11]
    s_cbranch_scc1 L_g2p0mr
L_g2p0mb:
    s_add_u32 s49, s73, 0
    buffer_load_dwordx4 a[0:3], v10, s[44:47], s49 offen offset:0 sc1
    buffer_load_dwordx4 a[4:7], v10, s[44:47], s49 offen offset:1024 sc1
    buffer_load_dwordx4 a[8:11], v10, s[44:47], s49 offen offset:2048 sc1
    buffer_load_dwordx4 a[12:15], v10, s[44:47], s49 offen offset:3072 sc1
    s_add_u32 s49, s73, 4096
    buffer_load_dwordx4 a[16:19], v10, s[44:47], s49 offen offset:0 sc1
    buffer_load_dwordx4 a[20:23], v10, s[44:47], s49 offen offset:1024 sc1
    buffer_load_dwordx4 a[24:27], v10, s[44:47], s49 offen offset:2048 sc1
    buffer_load_dwordx4 a[28:31], v10, s[44:47], s49 offen offset:3072 sc1
    s_add_u32 s49, s73, 8192
    buffer_load_dwordx4 a[32:35], v10, s[44:47], s49 offen offset:0 sc1
    s_buffer_load_dword s6, s[44:47], s59 offset:131072
    s_buffer_load_dword s7, s[44:47], s59 offset:131328
    s_buffer_load_dword s8, s[44:47], s59 offset:131584
    s_buffer_load_dword s9, s[44:47], s59 offset:131840
    s_buffer_load_dword s10, s[44:47], s59 offset:132096
    s_buffer_load_dword s11, s[44:47], s59 offset:132352
    s_buffer_load_dword s12, s[44:47], s59 offset:132608
    s_waitcnt lgkmcnt(0)
    s_mov_b32 s13, s12
    s_xor_b64 s[6:7], s[6:7], s[4:5]
    s_xor_b64 s[8:9], s[8:9], s[4:5]
    s_xor_b64 s[10:11], s[10:11], s[4:5]
    s_xor_b64 s[12:13], s[12:13], s[4:5]
    s_or_b64 s[6:7], s[6:7], s[8:9]
    s_or_b64 s[10:11], s[10:11], s[12:13]
    s_or_b64 s[6:7], s[6:7], s[10:11]
    s_cbranch_scc1 L_g2p1mr
L_g2p1mb:
    v_lshrrev_b32 v89, 2, v1
    v_and_b32 v88, 3, v1
    s_lshl_b32 s63, s3, 2
    v_add_u32 v88, s63, v88
    v_add_u32 v90, 24, v1
    v_lshrrev_b32 v90, 6, v90
    v_lshlrev_b32 v90, 31, v90
    v_lshl_or_b32 v90, v89, 8, v90
    v_lshl_add_u32 v90, v88, 4, v90
    s_mul_i32 s61, s76, 20480
    s_mul_i32 s63, s75, 2560
    s_add_u32 s61, s61, s63
    s_add_u32 s61, s61, 4194304
    v_and_b32 v91, 7, v88
    v_lshlrev_b32 v91, 4, v91
    s_lshr_b32 s62, s3, 1
    s_lshl_b32 s63, s76, 1
    s_add_u32 s62, s62, s63
    s_lshl_b32 s62, s62, 10
    s_lshl_b32 s63, s97, 7
    s_add_u32 s62, s62, s63
    s_add_u32 s62, s62, 42991616
    s_sub_u32 s30, s2, 216
    s_or_b32 s30, s30, s3
    s_cbranch_scc1 L_noep
    v_and_b32 v20, 31, v1
    v_min_u32 v20, 26, v20
    v_lshlrev_b32 v20, 8, v20
    v_lshrrev_b32 v21, 5, v1
    v_lshl_add_u32 v20, v21, 13, v20
    v_min_u32 v21, 39, v1
    v_lshlrev_b32 v21, 10, v21
    v_lshlrev_b32 v23, 2, v1
    s_mov_b32 s30, 42205184
    buffer_load_dword v24, v20, s[44:47], s30 offen sc1
    s_mov_b32 s30, 42221568
    buffer_load_dword v25, v20, s[44:47], s30 offen sc1
    s_mov_b32 s30, 42237952
    buffer_load_dword v26, v20, s[44:47], s30 offen sc1
    s_mov_b32 s30, 42254336
    buffer_load_dword v27, v20, s[44:47], s30 offen sc1
    s_mov_b32 s30, 42991616
    buffer_load_dword v28, v21, s[44:47], s30 offen sc1
    s_waitcnt vmcnt(0)
    v_xor_b32 v22, v11, v24
    v_bitop3_b32 v22, v25, v11, v22 bitop3:0xbe
    v_bitop3_b32 v22, v26, v11, v22 bitop3:0xbe
    v_bitop3_b32 v22, v27, v11, v22 bitop3:0xbe
    v_bitop3_b32 v22, v28, v11, v22 bitop3:0xbe
    v_cmp_ne_u32 vcc, 0, v22
    s_nop 0
    s_cbranch_vccnz L_epr
L_epb:
    s_mov_b32 s30, 41943040
    buffer_store_dword v11, v23, s[44:47], s30 offen sc1
L_noep:
    s_waitcnt vmcnt(0)
    s_branch L_g2
L_cv0r:
    s_mov_b32 s95, 131072
L_cv0l:
    s_add_u32 s30, s68, 0
    buffer_load_dwordx4 v[188:191], v10, s[44:47], s30 offen sc1
    s_sub_u32 s95, s95, 1
    s_waitcnt vmcnt(0)
    s_cbranch_scc1 L_cv0b
    v_xor_b32 v20, s99, v188
    v_bitop3_b32 v20, v189, s99, v20 bitop3:0xbe
    v_bitop3_b32 v20, v190, s99, v20 bitop3:0xbe
    v_bitop3_b32 v20, v191, s99, v20 bitop3:0xbe
    v_cmp_ne_u16 vcc, 0, v20
    s_nop 0
    s_cbranch_vccnz L_cv0l
    s_branch L_cv0b
L_cv1r:
    s_mov_b32 s95, 131072
L_cv1l:
    s_add_u32 s30, s68, 655360
    buffer_load_dwordx4 v[192:195], v10, s[44:47], s30 offen sc1
    s_sub_u32 s95, s95, 1
    s_waitcnt vmcnt(0)
    s_cbranch_scc1 L_cv1b
    v_xor_b32 v20, s99, v192
    v_bitop3_b32 v20, v193, s99, v20 bitop3:0xbe
    v_bitop3_b32 v20, v194, s99, v20 bitop3:0xbe
    v_bitop3_b32 v20, v195, s99, v20 bitop3:0xbe
    v_cmp_ne_u16 vcc, 0, v20
    s_nop 0
    s_cbranch_vccnz L_cv1l
    s_branch L_cv1b
L_cv2r:
    s_mov_b32 s95, 131072
L_cv2l:
    s_add_u32 s30, s68, 1310720
    buffer_load_dwordx4 v[196:199], v10, s[44:47], s30 offen sc1
    s_sub_u32 s95, s95, 1
    s_waitcnt vmcnt(0)
    s_cbranch_scc1 L_cv2b
    v_xor_b32 v20, s99, v196
    v_bitop3_b32 v20, v197, s99, v20 bitop3:0xbe
    v_bitop3_b32 v20, v198, s99, v20 bitop3:0xbe
    v_bitop3_b32 v20, v199, s99, v20 bitop3:0xbe
    v_cmp_ne_u16 vcc, 0, v20
    s_nop 0
    s_cbranch_vccnz L_cv2l
    s_branch L_cv2b
L_cv3r:
    s_mov_b32 s95, 131072
L_cv3l:
    s_add_u32 s30, s68, 1966080
    buffer_load_dwordx4 v[200:203], v10, s[44:47], s30 offen sc1
    s_sub_u32 s95, s95, 1
    s_waitcnt vmcnt(0)
    s_cbranch_scc1 L_cv3b
    v_xor_b32 v20, s99, v200
    v_bitop3_b32 v20, v201, s99, v20 bitop3:0xbe
    v_bitop3_b32 v20, v202, s99, v20 bitop3:0xbe
    v_bitop3_b32 v20, v203, s99, v20 bitop3:0xbe
    v_cmp_ne_u16 vcc, 0, v20
    s_nop 0
    s_cbranch_vccnz L_cv3l
    s_branch L_cv3b
L_cv4r:
    s_mov_b32 s95, 131072
L_cv4l:
    s_add_u32 s30, s68, 2621440
    buffer_load_dwordx4 v[204:207], v10, s[44:47], s30 offen sc1
    s_sub_u32 s95, s95, 1
    s_waitcnt vmcnt(0)
    s_cbranch_scc1 L_cv4b
    v_xor_b32 v20, s99, v204
    v_bitop3_b32 v20, v205, s99, v20 bitop3:0xbe
    v_bitop3_b32 v20, v206, s99, v20 bitop3:0xbe
    v_bitop3_b32 v20, v207, s99, v20 bitop3:0xbe
    v_cmp_ne_u16 vcc, 0, v20
    s_nop 0
    s_cbranch_vccnz L_cv4l
    s_branch L_cv4b
L_cv5r:
    s_mov_b32 s95, 131072
L_cv5l:
    s_add_u32 s30, s68, 3276800
    buffer_load_dwordx4 v[208:211], v10, s[44:47], s30 offen sc1
    s_sub_u32 s95, s95, 1
    s_waitcnt vmcnt(0)
    s_cbranch_scc1 L_cv5b
    v_xor_b32 v20, s99, v208
    v_bitop3_b32 v20, v209, s99, v20 bitop3:0xbe
    v_bitop3_b32 v20, v210, s99, v20 bitop3:0xbe
    v_bitop3_b32 v20, v211, s99, v20 bitop3:0xbe
    v_cmp_ne_u16 vcc, 0, v20
    s_nop 0
    s_cbranch_vccnz L_cv5l
    s_branch L_cv5b
L_cv6r:
    s_mov_b32 s95, 131072
L_cv6l:
    s_add_u32 s30, s68, 3932160
    buffer_load_dwordx4 v[212:215], v10, s[44:47], s30 offen sc1
    s_sub_u32 s95, s95, 1
    s_waitcnt vmcnt(0)
    s_cbranch_scc1 L_cv6b
    v_xor_b32 v20, s99, v212
    v_bitop3_b32 v20, v213, s99, v20 bitop3:0xbe
    v_bitop3_b32 v20, v214, s99, v20 bitop3:0xbe
    v_bitop3_b32 v20, v215, s99, v20 bitop3:0xbe
    v_cmp_ne_u16 vcc, 0, v20
    s_nop 0
    s_cbranch_vccnz L_cv6l
    s_branch L_cv6b
L_cv7r:
    s_mov_b32 s95, 131072
L_cv7l:
    s_add_u32 s30, s68, 4587520
    buffer_load_dwordx4 v[216:219], v10, s[44:47], s30 offen sc1
    s_sub_u32 s95, s95, 1
    s_waitcnt vmcnt(0)
    s_cbranch_scc1 L_cv7b
    v_xor_b32 v20, s99, v216
    v_bitop3_b32 v20, v217, s99, v20 bitop3:0xbe
    v_bitop3_b32 v20, v218, s99, v20 bitop3:0xbe
    v_bitop3_b32 v20, v219, s99, v20 bitop3:0xbe
    v_cmp_ne_u16 vcc, 0, v20
    s_nop 0
    s_cbranch_vccnz L_cv7l
    s_branch L_cv7b
L_g1l0cr:
    s_mov_b32 s95, 131072
L_g1l0cl:
    s_buffer_load_dword s6, s[44:47], s53 offset:0 glc
    s_buffer_load_dword s7, s[44:47], s53 offset:1024 glc
    s_sub_u32 s95, s95, 1
    s_waitcnt lgkmcnt(0)
    s_cbranch_scc1 L_g1l0cb
    s_cmp_lg_u64 s[6:7], s[4:5]
    s_cbranch_scc1 L_g1l0cl
    s_branch L_g1l0cb
L_g1l1r:
    s_mov_b32 s95, 131072
L_g1l1l:
    s_buffer_load_dword s8, s[44:47], s53 offset:32768 glc
    s_buffer_load_dword s9, s[44:47], s53 offset:33792 glc
    s_sub_u32 s95, s95, 1
    s_waitcnt lgkmcnt(0)
    s_cbranch_scc1 L_g1l1b
    s_cmp_lg_u64 s[8:9], s[4:5]
    s_cbranch_scc1 L_g1l1l
    s_branch L_g1l1b
L_g1l2r:
    s_mov_b32 s95, 131072
L_g1l2l:
    s_buffer_load_dword s6, s[44:47], s53 offset:65536 glc
    s_buffer_load_dword s7, s[44:47], s53 offset:66560 glc
    s_sub_u32 s95, s95, 1
    s_waitcnt lgkmcnt(0)
    s_cbranch_scc1 L_g1l2b
    s_cmp_lg_u64 s[6:7], s[4:5]
    s_cbranch_scc1 L_g1l2l
    s_branch L_g1l2b
L_g1l3r:
    s_mov_b32 s95, 131072
L_g1l3l:
    s_buffer_load_dword s8, s[44:47], s53 offset:98304 glc
    s_buffer_load_dword s9, s[44:47], s53 offset:99328 glc
    s_sub_u32 s95, s95, 1
    s_waitcnt lgkmcnt(0)
    s_cbranch_scc1 L_g1l3b
    s_cmp_lg_u64 s[8:9], s[4:5]
    s_cbranch_scc1 L_g1l3l
    s_branch L_g1l3b
L_g1l4r:
    s_mov_b32 s95, 131072
L_g1l4l:
    s_buffer_load_dword s6, s[44:47], s53 offset:131072 glc
    s_buffer_load_dword s7, s[44:47], s53 offset:132096 glc
    s_sub_u32 s95, s95, 1
    s_waitcnt lgkmcnt(0)
    s_cbranch_scc1 L_g1l4b
    s_cmp_lg_u64 s[6:7], s[4:5]
    s_cbranch_scc1 L_g1l4l
    s_branch L_g1l4b
L_g1l5r:
    s_mov_b32 s95, 131072
L_g1l5l:
    s_buffer_load_dword s8, s[44:47], s53 offset:163840 glc
    s_buffer_load_dword s9, s[44:47], s53 offset:164864 glc
    s_sub_u32 s95, s95, 1
    s_waitcnt lgkmcnt(0)
    s_cbranch_scc1 L_g1l5b
    s_cmp_lg_u64 s[8:9], s[4:5]
    s_cbranch_scc1 L_g1l5l
    s_branch L_g1l5b
L_g1l6r:
    s_mov_b32 s95, 131072
L_g1l6l:
    s_buffer_load_dword s6, s[44:47], s53 offset:196608 glc
    s_buffer_load_dword s7, s[44:47], s53 offset:197632 glc
    s_sub_u32 s95, s95, 1
    s_waitcnt lgkmcnt(0)
    s_cbranch_scc1 L_g1l6b
    s_cmp_lg_u64 s[6:7], s[4:5]
    s_cbranch_scc1 L_g1l6l
    s_branch L_g1l6b
L_g1l7r:
    s_mov_b32 s95, 131072
L_g1l7l:
    s_buffer_load_dword s8, s[44:47], s53 offset:229376 glc
    s_buffer_load_dword s9, s[44:47], s53 offset:230400 glc
    s_sub_u32 s95, s95, 1
    s_waitcnt lgkmcnt(0)
    s_cbranch_scc1 L_g1l7b
    s_cmp_lg_u64 s[8:9], s[4:5]
    s_cbranch_scc1 L_g1l7l
    s_branch L_g1l7b
L_g1w2r:
    s_mov_b32 s95, 131072
L_g1w2l:
    s_mov_b32 s30, 41947136
    buffer_load_dword v88, v89, s[44:47], s30 offen sc1
    s_sub_u32 s95, s95, 1
    s_waitcnt vmcnt(0)
    s_cbranch_scc1 L_g1w2b
    v_cmp_ne_u32 vcc, v11, v88
    s_nop 0
    s_cbranch_vccnz L_g1w2l
    s_branch L_g1w2b
L_g2p0r:
    s_mov_b32 s95, 131072
L_g2p0l:
    s_add_u32 s30, s59, 0
    buffer_load_dword v8, v7, s[44:47], s30 offen sc1
    s_sub_u32 s95, s95, 1
    s_waitcnt vmcnt(0)
    s_cbranch_scc1 L_g2p0b
    v_cmp_ne_u32 vcc, v11, v8
    s_nop 0
    s_cbranch_vccnz L_g2p0l
    s_branch L_g2p0b
L_g2p1r:
    s_mov_b32 s95, 131072
L_g2p1l:
    s_add_u32 s30, s59, 131072
    buffer_load_dword v0, v7, s[44:47], s30 offen sc1
    s_sub_u32 s95, s95, 1
    s_waitcnt vmcnt(0)
    s_cbranch_scc1 L_g2p1b
    v_cmp_ne_u32 vcc, v11, v0
    s_nop 0
    s_cbranch_vccnz L_g2p1l
    s_branch L_g2p1b
L_g2p2r:
    s_mov_b32 s95, 131072
L_g2p2l:
    s_buffer_load_dword s6, s[44:47], s59 offset:262144 glc
    s_buffer_load_dword s7, s[44:47], s59 offset:262400 glc
    s_buffer_load_dword s8, s[44:47], s59 offset:262656 glc
    s_buffer_load_dword s9, s[44:47], s59 offset:262912 glc
    s_buffer_load_dword s10, s[44:47], s59 offset:263168 glc
    s_buffer_load_dword s11, s[44:47], s59 offset:263424 glc
    s_buffer_load_dword s12, s[44:47], s59 offset:263680 glc
    s_sub_u32 s95, s95, 1
    s_waitcnt lgkmcnt(0)
    s_cbranch_scc1 L_g2p2b
    s_mov_b32 s13, s12
    s_xor_b64 s[6:7], s[6:7], s[4:5]
    s_xor_b64 s[8:9], s[8:9], s[4:5]
    s_xor_b64 s[10:11], s[10:11], s[4:5]
    s_xor_b64 s[12:13], s[12:13], s[4:5]
    s_or_b64 s[6:7], s[6:7], s[8:9]
    s_or_b64 s[10:11], s[10:11], s[12:13]
    s_or_b64 s[6:7], s[6:7], s[10:11]
    s_cbranch_scc1 L_g2p2l
    s_branch L_g2p2b
L_g2p3r:
    s_mov_b32 s95, 131072
L_g2p3l:
    s_buffer_load_dword s6, s[44:47], s59 offset:393216 glc
    s_buffer_load_dword s7, s[44:47], s59 offset:393472 glc
    s_buffer_load_dword s8, s[44:47], s59 offset:393728 glc
    s_buffer_load_dword s9, s[44:47], s59 offset:393984 glc
    s_buffer_load_dword s10, s[44:47], s59 offset:394240 glc
    s_buffer_load_dword s11, s[44:47], s59 offset:394496 glc
    s_buffer_load_dword s12, s[44:47], s59 offset:394752 glc
    s_sub_u32 s95, s95, 1
    s_waitcnt lgkmcnt(0)
    s_cbranch_scc1 L_g2p3b
    s_mov_b32 s13, s12
    s_xor_b64 s[6:7], s[6:7], s[4:5]
    s_xor_b64 s[8:9], s[8:9], s[4:5]
    s_xor_b64 s[10:11], s[10:11], s[4:5]
    s_xor_b64 s[12:13], s[12:13], s[4:5]
    s_or_b64 s[6:7], s[6:7], s[8:9]
    s_or_b64 s[10:11], s[10:11], s[12:13]
    s_or_b64 s[6:7], s[6:7], s[10:11]
    s_cbranch_scc1 L_g2p3l
    s_branch L_g2p3b
L_g2s0r:
    s_mov_b32 s95, 131072
L_g2s0l:
    s_add_u32 s64, s62, 0
    buffer_load_dwordx4 v[60:63], v91, s[44:47], s64 offen sc1
    s_sub_u32 s95, s95, 1
    s_waitcnt vmcnt(0)
    s_cbranch_scc1 L_g2s0b
    v_xor_b32 v76, v11, v60
    v_bitop3_b32 v76, v63, v11, v76 bitop3:0xbe
    v_cmp_ne_u32 vcc, 0, v76
    s_nop 0
    s_cbranch_vccnz L_g2s0l
    s_branch L_g2s0b
L_g2s1r:
    s_mov_b32 s95, 131072
L_g2s1l:
    s_add_u32 s64, s62, 65536
    buffer_load_dwordx4 v[64:67], v91, s[44:47], s64 offen sc1
    s_sub_u32 s95, s95, 1
    s_waitcnt vmcnt(0)
    s_cbranch_scc1 L_g2s1b
    v_xor_b32 v76, v11, v64
    v_bitop3_b32 v76, v67, v11, v76 bitop3:0xbe
    v_cmp_ne_u32 vcc, 0, v76
    s_nop 0
    s_cbranch_vccnz L_g2s1l
    s_branch L_g2s1b
L_g2s2r:
    s_mov_b32 s95, 131072
L_g2s2l:
    s_add_u32 s64, s62, 131072
    buffer_load_dwordx4 v[60:63], v91, s[44:47], s64 offen sc1
    s_sub_u32 s95, s95, 1
    s_waitcnt vmcnt(0)
    s_cbranch_scc1 L_g2s2b
    v_xor_b32 v76, v11, v60
    v_bitop3_b32 v76, v63, v11, v76 bitop3:0xbe
    v_cmp_ne_u32 vcc, 0, v76
    s_nop 0
    s_cbranch_vccnz L_g2s2l
    s_branch L_g2s2b
L_g2s3r:
    s_mov_b32 s95, 131072
L_g2s3l:
    s_add_u32 s64, s62, 196608
    buffer_load_dwordx4 v[64:67], v91, s[44:47], s64 offen sc1
    s_sub_u32 s95, s95, 1
    s_waitcnt vmcnt(0)
    s_cbranch_scc1 L_g2s3b
    v_xor_b32 v44, v11, v64
    v_bitop3_b32 v44, v67, v11, v44 bitop3:0xbe
    v_cmp_ne_u32 vcc, 0, v44
    s_nop 0
    s_cbranch_vccnz L_g2s3l
    s_branch L_g2s3b
L_fpa:
    s_add_u32 m0, s71, 40960
    s_add_u32 s31, s70, 552960
    buffer_load_dwordx4 v248, s[40:43], s31 offen offset:0 lds
    s_add_u32 s31, s70, 579584
    buffer_load_dwordx4 v249, s[40:43], s31 offen offset:1024 lds
    s_add_u32 s31, s70, 606208
    buffer_load_dwordx4 v248, s[40:43], s31 offen offset:2048 lds
    s_add_u32 s31, s70, 632832
    buffer_load_dwordx4 v249, s[40:43], s31 offen offset:3072 lds
    s_add_u32 m0, s71, 45056
    s_add_u32 s31, s70, 663552
    buffer_load_dwordx4 v248, s[40:43], s31 offen offset:0 lds
    s_add_u32 s31, s70, 690176
    buffer_load_dwordx4 v249, s[40:43], s31 offen offset:1024 lds
    s_add_u32 s31, s70, 716800
    buffer_load_dwordx4 v248, s[40:43], s31 offen offset:2048 lds
    s_add_u32 s31, s70, 743424
    buffer_load_dwordx4 v249, s[40:43], s31 offen offset:3072 lds
    s_add_u32 m0, s71, 49152
    s_add_u32 s31, s70, 774144
    buffer_load_dwordx4 v248, s[40:43], s31 offen offset:0 lds
    s_add_u32 s31, s70, 800768
    buffer_load_dwordx4 v249, s[40:43], s31 offen offset:1024 lds
    s_add_u32 m0, s71, 122880
    s_add_u32 s31, s70, 1658880
    buffer_load_dwordx4 v248, s[40:43], s31 offen offset:0 lds
    s_add_u32 s31, s70, 1685504
    buffer_load_dwordx4 v249, s[40:43], s31 offen offset:1024 lds
    s_add_u32 s31, s70, 1712128
    buffer_load_dwordx4 v248, s[40:43], s31 offen offset:2048 lds
    s_add_u32 s31, s70, 1738752
    buffer_load_dwordx4 v249, s[40:43], s31 offen offset:3072 lds
    s_add_u32 m0, s71, 126976
    s_add_u32 s31, s70, 1769472
    buffer_load_dwordx4 v248, s[40:43], s31 offen offset:0 lds
    s_add_u32 s31, s70, 1796096
    buffer_load_dwordx4 v249, s[40:43], s31 offen offset:1024 lds
    s_add_u32 s31, s70, 1822720
    buffer_load_dwordx4 v248, s[40:43], s31 offen offset:2048 lds
    s_add_u32 s31, s70, 1849344
    buffer_load_dwordx4 v249, s[40:43], s31 offen offset:3072 lds
    s_add_u32 m0, s71, 131072
    s_add_u32 s31, s70, 1880064
    buffer_load_dwordx4 v248, s[40:43], s31 offen offset:0 lds
    s_add_u32 s31, s70, 1906688
    buffer_load_dwordx4 v249, s[40:43], s31 offen offset:1024 lds
    s_branch L_fqa
L_fpb:
    v_add_u32 v60, 40960, v250
    ds_read_b64_tr_b16 a[40:41], v60 offset:0
    ds_read_b64_tr_b16 a[42:43], v60 offset:512
    ds_read_b64_tr_b16 a[44:45], v60 offset:20480
    ds_read_b64_tr_b16 a[46:47], v60 offset:20992
    ds_read_b64_tr_b16 a[48:49], v60 offset:4096
    ds_read_b64_tr_b16 a[50:51], v60 offset:4608
    ds_read_b64_tr_b16 a[52:53], v60 offset:24576
    ds_read_b64_tr_b16 a[54:55], v60 offset:25088
    ds_read_b64_tr_b16 a[56:57], v60 offset:8192
    ds_read_b64_tr_b16 a[58:59], v60 offset:8704
    ds_read_b64_tr_b16 a[60:61], v60 offset:28672
    ds_read_b64_tr_b16 a[62:63], v60 offset:29184
    ds_read_b64_tr_b16 a[64:65], v60 offset:12288
    ds_read_b64_tr_b16 a[66:67], v60 offset:12800
    ds_read_b64_tr_b16 a[68:69], v60 offset:32768
    ds_read_b64_tr_b16 a[70:71], v60 offset:33280
    ds_read_b64_tr_b16 a[72:73], v60 offset:16384
    ds_read_b64_tr_b16 a[74:75], v60 offset:16896
    ds_read_b64_tr_b16 a[76:77], v60 offset:36864
    ds_read_b64_tr_b16 a[78:79], v60 offset:37376
    s_add_u32 m0, s71, 81920
    s_add_u32 s31, s70, 0
    buffer_load_dwordx4 v248, s[40:43], s31 offen offset:0 lds
    s_add_u32 s31, s70, 26624
    buffer_load_dwordx4 v249, s[40:43], s31 offen offset:1024 lds
    s_add_u32 s31, s70, 53248
    buffer_load_dwordx4 v248, s[40:43], s31 offen offset:2048 lds
    s_add_u32 s31, s70, 79872
    buffer_load_dwordx4 v249, s[40:43], s31 offen offset:3072 lds
    s_add_u32 m0, s71, 86016
    s_add_u32 s31, s70, 110592
    buffer_load_dwordx4 v248, s[40:43], s31 offen offset:0 lds
    s_add_u32 s31, s70, 137216
    buffer_load_dwordx4 v249, s[40:43], s31 offen offset:1024 lds
    s_add_u32 s31, s70, 163840
    buffer_load_dwordx4 v248, s[40:43], s31 offen offset:2048 lds
    s_add_u32 s31, s70, 190464
    buffer_load_dwordx4 v249, s[40:43], s31 offen offset:3072 lds
    s_add_u32 m0, s71, 90112
    s_add_u32 s31, s70, 221184
    buffer_load_dwordx4 v248, s[40:43], s31 offen offset:0 lds
    s_add_u32 s31, s70, 247808
    buffer_load_dwordx4 v249, s[40:43], s31 offen offset:1024 lds
    v_add_u32 v61, 122880, v250
    ds_read_b64_tr_b16 a[120:121], v61 offset:0
    ds_read_b64_tr_b16 a[122:123], v61 offset:512
    ds_read_b64_tr_b16 a[124:125], v61 offset:20480
    ds_read_b64_tr_b16 a[126:127], v61 offset:20992
    ds_read_b64_tr_b16 a[128:129], v61 offset:4096
    ds_read_b64_tr_b16 a[130:131], v61 offset:4608
    ds_read_b64_tr_b16 a[132:133], v61 offset:24576
    ds_read_b64_tr_b16 a[134:135], v61 offset:25088
    ds_read_b64_tr_b16 a[136:137], v61 offset:8192
    ds_read_b64_tr_b16 a[138:139], v61 offset:8704
    ds_read_b64_tr_b16 a[140:141], v61 offset:28672
    ds_read_b64_tr_b16 a[142:143], v61 offset:29184
    ds_read_b64_tr_b16 a[144:145], v61 offset:12288
    ds_read_b64_tr_b16 a[146:147], v61 offset:12800
    ds_read_b64_tr_b16 a[148:149], v61 offset:32768
    ds_read_b64_tr_b16 a[150:151], v61 offset:33280
    ds_read_b64_tr_b16 a[152:153], v61 offset:16384
    ds_read_b64_tr_b16 a[154:155], v61 offset:16896
    ds_read_b64_tr_b16 a[156:157], v61 offset:36864
    ds_read_b64_tr_b16 a[158:159], v61 offset:37376
    s_branch L_fqb
L_fpc:
    s_add_u32 m0, s71, 40960
    s_add_u32 s31, s70, 1105920
    buffer_load_dwordx4 v248, s[40:43], s31 offen offset:0 lds
    s_add_u32 s31, s70, 1132544
    buffer_load_dwordx4 v249, s[40:43], s31 offen offset:1024 lds
    s_add_u32 s31, s70, 1159168
    buffer_load_dwordx4 v248, s[40:43], s31 offen offset:2048 lds
    s_add_u32 s31, s70, 1185792
    buffer_load_dwordx4 v249, s[40:43], s31 offen offset:3072 lds
    s_add_u32 m0, s71, 45056
    s_add_u32 s31, s70, 1216512
    buffer_load_dwordx4 v248, s[40:43], s31 offen offset:0 lds
    s_add_u32 s31, s70, 1243136
    buffer_load_dwordx4 v249, s[40:43], s31 offen offset:1024 lds
    s_add_u32 s31, s70, 1269760
    buffer_load_dwordx4 v248, s[40:43], s31 offen offset:2048 lds
    s_add_u32 s31, s70, 1296384
    buffer_load_dwordx4 v249, s[40:43], s31 offen offset:3072 lds
    s_add_u32 m0, s71, 49152
    s_add_u32 s31, s70, 1327104
    buffer_load_dwordx4 v248, s[40:43], s31 offen offset:0 lds
    s_add_u32 s31, s70, 1353728
    buffer_load_dwordx4 v249, s[40:43], s31 offen offset:1024 lds
    s_branch L_fqc
L_fpd:
    v_add_u32 v60, 81920, v250
    ds_read_b64_tr_b16 a[0:1], v60 offset:0
    ds_read_b64_tr_b16 a[2:3], v60 offset:512
    ds_read_b64_tr_b16 a[4:5], v60 offset:20480
    ds_read_b64_tr_b16 a[6:7], v60 offset:20992
    ds_read_b64_tr_b16 a[8:9], v60 offset:4096
    ds_read_b64_tr_b16 a[10:11], v60 offset:4608
    ds_read_b64_tr_b16 a[12:13], v60 offset:24576
    ds_read_b64_tr_b16 a[14:15], v60 offset:25088
    ds_read_b64_tr_b16 a[16:17], v60 offset:8192
    ds_read_b64_tr_b16 a[18:19], v60 offset:8704
    ds_read_b64_tr_b16 a[20:21], v60 offset:28672
    ds_read_b64_tr_b16 a[22:23], v60 offset:29184
    ds_read_b64_tr_b16 a[24:25], v60 offset:12288
    ds_read_b64_tr_b16 a[26:27], v60 offset:12800
    ds_read_b64_tr_b16 a[28:29], v60 offset:32768
    ds_read_b64_tr_b16 a[30:31], v60 offset:33280
    ds_read_b64_tr_b16 a[32:33], v60 offset:16384
    ds_read_b64_tr_b16 a[34:35], v60 offset:16896
    ds_read_b64_tr_b16 a[36:37], v60 offset:36864
    ds_read_b64_tr_b16 a[38:39], v60 offset:37376
    s_branch L_fqd
L_fpe:
    v_add_u32 v60, 40960, v250
    ds_read_b64_tr_b16 a[80:81], v60 offset:0
    ds_read_b64_tr_b16 a[82:83], v60 offset:512
    ds_read_b64_tr_b16 a[84:85], v60 offset:20480
    ds_read_b64_tr_b16 a[86:87], v60 offset:20992
    ds_read_b64_tr_b16 a[88:89], v60 offset:4096
    ds_read_b64_tr_b16 a[90:91], v60 offset:4608
    ds_read_b64_tr_b16 a[92:93], v60 offset:24576
    ds_read_b64_tr_b16 a[94:95], v60 offset:25088
    ds_read_b64_tr_b16 a[96:97], v60 offset:8192
    ds_read_b64_tr_b16 a[98:99], v60 offset:8704
    ds_read_b64_tr_b16 a[100:101], v60 offset:28672
    ds_read_b64_tr_b16 a[102:103], v60 offset:29184
    ds_read_b64_tr_b16 a[104:105], v60 offset:12288
    ds_read_b64_tr_b16 a[106:107], v60 offset:12800
    ds_read_b64_tr_b16 a[108:109], v60 offset:32768
    ds_read_b64_tr_b16 a[110:111], v60 offset:33280
    ds_read_b64_tr_b16 a[112:113], v60 offset:16384
    ds_read_b64_tr_b16 a[114:115], v60 offset:16896
    ds_read_b64_tr_b16 a[116:117], v60 offset:36864
    ds_read_b64_tr_b16 a[118:119], v60 offset:37376
    s_branch L_fqe
L_g1l0fr:
    s_mov_b32 s95, 131072
L_g1l0fl:
    s_buffer_load_dword s6, s[44:47], s53 offset:0 glc
    s_buffer_load_dword s7, s[44:47], s53 offset:1024 glc
    s_sub_u32 s95, s95, 1
    s_waitcnt lgkmcnt(0)
    s_cbranch_scc1 L_g1l0fb
    s_cmp_lg_u64 s[6:7], s[4:5]
    s_cbranch_scc1 L_g1l0fl
    s_branch L_g1l0fb
L_ryr:
    s_mov_b32 s95, 131072
L_ryl:
    s_add_u32 s30, s56, 8192
    s_add_u32 s31, s56, 16384
    buffer_load_dwordx4 v[72:75], v2, s[44:47], s56 offen offset:0 sc1
    buffer_load_dwordx4 v[76:79], v2, s[44:47], s56 offen offset:128 sc1
    buffer_load_dwordx4 v[80:83], v2, s[44:47], s30 offen offset:0 sc1
    buffer_load_dwordx4 v[84:87], v2, s[44:47], s30 offen offset:128 sc1
    buffer_load_dwordx4 v[88:91], v3, s[44:47], s31 offen offset:0 sc1
    s_sub_u32 s95, s95, 1
    s_waitcnt vmcnt(0)
    s_cbranch_scc1 L_ryb
    v_xor_b32 v72, s99, v72
    v_xor_b32 v73, s99, v73
    v_xor_b32 v74, s99, v74
    v_xor_b32 v75, s99, v75
    v_xor_b32 v76, s99, v76
    v_xor_b32 v77, s99, v77
    v_xor_b32 v78, s99, v78
    v_xor_b32 v79, s99, v79
    v_xor_b32 v80, s99, v80
    v_xor_b32 v81, s99, v81
    v_xor_b32 v82, s99, v82
    v_xor_b32 v83, s99, v83
    v_xor_b32 v84, s99, v84
    v_xor_b32 v85, s99, v85
    v_xor_b32 v86, s99, v86
    v_xor_b32 v87, s99, v87
    v_xor_b32 v88, s99, v88
    v_xor_b32 v89, s99, v89
    v_xor_b32 v90, s99, v90
    v_xor_b32 v91, s99, v91
    v_or3_b32 v16, v72, v73, v74
    v_or3_b32 v17, v75, v76, v77
    v_or3_b32 v16, v78, v79, v16
    v_or3_b32 v17, v80, v81, v17
    v_or3_b32 v16, v82, v83, v16
    v_or3_b32 v17, v84, v85, v17
    v_or3_b32 v16, v86, v87, v16
    v_or3_b32 v17, v88, v89, v17
    v_or3_b32 v16, v90, v91, v16
    v_or_b32 v16, v16, v17
    v_cmp_ne_u16 vcc, 0, v16
    s_nop 0
    s_cbranch_vccnz L_ryl
    s_branch L_ryb
L_ry0r:
    s_mov_b32 s95, 131072
L_ry0l:
    s_add_u32 s30, s56, 8192
    s_add_u32 s31, s56, 16384
    buffer_load_dwordx4 v[72:75], v2, s[44:47], s56 offen offset:0 sc1
    buffer_load_dwordx4 v[76:79], v2, s[44:47], s56 offen offset:128 sc1
    buffer_load_dwordx4 v[80:83], v2, s[44:47], s30 offen offset:0 sc1
    buffer_load_dwordx4 v[84:87], v2, s[44:47], s30 offen offset:128 sc1
    buffer_load_dwordx4 v[88:91], v3, s[44:47], s31 offen offset:0 sc1
    s_sub_u32 s95, s95, 1
    s_waitcnt vmcnt(0)
    s_cbranch_scc1 L_ry0b
    v_xor_b32 v72, s99, v72
    v_xor_b32 v73, s99, v73
    v_xor_b32 v74, s99, v74
    v_xor_b32 v75, s99, v75
    v_xor_b32 v76, s99, v76
    v_xor_b32 v77, s99, v77
    v_xor_b32 v78, s99, v78
    v_xor_b32 v79, s99, v79
    v_xor_b32 v80, s99, v80
    v_xor_b32 v81, s99, v81
    v_xor_b32 v82, s99, v82
    v_xor_b32 v83, s99, v83
    v_xor_b32 v84, s99, v84
    v_xor_b32 v85, s99, v85
    v_xor_b32 v86, s99, v86
    v_xor_b32 v87, s99, v87
    v_xor_b32 v88, s99, v88
    v_xor_b32 v89, s99, v89
    v_xor_b32 v90, s99, v90
    v_xor_b32 v91, s99, v91
    v_or3_b32 v16, v72, v73, v74
    v_or3_b32 v17, v75, v76, v77
    v_or3_b32 v16, v78, v79, v16
    v_or3_b32 v17, v80, v81, v17
    v_or3_b32 v16, v82, v83, v16
    v_or3_b32 v17, v84, v85, v17
    v_or3_b32 v16, v86, v87, v16
    v_or3_b32 v17, v88, v89, v17
    v_or3_b32 v16, v90, v91, v16
    v_or_b32 v16, v16, v17
    v_cmp_ne_u16 vcc, 0, v16
    s_nop 0
    s_cbranch_vccnz L_ry0l
    s_branch L_ry0b
L_ry1r:
    s_mov_b32 s95, 131072
L_ry1l:
    s_add_u32 s30, s56, 8192
    s_add_u32 s31, s56, 16384
    buffer_load_dwordx4 v[140:143], v2, s[44:47], s56 offen offset:0 sc1
    buffer_load_dwordx4 v[144:147], v2, s[44:47], s56 offen offset:128 sc1
    buffer_load_dwordx4 v[148:151], v2, s[44:47], s30 offen offset:0 sc1
    buffer_load_dwordx4 v[152:155], v2, s[44:47], s30 offen offset:128 sc1
    buffer_load_dwordx4 v[156:159], v3, s[44:47], s31 offen offset:0 sc1
    s_sub_u32 s95, s95, 1
    s_waitcnt vmcnt(0)
    s_cbranch_scc1 L_ry1b
    v_xor_b32 v140, s99, v140
    v_xor_b32 v141, s99, v141
    v_xor_b32 v142, s99, v142
    v_xor_b32 v143, s99, v143
    v_xor_b32 v144, s99, v144
    v_xor_b32 v145, s99, v145
    v_xor_b32 v146, s99, v146
    v_xor_b32 v147, s99, v147
    v_xor_b32 v148, s99, v148
    v_xor_b32 v149, s99, v149
    v_xor_b32 v150, s99, v150
    v_xor_b32 v151, s99, v151
    v_xor_b32 v152, s99, v152
    v_xor_b32 v153, s99, v153
    v_xor_b32 v154, s99, v154
    v_xor_b32 v155, s99, v155
    v_xor_b32 v156, s99, v156
    v_xor_b32 v157, s99, v157
    v_xor_b32 v158, s99, v158
    v_xor_b32 v159, s99, v159
    v_or3_b32 v16, v140, v141, v142
    v_or3_b32 v17, v143, v144, v145
    v_or3_b32 v16, v146, v147, v16
    v_or3_b32 v17, v148, v149, v17
    v_or3_b32 v16, v150, v151, v16
    v_or3_b32 v17, v152, v153, v17
    v_or3_b32 v16, v154, v155, v16
    v_or3_b32 v17, v156, v157, v17
    v_or3_b32 v16, v158, v159, v16
    v_or_b32 v16, v16, v17
    v_cmp_ne_u16 vcc, 0, v16
    s_nop 0
    s_cbranch_vccnz L_ry1l
    s_branch L_ry1b
L_rh2r:
    s_mov_b32 s95, 131072
L_rh2l:
    buffer_load_dword v161, v160, s[44:47], s69 offen sc1
    s_sub_u32 s95, s95, 1
    s_waitcnt vmcnt(0)
    s_cbranch_scc1 L_rh2b
    v_xor_b32 v161, s99, v161
    v_cmp_ne_u16 vcc, 0, v161
    s_nop 0
    s_cbranch_vccnz L_rh2l
    s_branch L_rh2b
L_msw2r:
    s_mov_b32 s95, 131072
L_msw2l:
    s_mov_b32 s30, 41947136
    buffer_load_dword v88, v89, s[44:47], s30 offen sc1
    s_sub_u32 s95, s95, 1
    s_waitcnt vmcnt(0)
    s_cbranch_scc1 L_msw2b
    v_cmp_ne_u32 vcc, v11, v88
    s_nop 0
    s_cbranch_vccnz L_msw2l
    s_branch L_msw2b
L_mshr:
    s_mov_b32 s95, 131072
L_mshl:
    s_add_u32 s30, s59, 131072
    buffer_load_dword v8, v88, s[44:47], s30 offen sc1
    s_sub_u32 s95, s95, 1
    s_waitcnt vmcnt(0)
    s_cbranch_scc1 L_mshb
    v_cmp_ne_u32 vcc, v11, v8
    s_nop 0
    s_cbranch_vccnz L_mshl
    s_branch L_mshb
L_g2p0mr:
    s_mov_b32 s95, 131072
L_g2p0ml:
    s_buffer_load_dword s6, s[44:47], s59 offset:0 glc
    s_buffer_load_dword s7, s[44:47], s59 offset:256 glc
    s_buffer_load_dword s8, s[44:47], s59 offset:512 glc
    s_buffer_load_dword s9, s[44:47], s59 offset:768 glc
    s_buffer_load_dword s10, s[44:47], s59 offset:1024 glc
    s_buffer_load_dword s11, s[44:47], s59 offset:1280 glc
    s_buffer_load_dword s12, s[44:47], s59 offset:1536 glc
    s_sub_u32 s95, s95, 1
    s_waitcnt lgkmcnt(0)
    s_cbranch_scc1 L_g2p0mb
    s_mov_b32 s13, s12
    s_xor_b64 s[6:7], s[6:7], s[4:5]
    s_xor_b64 s[8:9], s[8:9], s[4:5]
    s_xor_b64 s[10:11], s[10:11], s[4:5]
    s_xor_b64 s[12:13], s[12:13], s[4:5]
    s_or_b64 s[6:7], s[6:7], s[8:9]
    s_or_b64 s[10:11], s[10:11], s[12:13]
    s_or_b64 s[6:7], s[6:7], s[10:11]
    s_cbranch_scc1 L_g2p0ml
    s_branch L_g2p0mb
L_g2p1mr:
    s_mov_b32 s95, 131072
L_g2p1ml:
    s_buffer_load_dword s6, s[44:47], s59 offset:131072 glc
    s_buffer_load_dword s7, s[44:47], s59 offset:131328 glc
    s_buffer_load_dword s8, s[44:47], s59 offset:131584 glc
    s_buffer_load_dword s9, s[44:47], s59 offset:131840 glc
    s_buffer_load_dword s10, s[44:47], s59 offset:132096 glc
    s_buffer_load_dword s11, s[44:47], s59 offset:132352 glc
    s_buffer_load_dword s12, s[44:47], s59 offset:132608 glc
    s_sub_u32 s95, s95, 1
    s_waitcnt lgkmcnt(0)
    s_cbranch_scc1 L_g2p1mb
    s_mov_b32 s13, s12
    s_xor_b64 s[6:7], s[6:7], s[4:5]
    s_xor_b64 s[8:9], s[8:9], s[4:5]
    s_xor_b64 s[10:11], s[10:11], s[4:5]
    s_xor_b64 s[12:13], s[12:13], s[4:5]
    s_or_b64 s[6:7], s[6:7], s[8:9]
    s_or_b64 s[10:11], s[10:11], s[12:13]
    s_or_b64 s[6:7], s[6:7], s[10:11]
    s_cbranch_scc1 L_g2p1ml
    s_branch L_g2p1mb
L_epr:
    s_mov_b32 s95, 131072
L_epl:
    s_mov_b32 s30, 42205184
    buffer_load_dword v24, v20, s[44:47], s30 offen sc1
    s_mov_b32 s30, 42221568
    buffer_load_dword v25, v20, s[44:47], s30 offen sc1
    s_mov_b32 s30, 42237952
    buffer_load_dword v26, v20, s[44:47], s30 offen sc1
    s_mov_b32 s30, 42254336
    buffer_load_dword v27, v20, s[44:47], s30 offen sc1
    s_mov_b32 s30, 42991616
    buffer_load_dword v28, v21, s[44:47], s30 offen sc1
    s_sub_u32 s95, s95, 1
    s_waitcnt vmcnt(0)
    s_cbranch_scc1 L_epb
    v_xor_b32 v22, v11, v24
    v_bitop3_b32 v22, v25, v11, v22 bitop3:0xbe
    v_bitop3_b32 v22, v26, v11, v22 bitop3:0xbe
    v_bitop3_b32 v22, v27, v11, v22 bitop3:0xbe
    v_bitop3_b32 v22, v28, v11, v22 bitop3:0xbe
    v_cmp_ne_u32 vcc, 0, v22
    s_nop 0
    s_cbranch_vccnz L_epl
    s_branch L_epb
L_code_end:

.section .rodata,"a"
.p2align 6
.amdhsa_kernel sequential_preLN__ssm_conv_h3__glu_gated_glu__prompt_kernel
  .amdhsa_next_free_vgpr 512
  .amdhsa_next_free_sgpr 102
  .amdhsa_accum_offset 256
  .amdhsa_group_segment_fixed_size 0
  .amdhsa_kernarg_size 104
  .amdhsa_user_sgpr_count 2
  .amdhsa_user_sgpr_kernarg_segment_ptr 1
  .amdhsa_system_sgpr_workgroup_id_x 1
  .amdhsa_float_denorm_mode_32 3
.end_amdhsa_kernel
```
